```python
import torch

def _softmax(x, axis=-1):
    return torch.softmax(x, dim=axis)

def _gelu(x):
    return torch.nn.functional.gelu(x, approximate='tanh')

def _silu(x):
    return torch.nn.functional.silu(x)

def _sigmoid(x):
    return torch.sigmoid(x)

def _layernorm(x, axis=-1, eps=1e-05):
    m = x.mean(dim=axis, keepdim=True)
    v = x.var(dim=axis, keepdim=True, unbiased=False)
    return (x - m) / torch.sqrt(v + eps)

def _scatter_add(tgt, idx, src, axis=0):
    return tgt.clone().index_add_(axis, idx, src)

def _segment_sum(src, seg, n):
    out = torch.zeros((n,) + src.shape[1:], dtype=src.dtype)
    return out.index_add_(0, seg, src)

def _pad(x, pw):
    flat = tuple((v for pair in reversed(pw) for v in pair))
    return torch.nn.functional.pad(x, flat)
kernel_name = 'recurrent_scan__sliding_local_dilated__mixer_gmlp__prompt'

def setup_inputs():

    _w = lambda a: (lambda t: t.to(torch.bfloat16) if t.is_floating_point() else t)(torch.as_tensor(a))

    def _A_setup():
        B, S, D = (1, 2048, 512)
        return {'x': _w((lambda *s: torch.randn(*s, dtype=torch.bfloat16) * 0.05)(B, S, D)), 'wqkv': _w((lambda *s: torch.randn(*s, dtype=torch.bfloat16) * 0.05)(D, 3 * D)), 'wo': _w((lambda *s: torch.randn(*s, dtype=torch.bfloat16) * 0.05)(D, D))}
    _A_in = _A_setup()

    def _B_setup():
        B, S, D, F = (1, 2048, 512, 1376)
        Fh = F // 2
        return {'x': _w((lambda *s: torch.randn(*s, dtype=torch.bfloat16) * 0.05)(B, S, D)), 'w_in': _w((lambda *s: torch.randn(*s, dtype=torch.bfloat16) * 0.4)(D, 2 * Fh)), 'w_sp': _w(0.01 * (lambda *s: torch.randn(*s, dtype=torch.bfloat16) * 0.4)(S, S)), 'b_sp': _w(1.0 + 0.01 * (lambda *s: torch.randn(*s, dtype=torch.bfloat16) * 0.05)(S)), 'w_out': _w((lambda *s: torch.randn(*s, dtype=torch.bfloat16) * 0.05)(Fh, D))}
    _B_in = _B_setup()
    return {'A_x': _A_in['x'], 'A_wqkv': _A_in['wqkv'], 'A_wo': _A_in['wo'], 'B_x': _B_in['x'], 'B_w_in': _B_in['w_in'], 'B_w_sp': _B_in['w_sp'], 'B_b_sp': _B_in['b_sp'], 'B_w_out': _B_in['w_out']}

def reference(A_x, A_wqkv, A_wo, B_x, B_w_in, B_w_sp, B_b_sp, B_w_out):

    def _A_ref(x, wqkv, wo):
        B, S, D = x.shape
        H = 32
        Dh = D // H
        W, dil = (8, 2)
        qkv = (lambda x, *d: x.permute(*d))((x @ wqkv).reshape(B, S, 3, H, Dh), 2, 0, 3, 1, 4)
        q, k, v = (qkv[0], qkv[1], qkv[2])
        scale = Dh ** (-0.5)
        pos = torch.arange(S)
        off = torch.arange(W) * dil
        idx = pos[:, None] - off[None, :]
        mask = idx >= 0
        idx_c = torch.where(mask, idx, 0).reshape(-1)
        kg = k[:, :, idx_c, :].reshape(B, H, S, W, Dh)
        vg = v[:, :, idx_c, :].reshape(B, H, S, W, Dh)
        logits = torch.einsum('bhsd,bhswd->bhsw', q, kg) * scale
        logits = torch.where(mask[None, None, :, :], logits, -1000000000.0)
        attn = _softmax(logits, axis=-1)
        o = torch.einsum('bhsw,bhswd->bhsd', attn, vg)
        return (lambda x, *d: x.permute(*d))(o, 0, 2, 1, 3).reshape(B, S, D) @ wo

    def _B_ref(x, w_in, w_sp, b_sp, w_out):
        B, S, D = x.shape
        F = w_in.shape[-1]
        Fh = F // 2
        z = _gelu(torch.einsum('bsd,df->bsf', x, w_in))
        z1 = z[..., :Fh].clone()
        z2 = _layernorm(z[..., Fh:], axis=-1)
        g = torch.einsum('ts,bsf->btf', w_sp, z2) + b_sp[None, :, None]
        return torch.einsum('bsf,fd->bsd', z1 * g, w_out)
    x = A_x
    xn = _layernorm(x, axis=-1)
    s = _A_ref(xn, A_wqkv, A_wo)
    g = _silu(_B_ref(xn, B_w_in, B_w_sp, B_b_sp, B_w_out))
    return x + s * g
```

```asm
; @launch grid=(256,1,1) block=(256,1,1) lds=163840
.amdgcn_target "amdgcn-amd-amdhsa--gfx950"
.text
.globl recurrent_scan__sliding_local_dilated__mixer_gmlp__prompt_kernel
.p2align 8
.type recurrent_scan__sliding_local_dilated__mixer_gmlp__prompt_kernel,@function
recurrent_scan__sliding_local_dilated__mixer_gmlp__prompt_kernel:
s_load_dwordx16 s[44:59], s[0:1], 0
s_load_dwordx4 s[60:63], s[0:1], 64
s_load_dwordx2 s[64:65], s[0:1], 80
s_cmp_ge_u32 s2, 256
s_cbranch_scc1 L_end
s_getpc_b64 s[98:99]
s_lshr_b32 s3, s2, 3
v_lshrrev_b32 v2, 4, v0
v_lshlrev_b32_e64 v2, 12, v2
v_lshl_add_u32 v2, s3, 7, v2
v_min_u32 v2, 43764, v2
global_load_dword v248, v2, s[98:99]
v_lshrrev_b32 v1, 6, v0
v_and_b32 v0, 63, v0
v_readfirstlane_b32 s66, v1
s_bfe_u32 s82, s2, 0x10002
s_lshr_b32 s3, s2, 5
s_lshl3_add_u32 s82, s82, s3
s_and_b32 s68, s2, 3
s_bfe_u32 s3, s2, 0x10003
s_lshl1_add_u32 s68, s68, s3
s_bfe_u32 s3, s2, 0x10004
s_lshl1_add_u32 s67, s82, s3
s_add_u32 s73, s82, s68
s_and_b32 s73, s73, 3
v_and_b32 v1, 15, v0
v_lshrrev_b32 v2, 4, v0
s_lshl_b32 s3, s66, 2
v_add_u32 v171, s3, v2
v_xor_b32 v161, v171, v1
v_lshlrev_b32 v161, 4, v161
v_lshl_add_u32 v5, v171, 11, v161
s_lshl_b32 s88, s82, 17
s_xor_b32 s3, s73, 0
s_lshl_b32 s78, s3, 7
s_lshl1_add_u32 s74, s78, s88
s_xor_b32 s3, s73, 1
s_lshl_b32 s79, s3, 7
s_lshl1_add_u32 s75, s79, s88
s_xor_b32 s3, s73, 2
s_lshl_b32 s80, s3, 7
s_lshl1_add_u32 s76, s80, s88
s_xor_b32 s3, s73, 3
s_lshl_b32 s81, s3, 7
s_lshl1_add_u32 s77, s81, s88
s_mov_b32 s6, 2097152
s_mov_b32 s7, 0x20000
s_lshl_b32 s89, s66, 10
s_waitcnt lgkmcnt(0)
s_mov_b64 s[4:5], s[44:45]
s_mov_b64 s[32:33], s[60:61]
s_mov_b32 s60, s89
s_lshl_b32 s84, s89, 1
s_add_u32 m0, s84, 0
s_add_u32 s3, s74, 0
s_nop 0
buffer_load_dwordx4 v5, s[4:7], s3 offen lds
buffer_load_dwordx4 v5, s[4:7], s3 offen offset:1024 lds
s_add_u32 m0, s84, 8192
s_add_u32 s3, s74, 32768
buffer_load_dwordx4 v5, s[4:7], s3 offen lds
buffer_load_dwordx4 v5, s[4:7], s3 offen offset:1024 lds
s_add_u32 m0, s84, 16384
s_add_u32 s3, s74, 65536
buffer_load_dwordx4 v5, s[4:7], s3 offen lds
buffer_load_dwordx4 v5, s[4:7], s3 offen offset:1024 lds
s_add_u32 m0, s84, 24576
s_add_u32 s3, s74, 98304
buffer_load_dwordx4 v5, s[4:7], s3 offen lds
buffer_load_dwordx4 v5, s[4:7], s3 offen offset:1024 lds
s_load_dword s69, s[64:65], 0
v_bfe_u32 v168, v0, 2, 2
v_and_b32 v169, 3, v0
v_and_b32 v164, 1, v0
s_lshr_b32 s70, s66, 1
s_and_b32 s71, s66, 1
s_mul_i32 s86, s66, 3072
s_add_u32 s86, s86, 73728
s_bitcmp1_b32 s67, 0
s_cbranch_scc0 L_roleA
s_mov_b64 s[8:9], s[52:53]
s_mov_b32 s10, 1409024
s_mov_b32 s11, 0x20000
s_mul_i32 s87, s68, 192
s_lshl_b32 s88, s66, 4
s_add_u32 s3, s88, s78
s_mul_i32 s3, s3, 2752
s_add_u32 s78, s3, s87
s_add_u32 s3, s88, s79
s_mul_i32 s3, s3, 2752
s_add_u32 s79, s3, s87
s_add_u32 s3, s88, s80
s_mul_i32 s3, s3, 2752
s_add_u32 s80, s3, s87
s_add_u32 s3, s88, s81
s_mul_i32 s3, s3, 2752
s_add_u32 s81, s3, s87
s_mul_i32 s87, s68, 6
v_mov_b32 v170, 0x80000000
v_add_u32 v160, 0, v2
v_mul_u32_u24 v161, 11, v160
v_lshrrev_b32 v161, 5, v161
v_mul_u32_u24 v162, 3, v161
v_sub_u32 v162, v160, v162
v_xor_b32 v163, v169, v161
v_lshrrev_b32 v163, 1, v163
v_lshl_add_u32 v163, v162, 1, v163
v_lshl_add_u32 v161, v161, 2, v168
v_mul_u32_u24 v161, 2752, v161
v_lshl_add_u32 v161, v163, 5, v161
v_lshl_add_u32 v161, v164, 4, v161
v_add_u32 v163, s87, v163
v_cmp_gt_u32 vcc, 43, v163
v_subrev_u32 v163, 1, v163
s_nop 0
v_cndmask_b32 v10, v170, v161, vcc
v_cmp_gt_u32 vcc, 43, v163
v_add_u32 v161, 1344, v161
s_nop 0
v_cndmask_b32 v7, v170, v161, vcc
v_add_u32 v160, 4, v2
v_mul_u32_u24 v161, 11, v160
v_lshrrev_b32 v161, 5, v161
v_mul_u32_u24 v162, 3, v161
v_sub_u32 v162, v160, v162
v_xor_b32 v163, v169, v161
v_lshrrev_b32_e64 v163, 1, v163
v_lshl_add_u32 v163, v162, 1, v163
v_lshl_add_u32 v161, v161, 2, v168
v_mul_u32_u24 v161, 2752, v161
v_lshl_add_u32 v161, v163, 5, v161
v_lshl_add_u32 v161, v164, 4, v161
v_add_u32 v163, s87, v163
v_cmp_gt_u32 vcc, 43, v163
v_subrev_u32 v161, 1024, v161
v_subrev_u32 v163, 1, v163
v_cndmask_b32 v11, v170, v161, vcc
v_cmp_gt_u32 vcc, 43, v163
v_add_u32 v161, 1344, v161
s_nop 0
v_cndmask_b32 v8, v170, v161, vcc
v_add_u32 v160, 8, v2
v_mul_u32_u24 v161, 11, v160
v_lshrrev_b32 v161, 5, v161
v_mul_u32_u24 v162, 3, v161
v_sub_u32 v162, v160, v162
v_xor_b32 v163, v169, v161
v_lshrrev_b32 v163, 1, v163
v_lshl_add_u32 v163, v162, 1, v163
v_lshl_add_u32 v161, v161, 2, v168
v_mul_u32_u24 v161, 2752, v161
v_lshl_add_u32 v161, v163, 5, v161
v_lshl_add_u32 v161, v164, 4, v161
v_add_u32 v163, s87, v163
v_cmp_gt_u32 vcc, 43, v163
v_subrev_u32 v161, 2048, v161
v_subrev_u32 v163, 1, v163
v_cndmask_b32 v12, v170, v161, vcc
v_cmp_gt_u32 vcc, 43, v163
v_add_u32 v161, 1344, v161
s_nop 0
v_cndmask_b32 v9, v170, v161, vcc
v_and_b32 v161, 1, v2
s_add_u32 m0, s86, 0
s_add_u32 s3, s78, 0
buffer_load_dwordx4 v7, s[8:11], s3 offen offset:0 lds
buffer_load_dwordx4 v8, s[8:11], s3 offen offset:1024 lds
buffer_load_dwordx4 v9, s[8:11], s3 offen offset:2048 lds
s_add_u32 m0, s86, 12288
s_add_u32 s3, s78, 0
buffer_load_dwordx4 v10, s[8:11], s3 offen offset:0 lds
buffer_load_dwordx4 v11, s[8:11], s3 offen offset:1024 lds
buffer_load_dwordx4 v12, s[8:11], s3 offen offset:2048 lds
v_lshlrev_b32 v4, 4, v0
v_add_u32 v160, 0, v2
v_xor_b32 v162, v160, v1
v_lshlrev_b32_e64 v162, 4, v162
v_lshl_add_u32 v220, v1, 8, v162
v_lshl_add_u32 v216, v160, 13, v162
v_add_u32 v160, 4, v2
v_xor_b32 v162, v160, v1
v_lshlrev_b32_e64 v162, 4, v162
v_lshl_add_u32 v221, v1, 8, v162
v_lshl_add_u32 v217, v160, 13, v162
v_add_u32 v160, 8, v2
v_xor_b32 v162, v160, v1
v_lshlrev_b32_e64 v162, 4, v162
v_lshl_add_u32 v222, v1, 8, v162
v_lshl_add_u32 v218, v160, 13, v162
v_add_u32 v160, 12, v2
v_xor_b32 v162, v160, v1
v_lshlrev_b32_e64 v162, 4, v162
v_lshl_add_u32 v223, v1, 8, v162
v_lshl_add_u32 v219, v160, 13, v162
v_lshrrev_b32 v160, 2, v1
v_lshlrev_b32 v160, 10, v160
s_mul_i32 s3, s70, 16448
v_add_u32 v14, v160, v220
v_xor_b32 v14, s3, v14
v_add_u32 v15, v160, v221
v_xor_b32 v15, s3, v15
v_add_u32 v16, v160, v222
v_xor_b32 v16, s3, v16
v_add_u32 v17, v160, v223
v_xor_b32 v17, s3, v17
v_lshlrev_b32_e64 v160, 6, v168
v_lshl_add_u32 v160, v169, 3, v160
v_mul_u32_u24 v162, 1536, v2
v_add_u32 v162, v162, v160
s_mul_i32 s3, s70, 6144
v_mov_b32 v170, s3
s_lshl_b32 s3, s3, 1
s_sub_u32 s88, 6144, s3
s_mul_i32 s3, s71, 3
s_add_u32 s3, s3, 0
s_and_b32 s87, s3, 1
s_lshr_b32 s3, s3, 1
s_lshl_b32 s3, s3, 8
s_add_u32 s3, s3, 73728
v_xor_b32_e64 v163, s87, v161
v_lshl_add_u32 v163, v163, 5, v162
v_add3_u32 v18, s3, v163, v170
v_add_u32 v21, 49152, v18
v_add_u32 v24, s88, v18
v_add_u32 v27, s88, v21
s_mul_i32 s3, s71, 3
s_add_u32 s3, s3, 1
s_and_b32 s87, s3, 1
s_lshr_b32 s3, s3, 1
s_lshl_b32 s3, s3, 8
s_add_u32 s3, s3, 73728
v_xor_b32 v163, s87, v161
v_lshl_add_u32 v163, v163, 5, v162
v_add3_u32 v19, s3, v163, v170
v_add_u32 v22, 49152, v19
v_add_u32 v25, s88, v19
v_add_u32 v28, s88, v22
s_mul_i32 s3, s71, 3
s_add_u32 s3, s3, 2
s_and_b32 s87, s3, 1
s_lshr_b32 s3, s3, 1
s_lshl_b32 s3, s3, 8
s_add_u32 s3, s3, 73728
v_xor_b32 v163, s87, v161
v_lshl_add_u32 v163, v163, 5, v162
v_add3_u32 v20, s3, v163, v170
v_add_u32 v23, 49152, v20
v_add_u32 v26, s88, v20
v_add_u32 v29, s88, v23
v_mov_b32 v32, 0x3f803f80
v_mov_b32 v33, 0x3f803f80
v_mov_b32 v34, 0x3f803f80
v_mov_b32 v35, 0x3f803f80
s_mov_b64 s[12:13], s[48:49]
s_mov_b32 s14, 524288
s_mov_b32 s15, 0x20000
s_mov_b64 s[20:21], s[54:55]
s_mov_b32 s22, 8388608
s_mov_b32 s23, 0x20000
s_mov_b64 s[24:25], s[56:57]
s_mov_b32 s26, 4096
s_mov_b32 s27, 0x20000
s_mov_b64 s[28:29], s[58:59]
s_mov_b32 s30, 704512
s_mov_b32 s31, 0x20000
s_mov_b64 s[36:37], s[64:65]
s_mov_b32 s38, 16777216
s_mov_b32 s39, 0x20000
s_mov_b32 s34, 2097152
s_mov_b32 s35, 0x20000
s_add_u32 s40, s64, 6291456
s_addc_u32 s41, s65, 0
s_mov_b32 s42, 2818048
s_mov_b32 s43, 0x20000
s_waitcnt lgkmcnt(0)
s_mul_i32 s69, s69, 0x0019660d
s_add_u32 s69, s69, 0x3c6ef35f
v_mov_b32 v3, s69
s_bfe_u32 s0, s2, 0x20001
s_lshr_b32 s3, s2, 5
s_lshl3_add_u32 s0, s0, s3
s_and_b32 s1, s2, 1
s_bfe_u32 s3, s2, 0x20003
s_lshl2_add_u32 s1, s1, s3
s_xor_b32 s72, s66, s3
s_lshr_b32 s3, s72, 1
s_lshl1_add_u32 s3, s0, s3
s_lshl_b32 s3, s3, 5
s_and_b32 s87, s72, 1
s_add_u32 s83, s3, s87
s_lshl_b32 s3, s83, 1
v_lshlrev_b32 v251, 2, v1
buffer_load_ushort v31, v251, s[24:27], s3 offen
s_add_u32 m0, s86, 24576
s_add_u32 s3, s78, 176128
buffer_load_dwordx4 v7, s[8:11], s3 offen offset:0 lds
buffer_load_dwordx4 v8, s[8:11], s3 offen offset:1024 lds
buffer_load_dwordx4 v9, s[8:11], s3 offen offset:2048 lds
s_add_u32 m0, s86, 36864
s_add_u32 s3, s78, 176128
buffer_load_dwordx4 v10, s[8:11], s3 offen offset:0 lds
buffer_load_dwordx4 v11, s[8:11], s3 offen offset:1024 lds
buffer_load_dwordx4 v12, s[8:11], s3 offen offset:2048 lds
s_lshl_b32 s65, s66, 12
s_xor_b32 s85, s1, 4
s_lshl_b32 s89, s85, 7
s_lshl_b32 s97, s66, 6
v_add_u32 v160, s97, v0
v_min_u32 v160, 143, v160
s_lshl_b32 s97, s82, 7
s_sub_u32 s97, s97, 16
v_add_u32 v162, s97, v160
v_max_i32 v162, 0, v162
v_lshlrev_b32 v249, 4, v162
v_add_u32 v249, 393216, v249
v_subrev_u32 v162, 16, v160
v_lshrrev_b32 v163, 5, v162
v_lshlrev_b32 v163, 8, v163
v_and_b32 v250, 1, v162
v_lshl_add_u32 v163, v250, 7, v163
v_bfe_u32 v162, v162, 1, 4
v_lshl_add_u32 v163, v162, 2, v163
v_lshrrev_b32 v162, 1, v160
v_lshl_add_u32 v162, v250, 3, v162
v_lshlrev_b32 v162, 2, v162
v_add_u32 v162, 1024, v162
v_cmp_gt_u32 vcc, 16, v160
s_nop 1
v_cndmask_b32 v250, v163, v162, vcc
v_add_u32 v250, 159744, v250
v_add_u32 v220, s65, v220
v_add_u32 v224, 81920, v220
v_subrev_u32 v217, 1024, v217
v_add_u32_e64 v221, s65, v221
v_add_u32 v225, 81920, v221
v_subrev_u32 v218, 2048, v218
v_add_u32 v222, s65, v222
v_add_u32 v226, 81920, v222
v_subrev_u32 v219, 3072, v219
v_add_u32 v223, s65, v223
v_add_u32 v227, 81920, v223
s_lshl_b32 s97, s83, 12
s_add_u32 s24, s97, s60
s_lshl2_add_u32 s97, s0, s72
s_lshl3_add_u32 s97, s97, s1
s_mul_i32 s97, s97, 3072
s_add_u32 s58, s97, 3145728
v_mov_b32 v188, -1
v_mov_b32 v189, -1
v_mov_b32 v190, -1
v_mov_b32 v191, -1
s_lshl_b32 s97, s70, 9
s_add_u32 s97, s97, 159744
v_add_u32 v251, s97, v251
v_lshl_add_u32 v252, v2, 4, s97
s_mov_b32 s94, 0xc0135761
s_mov_b32 s95, 0xbdd2d3e8
s_lshl4_add_u32 s87, s68, s82
s_lshl_b32 s97, s87, 8
s_add_u32 s93, s97, 458752
s_cmp_eq_u32 s66, 0
s_cselect_b32 s93, s93, 16777216
s_lshl2_add_u32 s97, s87, s66
s_lshl_b32 s97, s97, 7
s_add_u32 s49, s97, 13631488
s_waitcnt vmcnt(7)
s_nop 0
s_barrier
ds_read_b64_tr_b16 a[176:177], v18 offset:0
ds_read_b64_tr_b16 a[178:179], v18 offset:768
ds_read_b64_tr_b16 a[180:181], v19 offset:0
ds_read_b64_tr_b16 a[182:183], v19 offset:768
ds_read_b64_tr_b16 a[184:185], v20 offset:0
ds_read_b64_tr_b16 a[186:187], v20 offset:768
ds_read_b128 a[160:163], v14 offset:0
ds_read_b128 a[164:167], v14 offset:1024
ds_read_b128 a[168:171], v14 offset:8192
ds_read_b128 a[172:175], v14 offset:9216
ds_read_b64_tr_b16 a[188:189], v18 offset:12288
ds_read_b64_tr_b16 a[190:191], v18 offset:13056
ds_read_b64_tr_b16 a[192:193], v19 offset:12288
ds_read_b64_tr_b16 a[194:195], v19 offset:13056
ds_read_b64_tr_b16 a[196:197], v20 offset:12288
ds_read_b64_tr_b16 a[198:199], v20 offset:13056
s_waitcnt lgkmcnt(0)
v_mfma_f32_16x16x32_bf16 v[40:43], a[160:163], a[176:179], 0
s_add_u32 m0, s84, 32768
s_add_u32 s3, s75, 0
v_mfma_f32_16x16x32_bf16 v[52:55], a[164:167], a[176:179], 0
buffer_load_dwordx4 v5, s[4:7], s3 offen lds
v_mfma_f32_16x16x32_bf16 v[64:67], a[168:171], a[176:179], 0
ds_read_b64_tr_b16 a[224:225], v24 offset:0
s_lshl_b32 s97, s66, 9
s_nop 0
v_mfma_f32_16x16x32_bf16 v[76:79], a[172:175], a[176:179], 0
ds_read_b64_tr_b16 a[226:227], v24 offset:768
v_mfma_f32_16x16x32_bf16 v[136:139], v[32:35], a[176:179], 0
ds_read_b64_tr_b16 a[228:229], v25 offset:0
s_add_u32 s97, s97, 65536
v_mfma_f32_16x16x32_bf16 v[44:47], a[160:163], a[180:183], 0
buffer_load_dwordx4 v5, s[4:7], s3 offen offset:1024 lds
v_mfma_f32_16x16x32_bf16 v[56:59], a[164:167], a[180:183], 0
ds_read_b64_tr_b16 a[230:231], v25 offset:768
v_lshl_add_u32 v234, v1, 2, s97
v_mfma_f32_16x16x32_bf16 v[68:71], a[168:171], a[180:183], 0
s_add_u32 m0, s84, 40960
ds_read_b64_tr_b16 a[232:233], v26 offset:0
v_mfma_f32_16x16x32_bf16 v[80:83], a[172:175], a[180:183], 0
s_add_u32 s3, s75, 32768
v_lshl_add_u32 v235, v2, 4, s97
v_mfma_f32_16x16x32_bf16 v[140:143], v[32:35], a[180:183], 0
buffer_load_dwordx4 v5, s[4:7], s3 offen lds
v_mfma_f32_16x16x32_bf16 v[48:51], a[160:163], a[184:187], 0
ds_read_b64_tr_b16 a[234:235], v26 offset:768
v_mfma_f32_16x16x32_bf16 v[60:63], a[164:167], a[184:187], 0
ds_read_b128 a[208:211], v15 offset:0
s_lshl_b32 s97, s66, 13
v_mfma_f32_16x16x32_bf16 v[72:75], a[168:171], a[184:187], 0
ds_read_b128 a[212:215], v15 offset:1024
ds_read_b128 a[216:219], v15 offset:8192
v_mfma_f32_16x16x32_bf16 v[84:87], a[172:175], a[184:187], 0
buffer_load_dwordx4 v5, s[4:7], s3 offen offset:1024 lds
v_mfma_f32_16x16x32_bf16 v[144:147], v[32:35], a[184:187], 0
s_add_u32 m0, s84, 49152
s_add_u32 s64, s97, s89
v_mfma_f32_16x16x32_bf16 v[88:91], a[188:191], a[160:163], 0
s_add_u32 s3, s75, 65536
ds_read_b128 a[220:223], v15 offset:9216
v_mfma_f32_16x16x32_bf16 v[100:103], a[188:191], a[164:167], 0
buffer_load_dwordx4 v5, s[4:7], s3 offen lds
v_mfma_f32_16x16x32_bf16 v[112:115], a[188:191], a[168:171], 0
ds_read_b64_tr_b16 a[236:237], v24 offset:12288
v_mfma_f32_16x16x32_bf16 v[124:127], a[188:191], a[172:175], 0
ds_read_b64_tr_b16 a[238:239], v24 offset:13056
v_bfe_u32 v160, v0, 2, 1
v_mfma_f32_16x16x32_bf16 v[148:151], a[188:191], v[32:35], 0
ds_read_b64_tr_b16 a[240:241], v25 offset:12288
v_add_u32_e64 v160, s1, v160
v_mfma_f32_16x16x32_bf16 v[92:95], a[192:195], a[160:163], 0
buffer_load_dwordx4 v5, s[4:7], s3 offen offset:1024 lds
v_mfma_f32_16x16x32_bf16 v[104:107], a[192:195], a[164:167], 0
ds_read_b64_tr_b16 a[242:243], v25 offset:13056
v_mfma_f32_16x16x32_bf16 v[116:119], a[192:195], a[168:171], 0
s_add_u32 m0, s84, 57344
v_min_u32_e64 v160, 7, v160
v_mfma_f32_16x16x32_bf16 v[128:131], a[192:195], a[172:175], 0
s_add_u32 s3, s75, 98304
ds_read_b64_tr_b16 a[244:245], v26 offset:12288
v_mfma_f32_16x16x32_bf16 v[152:155], a[192:195], v[32:35], 0
buffer_load_dwordx4 v5, s[4:7], s3 offen lds
v_mfma_f32_16x16x32_bf16 v[96:99], a[196:199], a[160:163], 0
ds_read_b64_tr_b16 a[246:247], v26 offset:13056
v_lshl_add_u32 v160, v160, 4, v169
v_mfma_f32_16x16x32_bf16 v[108:111], a[196:199], a[164:167], 0
s_add_u32 s52, s60, 458752
v_mfma_f32_16x16x32_bf16 v[120:123], a[196:199], a[168:171], 0
v_lshlrev_b32 v37, 8, v160
v_lshrrev_b32 v160, 1, v2
v_mfma_f32_16x16x32_bf16 v[132:135], a[196:199], a[172:175], 0
buffer_load_dwordx4 v5, s[4:7], s3 offen offset:1024 lds
v_mfma_f32_16x16x32_bf16 v[156:159], a[196:199], v[32:35], 0
v_lshl_add_u32 v39, v160, 2, v168
s_waitcnt lgkmcnt(0)
s_waitcnt vmcnt(8)
s_barrier
v_mfma_f32_16x16x32_bf16 v[40:43], a[208:211], a[224:227], v[40:43]
s_add_u32 m0, s86, 49152
ds_read_b64_tr_b16 a[176:177], v18 offset:24576
v_mfma_f32_16x16x32_bf16 v[52:55], a[212:215], a[224:227], v[52:55]
s_add_u32 s3, s79, 0
v_lshlrev_b32_e64 v39, 10, v39
v_mfma_f32_16x16x32_bf16 v[64:67], a[216:219], a[224:227], v[64:67]
buffer_load_dwordx4 v7, s[8:11], s3 offen offset:0 lds
v_mfma_f32_16x16x32_bf16 v[76:79], a[220:223], a[224:227], v[76:79]
ds_read_b64_tr_b16 a[178:179], v18 offset:25344
v_lshl_add_u32 v39, v161, 6, v39
v_mfma_f32_16x16x32_bf16 v[44:47], a[208:211], a[228:231], v[44:47]
ds_read_b64_tr_b16 a[180:181], v19 offset:24576
ds_read_b64_tr_b16 a[182:183], v19 offset:25344
v_mfma_f32_16x16x32_bf16 v[56:59], a[212:215], a[228:231], v[56:59]
ds_read_b64_tr_b16 a[184:185], v20 offset:24576
v_mfma_f32_16x16x32_bf16 v[68:71], a[216:219], a[228:231], v[68:71]
buffer_load_dwordx4 v8, s[8:11], s3 offen offset:1024 lds
v_mfma_f32_16x16x32_bf16 v[80:83], a[220:223], a[228:231], v[80:83]
ds_read_b64_tr_b16 a[186:187], v20 offset:25344
v_lshlrev_b32_e64 v160, 1, v160
v_mfma_f32_16x16x32_bf16 v[48:51], a[208:211], a[232:235], v[48:51]
ds_read_b128 a[160:163], v16 offset:0
v_xor_b32_e64 v160, v169, v160
v_mfma_f32_16x16x32_bf16 v[60:63], a[212:215], a[232:235], v[60:63]
ds_read_b128 a[164:167], v16 offset:1024
ds_read_b128 a[168:171], v16 offset:8192
v_mfma_f32_16x16x32_bf16 v[72:75], a[216:219], a[232:235], v[72:75]
buffer_load_dwordx4 v9, s[8:11], s3 offen offset:2048 lds
v_mfma_f32_16x16x32_bf16 v[84:87], a[220:223], a[232:235], v[84:87]
ds_read_b128 a[172:175], v16 offset:9216
v_lshl_add_u32 v39, v160, 4, v39
v_mfma_f32_16x16x32_bf16 v[88:91], a[236:239], a[208:211], v[88:91]
s_add_u32 m0, s86, 61440
s_lshl_b32 s87, s82, 2
v_mfma_f32_16x16x32_bf16 v[100:103], a[236:239], a[212:215], v[100:103]
s_add_u32 s3, s79, 0
ds_read_b64_tr_b16 a[188:189], v18 offset:36864
v_mfma_f32_16x16x32_bf16 v[112:115], a[236:239], a[216:219], v[112:115]
buffer_load_dwordx4 v10, s[8:11], s3 offen offset:0 lds
v_mfma_f32_16x16x32_bf16 v[124:127], a[236:239], a[220:223], v[124:127]
ds_read_b64_tr_b16 a[190:191], v18 offset:37632
s_add_u32 s97, s87, s66
v_mfma_f32_16x16x32_bf16 v[92:95], a[240:243], a[208:211], v[92:95]
ds_read_b64_tr_b16 a[192:193], v19 offset:36864
ds_read_b64_tr_b16 a[194:195], v19 offset:37632
v_mfma_f32_16x16x32_bf16 v[104:107], a[240:243], a[212:215], v[104:107]
ds_read_b64_tr_b16 a[196:197], v20 offset:36864
v_mfma_f32_16x16x32_bf16 v[116:119], a[240:243], a[216:219], v[116:119]
buffer_load_dwordx4 v11, s[8:11], s3 offen offset:1024 lds
v_mfma_f32_16x16x32_bf16 v[128:131], a[240:243], a[220:223], v[128:131]
ds_read_b64_tr_b16 a[198:199], v20 offset:37632
s_lshl_b32 s97, s97, 12
v_mfma_f32_16x16x32_bf16 v[96:99], a[244:247], a[208:211], v[96:99]
s_add_u32 s44, s97, 65536
s_lshl_b32 s97, s68, 9
v_mfma_f32_16x16x32_bf16 v[108:111], a[244:247], a[212:215], v[108:111]
s_add_u32 s45, s97, s44
v_mfma_f32_16x16x32_bf16 v[120:123], a[244:247], a[216:219], v[120:123]
buffer_load_dwordx4 v12, s[8:11], s3 offen offset:2048 lds
v_mfma_f32_16x16x32_bf16 v[132:135], a[244:247], a[220:223], v[132:135]
s_lshl_b32 s97, s70, 1
s_add_u32 s87, s87, s97
s_waitcnt lgkmcnt(0)
v_mfma_f32_16x16x32_bf16 v[40:43], a[160:163], a[176:179], v[40:43]
s_add_u32 m0, s86, 73728
s_lshl_b32 s87, s87, 10
v_mfma_f32_16x16x32_bf16 v[52:55], a[164:167], a[176:179], v[52:55]
s_add_u32 s3, s79, 176128
ds_read_b64_tr_b16 a[224:225], v24 offset:24576
v_mfma_f32_16x16x32_bf16 v[64:67], a[168:171], a[176:179], v[64:67]
buffer_load_dwordx4 v7, s[8:11], s3 offen offset:0 lds
v_mfma_f32_16x16x32_bf16 v[76:79], a[172:175], a[176:179], v[76:79]
ds_read_b64_tr_b16 a[226:227], v24 offset:25344
v_mfma_f32_16x16x32_bf16 v[136:139], v[32:35], a[176:179], v[136:139]
ds_read_b64_tr_b16 a[228:229], v25 offset:24576
s_lshl_b32 s97, s68, 1
v_mfma_f32_16x16x32_bf16 v[44:47], a[160:163], a[180:183], v[44:47]
s_add_u32 s97, s97, s71
v_mfma_f32_16x16x32_bf16 v[56:59], a[164:167], a[180:183], v[56:59]
ds_read_b64_tr_b16 a[230:231], v25 offset:25344
v_mfma_f32_16x16x32_bf16 v[68:71], a[168:171], a[180:183], v[68:71]
buffer_load_dwordx4 v8, s[8:11], s3 offen offset:1024 lds
v_mfma_f32_16x16x32_bf16 v[80:83], a[172:175], a[180:183], v[80:83]
ds_read_b64_tr_b16 a[232:233], v26 offset:24576
s_mul_i32 s88, s97, 3
v_mfma_f32_16x16x32_bf16 v[140:143], v[32:35], a[180:183], v[140:143]
ds_read_b64_tr_b16 a[234:235], v26 offset:25344
v_mfma_f32_16x16x32_bf16 v[48:51], a[160:163], a[184:187], v[48:51]
ds_read_b128 a[208:211], v17 offset:0
s_add_u32 s97, s88, 0xffffffff
v_mfma_f32_16x16x32_bf16 v[60:63], a[164:167], a[184:187], v[60:63]
ds_read_b128 a[212:215], v17 offset:1024
v_mfma_f32_16x16x32_bf16 v[72:75], a[168:171], a[184:187], v[72:75]
buffer_load_dwordx4 v9, s[8:11], s3 offen offset:2048 lds
v_mfma_f32_16x16x32_bf16 v[84:87], a[172:175], a[184:187], v[84:87]
s_min_u32 s97, s97, 43
v_mfma_f32_16x16x32_bf16 v[144:147], v[32:35], a[184:187], v[144:147]
ds_read_b128 a[216:219], v17 offset:8192
s_lshl_b32 s97, s97, 16
v_mfma_f32_16x16x32_bf16 v[88:91], a[188:191], a[160:163], v[88:91]
s_add_u32 m0, s86, 0
ds_read_b128 a[220:223], v17 offset:9216
v_mfma_f32_16x16x32_bf16 v[100:103], a[188:191], a[164:167], v[100:103]
s_add_u32 s3, s79, 176128
v_mfma_f32_16x16x32_bf16 v[112:115], a[188:191], a[168:171], v[112:115]
buffer_load_dwordx4 v10, s[8:11], s3 offen offset:0 lds
v_mfma_f32_16x16x32_bf16 v[124:127], a[188:191], a[172:175], v[124:127]
ds_read_b64_tr_b16 a[236:237], v24 offset:36864
s_add_u32 s46, s97, s87
v_mfma_f32_16x16x32_bf16 v[148:151], a[188:191], v[32:35], v[148:151]
ds_read_b64_tr_b16 a[238:239], v24 offset:37632
v_mfma_f32_16x16x32_bf16 v[92:95], a[192:195], a[160:163], v[92:95]
ds_read_b64_tr_b16 a[240:241], v25 offset:36864
s_add_u32 s97, s88, 0x00000000
v_mfma_f32_16x16x32_bf16 v[104:107], a[192:195], a[164:167], v[104:107]
s_min_u32 s97, s97, 43
v_mfma_f32_16x16x32_bf16 v[116:119], a[192:195], a[168:171], v[116:119]
buffer_load_dwordx4 v11, s[8:11], s3 offen offset:1024 lds
v_mfma_f32_16x16x32_bf16 v[128:131], a[192:195], a[172:175], v[128:131]
ds_read_b64_tr_b16 a[242:243], v25 offset:37632
v_mfma_f32_16x16x32_bf16 v[152:155], a[192:195], v[32:35], v[152:155]
ds_read_b64_tr_b16 a[244:245], v26 offset:36864
s_lshl_b32 s97, s97, 16
v_mfma_f32_16x16x32_bf16 v[96:99], a[196:199], a[160:163], v[96:99]
ds_read_b64_tr_b16 a[246:247], v26 offset:37632
v_mfma_f32_16x16x32_bf16 v[108:111], a[196:199], a[164:167], v[108:111]
s_add_u32 s47, s97, s87
v_mfma_f32_16x16x32_bf16 v[120:123], a[196:199], a[168:171], v[120:123]
buffer_load_dwordx4 v12, s[8:11], s3 offen offset:2048 lds
v_mfma_f32_16x16x32_bf16 v[132:135], a[196:199], a[172:175], v[132:135]
s_add_u32 s97, s88, 0x00000001
v_mfma_f32_16x16x32_bf16 v[156:159], a[196:199], v[32:35], v[156:159]
s_min_u32 s97, s97, 43
s_waitcnt lgkmcnt(0)
s_waitcnt vmcnt(6)
s_barrier
v_mfma_f32_16x16x32_bf16 v[40:43], a[208:211], a[224:227], v[40:43]
s_add_u32 m0, s84, 0
s_add_u32 s3, s76, 0
v_mfma_f32_16x16x32_bf16 v[52:55], a[212:215], a[224:227], v[52:55]
buffer_load_dwordx4 v5, s[4:7], s3 offen lds
v_mfma_f32_16x16x32_bf16 v[64:67], a[216:219], a[224:227], v[64:67]
ds_read_b64_tr_b16 a[176:177], v21 offset:0
ds_read_b64_tr_b16 a[178:179], v21 offset:768
v_mfma_f32_16x16x32_bf16 v[76:79], a[220:223], a[224:227], v[76:79]
ds_read_b64_tr_b16 a[180:181], v22 offset:0
ds_read_b64_tr_b16 a[182:183], v22 offset:768
v_mfma_f32_16x16x32_bf16 v[44:47], a[208:211], a[228:231], v[44:47]
buffer_load_dwordx4 v5, s[4:7], s3 offen offset:1024 lds
v_mfma_f32_16x16x32_bf16 v[56:59], a[212:215], a[228:231], v[56:59]
s_add_u32 m0, s84, 8192
s_lshl_b32 s97, s97, 16
v_mfma_f32_16x16x32_bf16 v[68:71], a[216:219], a[228:231], v[68:71]
s_add_u32 s3, s76, 32768
ds_read_b64_tr_b16 a[184:185], v23 offset:0
v_mfma_f32_16x16x32_bf16 v[80:83], a[220:223], a[228:231], v[80:83]
buffer_load_dwordx4 v5, s[4:7], s3 offen lds
v_mfma_f32_16x16x32_bf16 v[48:51], a[208:211], a[232:235], v[48:51]
ds_read_b64_tr_b16 a[186:187], v23 offset:768
ds_read_b128 a[160:163], v14 offset:32768
v_mfma_f32_16x16x32_bf16 v[60:63], a[212:215], a[232:235], v[60:63]
ds_read_b128 a[164:167], v14 offset:33792
ds_read_b128 a[168:171], v14 offset:40960
v_mfma_f32_16x16x32_bf16 v[72:75], a[216:219], a[232:235], v[72:75]
buffer_load_dwordx4 v5, s[4:7], s3 offen offset:1024 lds
v_mfma_f32_16x16x32_bf16 v[84:87], a[220:223], a[232:235], v[84:87]
s_add_u32 m0, s84, 16384
ds_read_b128 a[172:175], v14 offset:41984
v_mfma_f32_16x16x32_bf16 v[88:91], a[236:239], a[208:211], v[88:91]
s_add_u32 s3, s76, 65536
ds_read_b64_tr_b16 a[188:189], v21 offset:12288
v_mfma_f32_16x16x32_bf16 v[100:103], a[236:239], a[212:215], v[100:103]
buffer_load_dwordx4 v5, s[4:7], s3 offen lds
v_mfma_f32_16x16x32_bf16 v[112:115], a[236:239], a[216:219], v[112:115]
ds_read_b64_tr_b16 a[190:191], v21 offset:13056
v_mfma_f32_16x16x32_bf16 v[124:127], a[236:239], a[220:223], v[124:127]
ds_read_b64_tr_b16 a[192:193], v22 offset:12288
ds_read_b64_tr_b16 a[194:195], v22 offset:13056
v_mfma_f32_16x16x32_bf16 v[92:95], a[240:243], a[208:211], v[92:95]
buffer_load_dwordx4 v5, s[4:7], s3 offen offset:1024 lds
v_mfma_f32_16x16x32_bf16 v[104:107], a[240:243], a[212:215], v[104:107]
s_add_u32 m0, s84, 24576
ds_read_b64_tr_b16 a[196:197], v23 offset:12288
v_mfma_f32_16x16x32_bf16 v[116:119], a[240:243], a[216:219], v[116:119]
s_add_u32 s3, s76, 98304
ds_read_b64_tr_b16 a[198:199], v23 offset:13056
v_mfma_f32_16x16x32_bf16 v[128:131], a[240:243], a[220:223], v[128:131]
buffer_load_dwordx4 v5, s[4:7], s3 offen lds
v_mfma_f32_16x16x32_bf16 v[96:99], a[244:247], a[208:211], v[96:99]
s_add_u32 s48, s97, s87
s_lshl_b32 s97, s82, 1
v_mfma_f32_16x16x32_bf16 v[108:111], a[244:247], a[212:215], v[108:111]
s_add_u32 s97, s97, s70
v_mfma_f32_16x16x32_bf16 v[120:123], a[244:247], a[216:219], v[120:123]
buffer_load_dwordx4 v5, s[4:7], s3 offen offset:1024 lds
v_mfma_f32_16x16x32_bf16 v[132:135], a[244:247], a[220:223], v[132:135]
s_lshl_b32 s97, s97, 4
s_waitcnt lgkmcnt(0)
v_mfma_f32_16x16x32_bf16 v[40:43], a[160:163], a[176:179], v[40:43]
s_add_u32 m0, s86, 12288
s_add_u32 s97, s97, s68
v_mfma_f32_16x16x32_bf16 v[52:55], a[164:167], a[176:179], v[52:55]
s_add_u32 s3, s80, 0
s_nop 0
ds_read_b64_tr_b16 a[224:225], v27 offset:0
v_mfma_f32_16x16x32_bf16 v[64:67], a[168:171], a[176:179], v[64:67]
buffer_load_dwordx4 v7, s[8:11], s3 offen offset:0 lds
v_mfma_f32_16x16x32_bf16 v[76:79], a[172:175], a[176:179], v[76:79]
ds_read_b64_tr_b16 a[226:227], v27 offset:768
v_mfma_f32_16x16x32_bf16 v[136:139], v[32:35], a[176:179], v[136:139]
ds_read_b64_tr_b16 a[228:229], v28 offset:0
s_mul_i32 s97, s97, 6144
v_mfma_f32_16x16x32_bf16 v[44:47], a[160:163], a[180:183], v[44:47]
s_mul_i32 s87, s71, 3072
v_mfma_f32_16x16x32_bf16 v[56:59], a[164:167], a[180:183], v[56:59]
ds_read_b64_tr_b16 a[230:231], v28 offset:768
v_mfma_f32_16x16x32_bf16 v[68:71], a[168:171], a[180:183], v[68:71]
buffer_load_dwordx4 v8, s[8:11], s3 offen offset:1024 lds
v_mfma_f32_16x16x32_bf16 v[80:83], a[172:175], a[180:183], v[80:83]
ds_read_b64_tr_b16 a[232:233], v29 offset:0
s_add_u32 s97, s97, s87
v_mfma_f32_16x16x32_bf16 v[140:143], v[32:35], a[180:183], v[140:143]
ds_read_b64_tr_b16 a[234:235], v29 offset:768
v_mfma_f32_16x16x32_bf16 v[48:51], a[160:163], a[184:187], v[48:51]
ds_read_b128 a[208:211], v15 offset:32768
s_add_u32 s16, s97, 10485760
v_mfma_f32_16x16x32_bf16 v[60:63], a[164:167], a[184:187], v[60:63]
ds_read_b128 a[212:215], v15 offset:33792
v_mfma_f32_16x16x32_bf16 v[72:75], a[168:171], a[184:187], v[72:75]
buffer_load_dwordx4 v9, s[8:11], s3 offen offset:2048 lds
v_mfma_f32_16x16x32_bf16 v[84:87], a[172:175], a[184:187], v[84:87]
v_lshrrev_b32 v160, 2, v0
v_mfma_f32_16x16x32_bf16 v[144:147], v[32:35], a[184:187], v[144:147]
ds_read_b128 a[216:219], v15 offset:40960
v_lshl_add_u32 v160, v160, 1, v164
v_mfma_f32_16x16x32_bf16 v[88:91], a[188:191], a[160:163], v[88:91]
s_add_u32 m0, s86, 24576
ds_read_b128 a[220:223], v15 offset:41984
v_mfma_f32_16x16x32_bf16 v[100:103], a[188:191], a[164:167], v[100:103]
s_add_u32 s3, s80, 0
v_mfma_f32_16x16x32_bf16 v[112:115], a[188:191], a[168:171], v[112:115]
buffer_load_dwordx4 v10, s[8:11], s3 offen offset:0 lds
v_mfma_f32_16x16x32_bf16 v[124:127], a[188:191], a[172:175], v[124:127]
ds_read_b64_tr_b16 a[236:237], v27 offset:12288
v_lshlrev_b32 v228, 4, v160
v_mfma_f32_16x16x32_bf16 v[148:151], a[188:191], v[32:35], v[148:151]
ds_read_b64_tr_b16 a[238:239], v27 offset:13056
v_mfma_f32_16x16x32_bf16 v[92:95], a[192:195], a[160:163], v[92:95]
ds_read_b64_tr_b16 a[240:241], v28 offset:12288
s_lshl_b32 s97, s66, 8
s_nop 0
v_mfma_f32_16x16x32_bf16 v[104:107], a[192:195], a[164:167], v[104:107]
s_add_u32 s97, s97, 161024
v_mfma_f32_16x16x32_bf16 v[116:119], a[192:195], a[168:171], v[116:119]
buffer_load_dwordx4 v11, s[8:11], s3 offen offset:1024 lds
v_mfma_f32_16x16x32_bf16 v[128:131], a[192:195], a[172:175], v[128:131]
ds_read_b64_tr_b16 a[242:243], v28 offset:13056
v_mfma_f32_16x16x32_bf16 v[152:155], a[192:195], v[32:35], v[152:155]
ds_read_b64_tr_b16 a[244:245], v29 offset:12288
v_bfe_u32 v160, v0, 1, 4
v_mfma_f32_16x16x32_bf16 v[96:99], a[196:199], a[160:163], v[96:99]
ds_read_b64_tr_b16 a[246:247], v29 offset:13056
v_mfma_f32_16x16x32_bf16 v[108:111], a[196:199], a[164:167], v[108:111]
v_lshl_add_u32 v160, v164, 4, v160
v_mfma_f32_16x16x32_bf16 v[120:123], a[196:199], a[168:171], v[120:123]
buffer_load_dwordx4 v12, s[8:11], s3 offen offset:2048 lds
v_mfma_f32_16x16x32_bf16 v[132:135], a[196:199], a[172:175], v[132:135]
v_lshl_add_u32 v229, v160, 2, s97
v_mfma_f32_16x16x32_bf16 v[156:159], a[196:199], v[32:35], v[156:159]
s_lshl_b32 s97, s70, 9
s_waitcnt lgkmcnt(0)
s_waitcnt vmcnt(14)
s_barrier
v_mfma_f32_16x16x32_bf16 v[40:43], a[208:211], a[224:227], v[40:43]
s_add_u32 m0, s86, 36864
ds_read_b64_tr_b16 a[176:177], v21 offset:24576
v_mfma_f32_16x16x32_bf16 v[52:55], a[212:215], a[224:227], v[52:55]
s_add_u32 s3, s80, 176128
s_add_u32 s97, s97, 161024
v_mfma_f32_16x16x32_bf16 v[64:67], a[216:219], a[224:227], v[64:67]
buffer_load_dwordx4 v7, s[8:11], s3 offen offset:0 lds
v_mfma_f32_16x16x32_bf16 v[76:79], a[220:223], a[224:227], v[76:79]
ds_read_b64_tr_b16 a[178:179], v21 offset:25344
v_mfma_f32_16x16x32_bf16 v[44:47], a[208:211], a[228:231], v[44:47]
ds_read_b64_tr_b16 a[180:181], v22 offset:24576
ds_read_b64_tr_b16 a[182:183], v22 offset:25344
v_mfma_f32_16x16x32_bf16 v[56:59], a[212:215], a[228:231], v[56:59]
ds_read_b64_tr_b16 a[184:185], v23 offset:24576
v_lshl_add_u32 v230, v2, 4, s97
v_mfma_f32_16x16x32_bf16 v[68:71], a[216:219], a[228:231], v[68:71]
buffer_load_dwordx4 v8, s[8:11], s3 offen offset:1024 lds
v_mfma_f32_16x16x32_bf16 v[80:83], a[220:223], a[228:231], v[80:83]
ds_read_b64_tr_b16 a[186:187], v23 offset:25344
v_mfma_f32_16x16x32_bf16 v[48:51], a[208:211], a[232:235], v[48:51]
ds_read_b128 a[160:163], v16 offset:32768
s_add_u32 s97, s60, 73728
v_mfma_f32_16x16x32_bf16 v[60:63], a[212:215], a[232:235], v[60:63]
ds_read_b128 a[164:167], v16 offset:33792
ds_read_b128 a[168:171], v16 offset:40960
v_mfma_f32_16x16x32_bf16 v[72:75], a[216:219], a[232:235], v[72:75]
buffer_load_dwordx4 v9, s[8:11], s3 offen offset:2048 lds
v_mfma_f32_16x16x32_bf16 v[84:87], a[220:223], a[232:235], v[84:87]
ds_read_b128 a[172:175], v16 offset:41984
v_mfma_f32_16x16x32_bf16 v[88:91], a[236:239], a[208:211], v[88:91]
s_add_u32 m0, s86, 49152
v_lshl_add_u32 v231, v0, 2, s97
v_mfma_f32_16x16x32_bf16 v[100:103], a[236:239], a[212:215], v[100:103]
s_add_u32 s3, s80, 176128
ds_read_b64_tr_b16 a[188:189], v18 offset:0
v_mfma_f32_16x16x32_bf16 v[112:115], a[236:239], a[216:219], v[112:115]
buffer_load_dwordx4 v10, s[8:11], s3 offen offset:0 lds
v_mfma_f32_16x16x32_bf16 v[124:127], a[236:239], a[220:223], v[124:127]
ds_read_b64_tr_b16 a[190:191], v18 offset:768
s_lshl_b32 s97, s71, 9
v_mfma_f32_16x16x32_bf16 v[92:95], a[240:243], a[208:211], v[92:95]
ds_read_b64_tr_b16 a[192:193], v19 offset:0
ds_read_b64_tr_b16 a[194:195], v19 offset:768
v_mfma_f32_16x16x32_bf16 v[104:107], a[240:243], a[212:215], v[104:107]
ds_read_b64_tr_b16 a[196:197], v20 offset:0
v_mfma_f32_16x16x32_bf16 v[116:119], a[240:243], a[216:219], v[116:119]
buffer_load_dwordx4 v11, s[8:11], s3 offen offset:1024 lds
v_mfma_f32_16x16x32_bf16 v[128:131], a[240:243], a[220:223], v[128:131]
ds_read_b64_tr_b16 a[198:199], v20 offset:768
v_add_u32 v232, s97, v231
v_mfma_f32_16x16x32_bf16 v[96:99], a[244:247], a[208:211], v[96:99]
v_xor_b32 v233, 1024, v232
v_mfma_f32_16x16x32_bf16 v[108:111], a[244:247], a[212:215], v[108:111]
s_mov_b32 s90, 0xaaaaaaaa
v_mfma_f32_16x16x32_bf16 v[120:123], a[244:247], a[216:219], v[120:123]
buffer_load_dwordx4 v12, s[8:11], s3 offen offset:2048 lds
v_mfma_f32_16x16x32_bf16 v[132:135], a[244:247], a[220:223], v[132:135]
s_mov_b32 s91, 0xaaaaaaaa
s_nop 0
s_waitcnt lgkmcnt(0)
v_mfma_f32_16x16x32_bf16 v[40:43], a[160:163], a[176:179], v[40:43]
ds_read_b64_tr_b16 a[224:225], v27 offset:24576
v_mfma_f32_16x16x32_bf16 v[52:55], a[164:167], a[176:179], v[52:55]
v_mfma_f32_16x16x32_bf16 v[64:67], a[168:171], a[176:179], v[64:67]
ds_read_b64_tr_b16 a[226:227], v27 offset:25344
v_mfma_f32_16x16x32_bf16 v[76:79], a[172:175], a[176:179], v[76:79]
v_mfma_f32_16x16x32_bf16 v[136:139], v[32:35], a[176:179], v[136:139]
ds_read_b64_tr_b16 a[228:229], v28 offset:24576
v_mfma_f32_16x16x32_bf16 v[44:47], a[160:163], a[180:183], v[44:47]
ds_read_b64_tr_b16 a[230:231], v28 offset:25344
v_mfma_f32_16x16x32_bf16 v[56:59], a[164:167], a[180:183], v[56:59]
v_mfma_f32_16x16x32_bf16 v[68:71], a[168:171], a[180:183], v[68:71]
ds_read_b64_tr_b16 a[232:233], v29 offset:24576
v_mfma_f32_16x16x32_bf16 v[80:83], a[172:175], a[180:183], v[80:83]
ds_read_b64_tr_b16 a[234:235], v29 offset:25344
v_mfma_f32_16x16x32_bf16 v[140:143], v[32:35], a[180:183], v[140:143]
v_mfma_f32_16x16x32_bf16 v[48:51], a[160:163], a[184:187], v[48:51]
ds_read_b128 a[208:211], v17 offset:32768
v_mfma_f32_16x16x32_bf16 v[60:63], a[164:167], a[184:187], v[60:63]
v_mfma_f32_16x16x32_bf16 v[72:75], a[168:171], a[184:187], v[72:75]
ds_read_b128 a[212:215], v17 offset:33792
v_mfma_f32_16x16x32_bf16 v[84:87], a[172:175], a[184:187], v[84:87]
ds_read_b128 a[216:219], v17 offset:40960
v_mfma_f32_16x16x32_bf16 v[144:147], v[32:35], a[184:187], v[144:147]
v_mfma_f32_16x16x32_bf16 v[88:91], a[188:191], a[160:163], v[88:91]
ds_read_b128 a[220:223], v17 offset:41984
v_mfma_f32_16x16x32_bf16 v[100:103], a[188:191], a[164:167], v[100:103]
v_mfma_f32_16x16x32_bf16 v[112:115], a[188:191], a[168:171], v[112:115]
ds_read_b64_tr_b16 a[236:237], v24 offset:0
v_mfma_f32_16x16x32_bf16 v[124:127], a[188:191], a[172:175], v[124:127]
ds_read_b64_tr_b16 a[238:239], v24 offset:768
v_mfma_f32_16x16x32_bf16 v[148:151], a[188:191], v[32:35], v[148:151]
v_mfma_f32_16x16x32_bf16 v[92:95], a[192:195], a[160:163], v[92:95]
ds_read_b64_tr_b16 a[240:241], v25 offset:0
v_mfma_f32_16x16x32_bf16 v[104:107], a[192:195], a[164:167], v[104:107]
ds_read_b64_tr_b16 a[242:243], v25 offset:768
v_mfma_f32_16x16x32_bf16 v[116:119], a[192:195], a[168:171], v[116:119]
v_mfma_f32_16x16x32_bf16 v[128:131], a[192:195], a[172:175], v[128:131]
ds_read_b64_tr_b16 a[244:245], v26 offset:0
v_mfma_f32_16x16x32_bf16 v[152:155], a[192:195], v[32:35], v[152:155]
v_mfma_f32_16x16x32_bf16 v[96:99], a[196:199], a[160:163], v[96:99]
ds_read_b64_tr_b16 a[246:247], v26 offset:768
v_mfma_f32_16x16x32_bf16 v[108:111], a[196:199], a[164:167], v[108:111]
v_mfma_f32_16x16x32_bf16 v[120:123], a[196:199], a[168:171], v[120:123]
v_mfma_f32_16x16x32_bf16 v[132:135], a[196:199], a[172:175], v[132:135]
v_mfma_f32_16x16x32_bf16 v[156:159], a[196:199], v[32:35], v[156:159]
s_waitcnt lgkmcnt(0)
s_waitcnt vmcnt(6)
s_barrier
v_mfma_f32_16x16x32_bf16 v[40:43], a[208:211], a[224:227], v[40:43]
ds_read_b64_tr_b16 a[176:177], v18 offset:12288
v_mfma_f32_16x16x32_bf16 v[52:55], a[212:215], a[224:227], v[52:55]
buffer_load_dwordx4 v[180:183], v249, s[36:39], 0 offen sc1
v_mfma_f32_16x16x32_bf16 v[64:67], a[216:219], a[224:227], v[64:67]
ds_read_b64_tr_b16 a[178:179], v18 offset:13056
ds_read_b64_tr_b16 a[180:181], v19 offset:12288
v_mfma_f32_16x16x32_bf16 v[76:79], a[220:223], a[224:227], v[76:79]
s_add_u32 m0, s84, 32768
ds_read_b64_tr_b16 a[182:183], v19 offset:13056
v_mfma_f32_16x16x32_bf16 v[44:47], a[208:211], a[228:231], v[44:47]
s_add_u32 s3, s77, 0
v_mfma_f32_16x16x32_bf16 v[56:59], a[212:215], a[228:231], v[56:59]
buffer_load_dwordx4 v5, s[4:7], s3 offen lds
v_mfma_f32_16x16x32_bf16 v[68:71], a[216:219], a[228:231], v[68:71]
ds_read_b64_tr_b16 a[184:185], v20 offset:12288
ds_read_b64_tr_b16 a[186:187], v20 offset:13056
v_mfma_f32_16x16x32_bf16 v[80:83], a[220:223], a[228:231], v[80:83]
ds_read_b128 a[160:163], v14 offset:0
v_mfma_f32_16x16x32_bf16 v[48:51], a[208:211], a[232:235], v[48:51]
buffer_load_dwordx4 v5, s[4:7], s3 offen offset:1024 lds
v_mfma_f32_16x16x32_bf16 v[60:63], a[212:215], a[232:235], v[60:63]
ds_read_b128 a[164:167], v14 offset:1024
ds_read_b128 a[168:171], v14 offset:8192
v_mfma_f32_16x16x32_bf16 v[72:75], a[216:219], a[232:235], v[72:75]
s_add_u32 m0, s84, 40960
v_mfma_f32_16x16x32_bf16 v[84:87], a[220:223], a[232:235], v[84:87]
s_add_u32 s3, s77, 32768
ds_read_b128 a[172:175], v14 offset:9216
v_mfma_f32_16x16x32_bf16 v[88:91], a[236:239], a[208:211], v[88:91]
buffer_load_dwordx4 v5, s[4:7], s3 offen lds
v_mfma_f32_16x16x32_bf16 v[100:103], a[236:239], a[212:215], v[100:103]
ds_read_b64_tr_b16 a[188:189], v18 offset:24576
ds_read_b64_tr_b16 a[190:191], v18 offset:25344
v_mfma_f32_16x16x32_bf16 v[112:115], a[236:239], a[216:219], v[112:115]
ds_read_b64_tr_b16 a[192:193], v19 offset:24576
v_mfma_f32_16x16x32_bf16 v[124:127], a[236:239], a[220:223], v[124:127]
buffer_load_dwordx4 v5, s[4:7], s3 offen offset:1024 lds
v_mfma_f32_16x16x32_bf16 v[92:95], a[240:243], a[208:211], v[92:95]
s_add_u32 m0, s84, 49152
ds_read_b64_tr_b16 a[194:195], v19 offset:25344
v_mfma_f32_16x16x32_bf16 v[104:107], a[240:243], a[212:215], v[104:107]
s_add_u32 s3, s77, 65536
ds_read_b64_tr_b16 a[196:197], v20 offset:24576
v_mfma_f32_16x16x32_bf16 v[116:119], a[240:243], a[216:219], v[116:119]
buffer_load_dwordx4 v5, s[4:7], s3 offen lds
v_mfma_f32_16x16x32_bf16 v[128:131], a[240:243], a[220:223], v[128:131]
ds_read_b64_tr_b16 a[198:199], v20 offset:25344
v_mfma_f32_16x16x32_bf16 v[96:99], a[244:247], a[208:211], v[96:99]
v_mfma_f32_16x16x32_bf16 v[108:111], a[244:247], a[212:215], v[108:111]
v_mfma_f32_16x16x32_bf16 v[120:123], a[244:247], a[216:219], v[120:123]
buffer_load_dwordx4 v5, s[4:7], s3 offen offset:1024 lds
v_mfma_f32_16x16x32_bf16 v[132:135], a[244:247], a[220:223], v[132:135]
s_nop 0
s_waitcnt lgkmcnt(0)
v_mfma_f32_16x16x32_bf16 v[40:43], a[160:163], a[176:179], v[40:43]
s_add_u32 m0, s84, 57344
s_add_u32 s3, s77, 98304
v_mfma_f32_16x16x32_bf16 v[52:55], a[164:167], a[176:179], v[52:55]
buffer_load_dwordx4 v5, s[4:7], s3 offen lds
v_mfma_f32_16x16x32_bf16 v[64:67], a[168:171], a[176:179], v[64:67]
ds_read_b64_tr_b16 a[224:225], v24 offset:12288
v_mfma_f32_16x16x32_bf16 v[76:79], a[172:175], a[176:179], v[76:79]
ds_read_b64_tr_b16 a[226:227], v24 offset:13056
v_mfma_f32_16x16x32_bf16 v[136:139], v[32:35], a[176:179], v[136:139]
ds_read_b64_tr_b16 a[228:229], v25 offset:12288
v_mfma_f32_16x16x32_bf16 v[44:47], a[160:163], a[180:183], v[44:47]
buffer_load_dwordx4 v5, s[4:7], s3 offen offset:1024 lds
v_mfma_f32_16x16x32_bf16 v[56:59], a[164:167], a[180:183], v[56:59]
ds_read_b64_tr_b16 a[230:231], v25 offset:13056
v_mfma_f32_16x16x32_bf16 v[68:71], a[168:171], a[180:183], v[68:71]
s_add_u32 m0, s86, 61440
ds_read_b64_tr_b16 a[232:233], v26 offset:12288
v_mfma_f32_16x16x32_bf16 v[80:83], a[172:175], a[180:183], v[80:83]
s_add_u32 s3, s81, 0
s_nop 0
v_mfma_f32_16x16x32_bf16 v[140:143], v[32:35], a[180:183], v[140:143]
buffer_load_dwordx4 v7, s[8:11], s3 offen offset:0 lds
v_mfma_f32_16x16x32_bf16 v[48:51], a[160:163], a[184:187], v[48:51]
ds_read_b64_tr_b16 a[234:235], v26 offset:13056
v_mfma_f32_16x16x32_bf16 v[60:63], a[164:167], a[184:187], v[60:63]
ds_read_b128 a[208:211], v15 offset:0
v_mfma_f32_16x16x32_bf16 v[72:75], a[168:171], a[184:187], v[72:75]
ds_read_b128 a[212:215], v15 offset:1024
v_mfma_f32_16x16x32_bf16 v[84:87], a[172:175], a[184:187], v[84:87]
buffer_load_dwordx4 v8, s[8:11], s3 offen offset:1024 lds
v_mfma_f32_16x16x32_bf16 v[144:147], v[32:35], a[184:187], v[144:147]
ds_read_b128 a[216:219], v15 offset:8192
v_mfma_f32_16x16x32_bf16 v[88:91], a[188:191], a[160:163], v[88:91]
ds_read_b128 a[220:223], v15 offset:9216
v_mfma_f32_16x16x32_bf16 v[100:103], a[188:191], a[164:167], v[100:103]
buffer_load_dwordx4 v9, s[8:11], s3 offen offset:2048 lds
v_mfma_f32_16x16x32_bf16 v[112:115], a[188:191], a[168:171], v[112:115]
ds_read_b64_tr_b16 a[236:237], v24 offset:24576
v_mfma_f32_16x16x32_bf16 v[124:127], a[188:191], a[172:175], v[124:127]
s_add_u32 m0, s86, 73728
ds_read_b64_tr_b16 a[238:239], v24 offset:25344
v_mfma_f32_16x16x32_bf16 v[148:151], a[188:191], v[32:35], v[148:151]
s_add_u32 s3, s81, 0
s_nop 0
v_mfma_f32_16x16x32_bf16 v[92:95], a[192:195], a[160:163], v[92:95]
buffer_load_dwordx4 v10, s[8:11], s3 offen offset:0 lds
v_mfma_f32_16x16x32_bf16 v[104:107], a[192:195], a[164:167], v[104:107]
ds_read_b64_tr_b16 a[240:241], v25 offset:24576
v_mfma_f32_16x16x32_bf16 v[116:119], a[192:195], a[168:171], v[116:119]
ds_read_b64_tr_b16 a[242:243], v25 offset:25344
v_mfma_f32_16x16x32_bf16 v[128:131], a[192:195], a[172:175], v[128:131]
ds_read_b64_tr_b16 a[244:245], v26 offset:24576
v_mfma_f32_16x16x32_bf16 v[152:155], a[192:195], v[32:35], v[152:155]
buffer_load_dwordx4 v11, s[8:11], s3 offen offset:1024 lds
v_mfma_f32_16x16x32_bf16 v[96:99], a[196:199], a[160:163], v[96:99]
ds_read_b64_tr_b16 a[246:247], v26 offset:25344
v_mfma_f32_16x16x32_bf16 v[108:111], a[196:199], a[164:167], v[108:111]
v_mfma_f32_16x16x32_bf16 v[120:123], a[196:199], a[168:171], v[120:123]
v_mfma_f32_16x16x32_bf16 v[132:135], a[196:199], a[172:175], v[132:135]
buffer_load_dwordx4 v12, s[8:11], s3 offen offset:2048 lds
v_mfma_f32_16x16x32_bf16 v[156:159], a[196:199], v[32:35], v[156:159]
s_waitcnt lgkmcnt(0)
s_waitcnt vmcnt(15)
s_barrier
v_mfma_f32_16x16x32_bf16 v[40:43], a[208:211], a[224:227], v[40:43]
s_add_u32 m0, s86, 0
ds_read_b64_tr_b16 a[176:177], v18 offset:36864
v_mfma_f32_16x16x32_bf16 v[52:55], a[212:215], a[224:227], v[52:55]
s_add_u32 s3, s81, 176128
v_mfma_f32_16x16x32_bf16 v[64:67], a[216:219], a[224:227], v[64:67]
buffer_load_dwordx4 v7, s[8:11], s3 offen offset:0 lds
v_mfma_f32_16x16x32_bf16 v[76:79], a[220:223], a[224:227], v[76:79]
ds_read_b64_tr_b16 a[178:179], v18 offset:37632
v_mfma_f32_16x16x32_bf16 v[44:47], a[208:211], a[228:231], v[44:47]
ds_read_b64_tr_b16 a[180:181], v19 offset:36864
ds_read_b64_tr_b16 a[182:183], v19 offset:37632
v_mfma_f32_16x16x32_bf16 v[56:59], a[212:215], a[228:231], v[56:59]
ds_read_b64_tr_b16 a[184:185], v20 offset:36864
v_mfma_f32_16x16x32_bf16 v[68:71], a[216:219], a[228:231], v[68:71]
buffer_load_dwordx4 v8, s[8:11], s3 offen offset:1024 lds
v_mfma_f32_16x16x32_bf16 v[80:83], a[220:223], a[228:231], v[80:83]
ds_read_b64_tr_b16 a[186:187], v20 offset:37632
v_mfma_f32_16x16x32_bf16 v[48:51], a[208:211], a[232:235], v[48:51]
ds_read_b128 a[160:163], v16 offset:0
v_mfma_f32_16x16x32_bf16 v[60:63], a[212:215], a[232:235], v[60:63]
ds_read_b128 a[164:167], v16 offset:1024
ds_read_b128 a[168:171], v16 offset:8192
v_mfma_f32_16x16x32_bf16 v[72:75], a[216:219], a[232:235], v[72:75]
buffer_load_dwordx4 v9, s[8:11], s3 offen offset:2048 lds
v_mfma_f32_16x16x32_bf16 v[84:87], a[220:223], a[232:235], v[84:87]
ds_read_b128 a[172:175], v16 offset:9216
v_mfma_f32_16x16x32_bf16 v[88:91], a[236:239], a[208:211], v[88:91]
s_add_u32 m0, s86, 12288
v_mfma_f32_16x16x32_bf16 v[100:103], a[236:239], a[212:215], v[100:103]
s_add_u32 s3, s81, 176128
ds_read_b64_tr_b16 a[188:189], v21 offset:0
v_mfma_f32_16x16x32_bf16 v[112:115], a[236:239], a[216:219], v[112:115]
buffer_load_dwordx4 v10, s[8:11], s3 offen offset:0 lds
v_mfma_f32_16x16x32_bf16 v[124:127], a[236:239], a[220:223], v[124:127]
ds_read_b64_tr_b16 a[190:191], v21 offset:768
v_mfma_f32_16x16x32_bf16 v[92:95], a[240:243], a[208:211], v[92:95]
ds_read_b64_tr_b16 a[192:193], v22 offset:0
ds_read_b64_tr_b16 a[194:195], v22 offset:768
v_mfma_f32_16x16x32_bf16 v[104:107], a[240:243], a[212:215], v[104:107]
ds_read_b64_tr_b16 a[196:197], v23 offset:0
v_mfma_f32_16x16x32_bf16 v[116:119], a[240:243], a[216:219], v[116:119]
buffer_load_dwordx4 v11, s[8:11], s3 offen offset:1024 lds
v_mfma_f32_16x16x32_bf16 v[128:131], a[240:243], a[220:223], v[128:131]
ds_read_b64_tr_b16 a[198:199], v23 offset:768
v_mfma_f32_16x16x32_bf16 v[96:99], a[244:247], a[208:211], v[96:99]
v_mfma_f32_16x16x32_bf16 v[108:111], a[244:247], a[212:215], v[108:111]
v_mfma_f32_16x16x32_bf16 v[120:123], a[244:247], a[216:219], v[120:123]
buffer_load_dwordx4 v12, s[8:11], s3 offen offset:2048 lds
v_mfma_f32_16x16x32_bf16 v[132:135], a[244:247], a[220:223], v[132:135]
s_waitcnt lgkmcnt(0)
s_waitcnt vmcnt(20)
v_xor_b32 v184, s69, v181
v_bitop3_b32 v184, v184, v183, s69 bitop3:0xf6
v_cmp_ne_u32 vcc, 0, v184
s_nop 0
s_cbranch_vccnz L_lnZ_slow
L_lnZ_ok:
v_mfma_f32_16x16x32_bf16 v[40:43], a[160:163], a[176:179], v[40:43]
ds_read_b64_tr_b16 a[224:225], v24 offset:36864
v_mfma_f32_16x16x32_bf16 v[52:55], a[164:167], a[176:179], v[52:55]
v_mfma_f32_16x16x32_bf16 v[64:67], a[168:171], a[176:179], v[64:67]
ds_read_b64_tr_b16 a[226:227], v24 offset:37632
v_mfma_f32_16x16x32_bf16 v[76:79], a[172:175], a[176:179], v[76:79]
ds_read_b64_tr_b16 a[228:229], v25 offset:36864
v_mfma_f32_16x16x32_bf16 v[136:139], v[32:35], a[176:179], v[136:139]
ds_read_b64_tr_b16 a[230:231], v25 offset:37632
v_mfma_f32_16x16x32_bf16 v[44:47], a[160:163], a[180:183], v[44:47]
v_mfma_f32_16x16x32_bf16 v[56:59], a[164:167], a[180:183], v[56:59]
ds_read_b64_tr_b16 a[232:233], v26 offset:36864
v_mfma_f32_16x16x32_bf16 v[68:71], a[168:171], a[180:183], v[68:71]
buffer_store_dwordx4 v[188:191], v4, s[36:39], s58 offen offset:1024 sc1
v_mfma_f32_16x16x32_bf16 v[80:83], a[172:175], a[180:183], v[80:83]
ds_read_b64_tr_b16 a[234:235], v26 offset:37632
v_mfma_f32_16x16x32_bf16 v[140:143], v[32:35], a[180:183], v[140:143]
v_mfma_f32_16x16x32_bf16 v[48:51], a[160:163], a[184:187], v[48:51]
ds_read_b128 a[208:211], v17 offset:0
v_mfma_f32_16x16x32_bf16 v[60:63], a[164:167], a[184:187], v[60:63]
ds_read_b128 a[212:215], v17 offset:1024
v_mfma_f32_16x16x32_bf16 v[72:75], a[168:171], a[184:187], v[72:75]
ds_read_b128 a[216:219], v17 offset:8192
v_mfma_f32_16x16x32_bf16 v[84:87], a[172:175], a[184:187], v[84:87]
v_mfma_f32_16x16x32_bf16 v[144:147], v[32:35], a[184:187], v[144:147]
ds_read_b128 a[220:223], v17 offset:9216
v_mfma_f32_16x16x32_bf16 v[88:91], a[188:191], a[160:163], v[88:91]
ds_read_b64_tr_b16 a[236:237], v27 offset:0
v_mfma_f32_16x16x32_bf16 v[100:103], a[188:191], a[164:167], v[100:103]
v_mfma_f32_16x16x32_bf16 v[112:115], a[188:191], a[168:171], v[112:115]
ds_read_b64_tr_b16 a[238:239], v27 offset:768
v_mfma_f32_16x16x32_bf16 v[124:127], a[188:191], a[172:175], v[124:127]
ds_read_b64_tr_b16 a[240:241], v28 offset:0
v_mfma_f32_16x16x32_bf16 v[148:151], a[188:191], v[32:35], v[148:151]
v_mfma_f32_16x16x32_bf16 v[92:95], a[192:195], a[160:163], v[92:95]
ds_read_b64_tr_b16 a[242:243], v28 offset:768
v_mfma_f32_16x16x32_bf16 v[104:107], a[192:195], a[164:167], v[104:107]
ds_read_b64_tr_b16 a[244:245], v29 offset:0
v_mfma_f32_16x16x32_bf16 v[116:119], a[192:195], a[168:171], v[116:119]
buffer_store_dwordx4 v[188:191], v4, s[36:39], s58 offen offset:2048 sc1
v_mfma_f32_16x16x32_bf16 v[128:131], a[192:195], a[172:175], v[128:131]
ds_read_b64_tr_b16 a[246:247], v29 offset:768
v_mfma_f32_16x16x32_bf16 v[152:155], a[192:195], v[32:35], v[152:155]
v_mfma_f32_16x16x32_bf16 v[96:99], a[196:199], a[160:163], v[96:99]
ds_write2_b32 v250, v180, v182 offset0:0 offset1:16
v_mfma_f32_16x16x32_bf16 v[108:111], a[196:199], a[164:167], v[108:111]
v_mfma_f32_16x16x32_bf16 v[120:123], a[196:199], a[168:171], v[120:123]
v_mfma_f32_16x16x32_bf16 v[132:135], a[196:199], a[172:175], v[132:135]
v_mfma_f32_16x16x32_bf16 v[156:159], a[196:199], v[32:35], v[156:159]
s_waitcnt lgkmcnt(0)
s_waitcnt vmcnt(8)
s_barrier
v_mfma_f32_16x16x32_bf16 v[40:43], a[208:211], a[224:227], v[40:43]
s_add_u32 m0, s65, 0
s_xor_b32 s3, s24, 0
s_nop 0
v_mfma_f32_16x16x32_bf16 v[52:55], a[212:215], a[224:227], v[52:55]
buffer_load_dwordx4 v216, s[20:23], s3 offen offset:0 lds
v_mfma_f32_16x16x32_bf16 v[64:67], a[216:219], a[224:227], v[64:67]
ds_read_b64_tr_b16 a[176:177], v21 offset:12288
v_mfma_f32_16x16x32_bf16 v[76:79], a[220:223], a[224:227], v[76:79]
ds_read_b64_tr_b16 a[178:179], v21 offset:13056
v_mfma_f32_16x16x32_bf16 v[44:47], a[208:211], a[228:231], v[44:47]
buffer_load_dwordx4 v217, s[20:23], s3 offen offset:1024 lds
v_mfma_f32_16x16x32_bf16 v[56:59], a[212:215], a[228:231], v[56:59]
ds_read_b64_tr_b16 a[180:181], v22 offset:12288
v_mfma_f32_16x16x32_bf16 v[68:71], a[216:219], a[228:231], v[68:71]
ds_read_b64_tr_b16 a[182:183], v22 offset:13056
v_mfma_f32_16x16x32_bf16 v[80:83], a[220:223], a[228:231], v[80:83]
buffer_load_dwordx4 v218, s[20:23], s3 offen offset:2048 lds
v_mfma_f32_16x16x32_bf16 v[48:51], a[208:211], a[232:235], v[48:51]
ds_read_b64_tr_b16 a[184:185], v23 offset:12288
v_mfma_f32_16x16x32_bf16 v[60:63], a[212:215], a[232:235], v[60:63]
v_mfma_f32_16x16x32_bf16 v[72:75], a[216:219], a[232:235], v[72:75]
buffer_load_dwordx4 v219, s[20:23], s3 offen offset:3072 lds
v_mfma_f32_16x16x32_bf16 v[84:87], a[220:223], a[232:235], v[84:87]
s_add_u32 m0, s65, 16384
ds_read_b64_tr_b16 a[186:187], v23 offset:13056
v_mfma_f32_16x16x32_bf16 v[88:91], a[236:239], a[208:211], v[88:91]
s_xor_b32 s3, s24, 4096
v_mfma_f32_16x16x32_bf16 v[100:103], a[236:239], a[212:215], v[100:103]
buffer_load_dwordx4 v216, s[20:23], s3 offen offset:0 lds
v_mfma_f32_16x16x32_bf16 v[112:115], a[236:239], a[216:219], v[112:115]
ds_read_b128 a[160:163], v14 offset:32768
v_mfma_f32_16x16x32_bf16 v[124:127], a[236:239], a[220:223], v[124:127]
ds_read_b128 a[164:167], v14 offset:33792
v_mfma_f32_16x16x32_bf16 v[92:95], a[240:243], a[208:211], v[92:95]
buffer_load_dwordx4 v217, s[20:23], s3 offen offset:1024 lds
v_mfma_f32_16x16x32_bf16 v[104:107], a[240:243], a[212:215], v[104:107]
ds_read_b128 a[168:171], v14 offset:40960
v_mfma_f32_16x16x32_bf16 v[116:119], a[240:243], a[216:219], v[116:119]
ds_read_b128 a[172:175], v14 offset:41984
v_mfma_f32_16x16x32_bf16 v[128:131], a[240:243], a[220:223], v[128:131]
buffer_load_dwordx4 v218, s[20:23], s3 offen offset:2048 lds
v_mfma_f32_16x16x32_bf16 v[96:99], a[244:247], a[208:211], v[96:99]
v_mfma_f32_16x16x32_bf16 v[108:111], a[244:247], a[212:215], v[108:111]
v_mfma_f32_16x16x32_bf16 v[120:123], a[244:247], a[216:219], v[120:123]
buffer_load_dwordx4 v219, s[20:23], s3 offen offset:3072 lds
v_mfma_f32_16x16x32_bf16 v[132:135], a[244:247], a[220:223], v[132:135]
s_nop 0
s_waitcnt lgkmcnt(0)
v_mfma_f32_16x16x32_bf16 v[40:43], a[160:163], a[176:179], v[40:43]
s_add_u32 m0, s65, 98304
s_xor_b32 s3, s24, 131072
v_mfma_f32_16x16x32_bf16 v[52:55], a[164:167], a[176:179], v[52:55]
buffer_load_dwordx4 v216, s[20:23], s3 offen offset:0 lds
v_mfma_f32_16x16x32_bf16 v[64:67], a[168:171], a[176:179], v[64:67]
ds_read_b64_tr_b16 a[224:225], v27 offset:12288
v_mfma_f32_16x16x32_bf16 v[76:79], a[172:175], a[176:179], v[76:79]
ds_read_b64_tr_b16 a[226:227], v27 offset:13056
ds_read_b64_tr_b16 a[228:229], v28 offset:12288
v_mfma_f32_16x16x32_bf16 v[136:139], v[32:35], a[176:179], v[136:139]
ds_read_b64_tr_b16 a[230:231], v28 offset:13056
v_mfma_f32_16x16x32_bf16 v[44:47], a[160:163], a[180:183], v[44:47]
buffer_load_dwordx4 v217, s[20:23], s3 offen offset:1024 lds
v_mfma_f32_16x16x32_bf16 v[56:59], a[164:167], a[180:183], v[56:59]
ds_read_b64_tr_b16 a[232:233], v29 offset:12288
ds_read_b64_tr_b16 a[234:235], v29 offset:13056
v_mfma_f32_16x16x32_bf16 v[68:71], a[168:171], a[180:183], v[68:71]
ds_read_b128 a[208:211], v15 offset:32768
v_mfma_f32_16x16x32_bf16 v[80:83], a[172:175], a[180:183], v[80:83]
ds_read_b128 a[212:215], v15 offset:33792
ds_read_b128 a[216:219], v15 offset:40960
v_mfma_f32_16x16x32_bf16 v[140:143], v[32:35], a[180:183], v[140:143]
buffer_load_dwordx4 v218, s[20:23], s3 offen offset:2048 lds
v_mfma_f32_16x16x32_bf16 v[48:51], a[160:163], a[184:187], v[48:51]
ds_read_b128 a[220:223], v15 offset:41984
v_mfma_f32_16x16x32_bf16 v[60:63], a[164:167], a[184:187], v[60:63]
v_mfma_f32_16x16x32_bf16 v[72:75], a[168:171], a[184:187], v[72:75]
v_mfma_f32_16x16x32_bf16 v[84:87], a[172:175], a[184:187], v[84:87]
buffer_load_dwordx4 v219, s[20:23], s3 offen offset:3072 lds
v_mfma_f32_16x16x32_bf16 v[144:147], v[32:35], a[184:187], v[144:147]
s_waitcnt lgkmcnt(0)
s_waitcnt vmcnt(14)
s_nop 0
s_barrier
v_mfma_f32_16x16x32_bf16 v[40:43], a[208:211], a[224:227], v[40:43]
s_add_u32 m0, s65, 114688
s_xor_b32 s3, s24, 135168
ds_read_b64_tr_b16 a[176:177], v18 offset:0
v_mfma_f32_16x16x32_bf16 v[52:55], a[212:215], a[224:227], v[52:55]
buffer_load_dwordx4 v216, s[20:23], s3 offen offset:0 lds
v_mfma_f32_16x16x32_bf16 v[64:67], a[216:219], a[224:227], v[64:67]
ds_read_b64_tr_b16 a[178:179], v18 offset:768
ds_read_b64_tr_b16 a[180:181], v19 offset:0
v_mfma_f32_16x16x32_bf16 v[76:79], a[220:223], a[224:227], v[76:79]
ds_read_b64_tr_b16 a[182:183], v19 offset:768
ds_read_b64_tr_b16 a[184:185], v20 offset:0
v_mfma_f32_16x16x32_bf16 v[44:47], a[208:211], a[228:231], v[44:47]
buffer_load_dwordx4 v217, s[20:23], s3 offen offset:1024 lds
ds_read_b64_tr_b16 a[186:187], v20 offset:768
v_mfma_f32_16x16x32_bf16 v[56:59], a[212:215], a[228:231], v[56:59]
ds_read_b128 a[160:163], v16 offset:32768
ds_read_b128 a[164:167], v16 offset:33792
v_mfma_f32_16x16x32_bf16 v[68:71], a[216:219], a[228:231], v[68:71]
ds_read_b128 a[168:171], v16 offset:40960
v_mfma_f32_16x16x32_bf16 v[80:83], a[220:223], a[228:231], v[80:83]
buffer_load_dwordx4 v218, s[20:23], s3 offen offset:2048 lds
ds_read_b128 a[172:175], v16 offset:41984
v_mfma_f32_16x16x32_bf16 v[48:51], a[208:211], a[232:235], v[48:51]
v_mfma_f32_16x16x32_bf16 v[60:63], a[212:215], a[232:235], v[60:63]
v_mfma_f32_16x16x32_bf16 v[72:75], a[216:219], a[232:235], v[72:75]
buffer_load_dwordx4 v219, s[20:23], s3 offen offset:3072 lds
v_mfma_f32_16x16x32_bf16 v[84:87], a[220:223], a[232:235], v[84:87]
s_nop 0
s_waitcnt lgkmcnt(0)
v_mfma_f32_16x16x32_bf16 v[136:139], v[32:35], a[176:179], v[136:139]
s_add_u32 m0, s65, 131072
s_xor_b32 s3, s24, 256
v_mfma_f32_16x16x32_bf16 v[140:143], v[32:35], a[180:183], v[140:143]
buffer_load_dwordx4 v216, s[20:23], s3 offen offset:0 lds
v_mfma_f32_16x16x32_bf16 v[144:147], v[32:35], a[184:187], v[144:147]
ds_read_b64_tr_b16 a[224:225], v24 offset:0
ds_read_b64_tr_b16 a[226:227], v24 offset:768
v_mfma_f32_16x16x32_bf16 v[40:43], a[160:163], a[176:179], v[40:43]
ds_read_b64_tr_b16 a[228:229], v25 offset:0
ds_read_b64_tr_b16 a[230:231], v25 offset:768
v_mfma_f32_16x16x32_bf16 v[52:55], a[164:167], a[176:179], v[52:55]
ds_read_b64_tr_b16 a[232:233], v26 offset:0
ds_read_b64_tr_b16 a[234:235], v26 offset:768
v_mfma_f32_16x16x32_bf16 v[64:67], a[168:171], a[176:179], v[64:67]
buffer_load_dwordx4 v217, s[20:23], s3 offen offset:1024 lds
v_mfma_f32_16x16x32_bf16 v[76:79], a[172:175], a[176:179], v[76:79]
ds_read_b128 a[208:211], v17 offset:32768
v_mfma_f32_16x16x32_bf16 v[44:47], a[160:163], a[180:183], v[44:47]
ds_read_b128 a[212:215], v17 offset:33792
ds_read_b128 a[216:219], v17 offset:40960
v_mfma_f32_16x16x32_bf16 v[56:59], a[164:167], a[180:183], v[56:59]
ds_read_b128 a[220:223], v17 offset:41984
ds_write2_b32 v234, v136, v140 offset0:0 offset1:16
v_mfma_f32_16x16x32_bf16 v[68:71], a[168:171], a[180:183], v[68:71]
buffer_load_dwordx4 v218, s[20:23], s3 offen offset:2048 lds
v_mfma_f32_16x16x32_bf16 v[80:83], a[172:175], a[180:183], v[80:83]
ds_write_b32 v234, v144 offset:128
v_xor_b32 v234, 1024, v234
v_mfma_f32_16x16x32_bf16 v[48:51], a[160:163], a[184:187], v[48:51]
v_mfma_f32_16x16x32_bf16 v[60:63], a[164:167], a[184:187], v[60:63]
v_mfma_f32_16x16x32_bf16 v[72:75], a[168:171], a[184:187], v[72:75]
buffer_load_dwordx4 v219, s[20:23], s3 offen offset:3072 lds
v_mfma_f32_16x16x32_bf16 v[84:87], a[172:175], a[184:187], v[84:87]
s_waitcnt lgkmcnt(0)
s_waitcnt vmcnt(12)
s_nop 0
s_barrier
v_mfma_f32_16x16x32_bf16 v[40:43], a[208:211], a[224:227], v[40:43]
ds_read_b128 v[160:163], v252 offset:0
ds_read_b128 v[164:167], v252 offset:64
ds_read_b128 v[168:171], v252 offset:128
v_mfma_f32_16x16x32_bf16 v[52:55], a[212:215], a[224:227], v[52:55]
ds_read_b128 v[172:175], v252 offset:192
ds_read_b128 v[176:179], v252 offset:256
ds_read_b128 v[180:183], v252 offset:320
v_mfma_f32_16x16x32_bf16 v[64:67], a[216:219], a[224:227], v[64:67]
ds_read_b128 v[184:187], v252 offset:384
ds_read_b128 v[188:191], v252 offset:448
v_mfma_f32_16x16x32_bf16 v[76:79], a[220:223], a[224:227], v[76:79]
ds_read2_b32 v[192:193], v234 offset0:0 offset1:16
ds_read_b32 v194, v234 offset:128
ds_read2_b32 v[208:209], v251 offset0:0 offset1:16
v_mfma_f32_16x16x32_bf16 v[44:47], a[208:211], a[228:231], v[44:47]
ds_read2_b32 v[210:211], v251 offset0:32 offset1:48
ds_read2_b32 v[212:213], v251 offset0:64 offset1:80
ds_read2_b32 v[214:215], v251 offset0:96 offset1:112
v_mfma_f32_16x16x32_bf16 v[56:59], a[212:215], a[228:231], v[56:59]
ds_read_b128 a[0:3], v220 offset:0
ds_read_b128 a[4:7], v221 offset:0
ds_read_b128 a[8:11], v222 offset:0
v_mfma_f32_16x16x32_bf16 v[68:71], a[216:219], a[228:231], v[68:71]
ds_read_b128 a[12:15], v223 offset:0
ds_read_b128 a[16:19], v220 offset:16384
v_mfma_f32_16x16x32_bf16 v[80:83], a[220:223], a[228:231], v[80:83]
ds_read_b128 a[20:23], v221 offset:16384
ds_read_b128 a[24:27], v222 offset:16384
ds_read_b128 a[28:31], v223 offset:16384
v_mfma_f32_16x16x32_bf16 v[48:51], a[208:211], a[232:235], v[48:51]
v_mfma_f32_16x16x32_bf16 v[60:63], a[212:215], a[232:235], v[60:63]
v_mfma_f32_16x16x32_bf16 v[72:75], a[216:219], a[232:235], v[72:75]
v_mfma_f32_16x16x32_bf16 v[84:87], a[220:223], a[232:235], v[84:87]
s_waitcnt lgkmcnt(12)
v_add_f32 v136, v136, v192
v_add_f32 v140, v140, v193
v_add_f32 v144, v144, v194
v_pk_fma_f32 v[40:41], v[160:161], v[136:137], v[40:41] op_sel_hi:[1,0,1] neg_lo:[1,0,0] neg_hi:[1,0,0]
v_pk_fma_f32 v[42:43], v[162:163], v[136:137], v[42:43] op_sel_hi:[1,0,1] neg_lo:[1,0,0] neg_hi:[1,0,0]
v_pk_mul_f32 v[40:41], v[40:41], v[164:165]
v_pk_mul_f32 v[42:43], v[42:43], v[166:167]
v_pk_fma_f32 v[44:45], v[160:161], v[140:141], v[44:45] op_sel_hi:[1,0,1] neg_lo:[1,0,0] neg_hi:[1,0,0]
v_pk_fma_f32 v[46:47], v[162:163], v[140:141], v[46:47] op_sel_hi:[1,0,1] neg_lo:[1,0,0] neg_hi:[1,0,0]
v_pk_mul_f32 v[44:45], v[44:45], v[164:165]
v_pk_mul_f32 v[46:47], v[46:47], v[166:167]
v_pk_fma_f32 v[48:49], v[160:161], v[144:145], v[48:49] op_sel_hi:[1,0,1] neg_lo:[1,0,0] neg_hi:[1,0,0]
v_pk_fma_f32 v[50:51], v[162:163], v[144:145], v[50:51] op_sel_hi:[1,0,1] neg_lo:[1,0,0] neg_hi:[1,0,0]
v_pk_mul_f32 v[48:49], v[48:49], v[164:165]
v_pk_mul_f32 v[50:51], v[50:51], v[166:167]
v_pk_fma_f32 v[52:53], v[168:169], v[136:137], v[52:53] op_sel_hi:[1,0,1] neg_lo:[1,0,0] neg_hi:[1,0,0]
v_pk_fma_f32 v[54:55], v[170:171], v[136:137], v[54:55] op_sel_hi:[1,0,1] neg_lo:[1,0,0] neg_hi:[1,0,0]
v_pk_mul_f32 v[52:53], v[52:53], v[172:173]
v_pk_mul_f32 v[54:55], v[54:55], v[174:175]
v_pk_fma_f32 v[56:57], v[168:169], v[140:141], v[56:57] op_sel_hi:[1,0,1] neg_lo:[1,0,0] neg_hi:[1,0,0]
v_pk_fma_f32 v[58:59], v[170:171], v[140:141], v[58:59] op_sel_hi:[1,0,1] neg_lo:[1,0,0] neg_hi:[1,0,0]
v_pk_mul_f32 v[56:57], v[56:57], v[172:173]
v_pk_mul_f32 v[58:59], v[58:59], v[174:175]
v_pk_fma_f32 v[60:61], v[168:169], v[144:145], v[60:61] op_sel_hi:[1,0,1] neg_lo:[1,0,0] neg_hi:[1,0,0]
v_pk_fma_f32 v[62:63], v[170:171], v[144:145], v[62:63] op_sel_hi:[1,0,1] neg_lo:[1,0,0] neg_hi:[1,0,0]
v_pk_mul_f32 v[60:61], v[60:61], v[172:173]
v_pk_mul_f32 v[62:63], v[62:63], v[174:175]
v_pk_fma_f32 v[64:65], v[176:177], v[136:137], v[64:65] op_sel_hi:[1,0,1] neg_lo:[1,0,0] neg_hi:[1,0,0]
v_pk_fma_f32 v[66:67], v[178:179], v[136:137], v[66:67] op_sel_hi:[1,0,1] neg_lo:[1,0,0] neg_hi:[1,0,0]
v_pk_mul_f32 v[64:65], v[64:65], v[180:181]
v_pk_mul_f32 v[66:67], v[66:67], v[182:183]
v_pk_fma_f32 v[68:69], v[176:177], v[140:141], v[68:69] op_sel_hi:[1,0,1] neg_lo:[1,0,0] neg_hi:[1,0,0]
v_pk_fma_f32 v[70:71], v[178:179], v[140:141], v[70:71] op_sel_hi:[1,0,1] neg_lo:[1,0,0] neg_hi:[1,0,0]
v_pk_mul_f32 v[68:69], v[68:69], v[180:181]
v_pk_mul_f32 v[70:71], v[70:71], v[182:183]
v_pk_fma_f32 v[72:73], v[176:177], v[144:145], v[72:73] op_sel_hi:[1,0,1] neg_lo:[1,0,0] neg_hi:[1,0,0]
s_waitcnt lgkmcnt(4)
s_add_u32 m0, s65, 0
s_xor_b32 s3, s24, 4352
buffer_load_dwordx4 v216, s[20:23], s3 offen offset:0 lds
v_pk_fma_f32 v[74:75], v[178:179], v[144:145], v[74:75] op_sel_hi:[1,0,1] neg_lo:[1,0,0] neg_hi:[1,0,0]
v_pk_mul_f32 v[72:73], v[72:73], v[180:181]
v_pk_mul_f32 v[74:75], v[74:75], v[182:183]
v_pk_fma_f32 v[76:77], v[184:185], v[136:137], v[76:77] op_sel_hi:[1,0,1] neg_lo:[1,0,0] neg_hi:[1,0,0]
v_pk_fma_f32 v[78:79], v[186:187], v[136:137], v[78:79] op_sel_hi:[1,0,1] neg_lo:[1,0,0] neg_hi:[1,0,0]
v_pk_mul_f32 v[76:77], v[76:77], v[188:189]
v_pk_mul_f32 v[78:79], v[78:79], v[190:191]
v_pk_fma_f32 v[80:81], v[184:185], v[140:141], v[80:81] op_sel_hi:[1,0,1] neg_lo:[1,0,0] neg_hi:[1,0,0]
v_pk_fma_f32 v[82:83], v[186:187], v[140:141], v[82:83] op_sel_hi:[1,0,1] neg_lo:[1,0,0] neg_hi:[1,0,0]
v_pk_mul_f32 v[80:81], v[80:81], v[188:189]
buffer_load_dwordx4 v217, s[20:23], s3 offen offset:1024 lds
v_pk_mul_f32 v[82:83], v[82:83], v[190:191]
v_pk_fma_f32 v[84:85], v[184:185], v[144:145], v[84:85] op_sel_hi:[1,0,1] neg_lo:[1,0,0] neg_hi:[1,0,0]
v_pk_fma_f32 v[86:87], v[186:187], v[144:145], v[86:87] op_sel_hi:[1,0,1] neg_lo:[1,0,0] neg_hi:[1,0,0]
v_pk_mul_f32 v[84:85], v[84:85], v[188:189]
v_pk_mul_f32 v[86:87], v[86:87], v[190:191]
v_pk_mul_f32 v[160:161], v[40:41], v[40:41]
v_pk_mul_f32 v[162:163], v[42:43], v[42:43]
v_pk_mul_f32 v[164:165], v[44:45], v[44:45]
v_pk_mul_f32 v[166:167], v[46:47], v[46:47]
v_pk_mul_f32 v[168:169], v[48:49], v[48:49]
v_pk_mul_f32 v[170:171], v[50:51], v[50:51]
buffer_load_dwordx4 v218, s[20:23], s3 offen offset:2048 lds
v_pk_mul_f32 v[172:173], v[52:53], v[52:53]
v_pk_mul_f32 v[174:175], v[54:55], v[54:55]
v_pk_mul_f32 v[176:177], v[56:57], v[56:57]
v_pk_mul_f32 v[178:179], v[58:59], v[58:59]
v_pk_mul_f32 v[180:181], v[60:61], v[60:61]
v_pk_mul_f32 v[182:183], v[62:63], v[62:63]
v_pk_fma_f32 v[160:161], v[160:161], s[94:95], s[94:95] op_sel:[0,1,0] op_sel_hi:[1,1,0]
v_pk_fma_f32 v[162:163], v[162:163], s[94:95], s[94:95] op_sel:[0,1,0] op_sel_hi:[1,1,0]
v_pk_fma_f32 v[164:165], v[164:165], s[94:95], s[94:95] op_sel:[0,1,0] op_sel_hi:[1,1,0]
v_pk_fma_f32 v[166:167], v[166:167], s[94:95], s[94:95] op_sel:[0,1,0] op_sel_hi:[1,1,0]
v_pk_fma_f32 v[168:169], v[168:169], s[94:95], s[94:95] op_sel:[0,1,0] op_sel_hi:[1,1,0]
buffer_load_dwordx4 v219, s[20:23], s3 offen offset:3072 lds
v_pk_fma_f32 v[170:171], v[170:171], s[94:95], s[94:95] op_sel:[0,1,0] op_sel_hi:[1,1,0]
v_pk_fma_f32 v[172:173], v[172:173], s[94:95], s[94:95] op_sel:[0,1,0] op_sel_hi:[1,1,0]
v_pk_fma_f32 v[174:175], v[174:175], s[94:95], s[94:95] op_sel:[0,1,0] op_sel_hi:[1,1,0]
v_pk_fma_f32 v[176:177], v[176:177], s[94:95], s[94:95] op_sel:[0,1,0] op_sel_hi:[1,1,0]
v_pk_fma_f32 v[178:179], v[178:179], s[94:95], s[94:95] op_sel:[0,1,0] op_sel_hi:[1,1,0]
v_pk_fma_f32 v[180:181], v[180:181], s[94:95], s[94:95] op_sel:[0,1,0] op_sel_hi:[1,1,0]
v_pk_fma_f32 v[182:183], v[182:183], s[94:95], s[94:95] op_sel:[0,1,0] op_sel_hi:[1,1,0]
v_pk_mul_f32 v[160:161], v[160:161], v[40:41]
v_pk_mul_f32 v[162:163], v[162:163], v[42:43]
v_pk_mul_f32 v[164:165], v[164:165], v[44:45]
s_nop 0
s_waitcnt vmcnt(12)
ds_read_b128 a[32:35], v224 offset:16384
v_pk_mul_f32 v[166:167], v[166:167], v[46:47]
v_pk_mul_f32 v[168:169], v[168:169], v[48:49]
v_pk_mul_f32 v[170:171], v[170:171], v[50:51]
ds_read_b128 a[36:39], v225 offset:16384
v_pk_mul_f32 v[172:173], v[172:173], v[52:53]
v_pk_mul_f32 v[174:175], v[174:175], v[54:55]
v_pk_mul_f32 v[176:177], v[176:177], v[56:57]
ds_read_b128 a[40:43], v226 offset:16384
v_pk_mul_f32 v[178:179], v[178:179], v[58:59]
v_pk_mul_f32 v[180:181], v[180:181], v[60:61]
v_pk_mul_f32 v[182:183], v[182:183], v[62:63]
ds_read_b128 a[44:47], v227 offset:16384
v_exp_f32 v160, v160
v_exp_f32 v161, v161
s_waitcnt lgkmcnt(4)
s_add_u32 m0, s65, 16384
s_xor_b32 s3, s24, 131328
buffer_load_dwordx4 v216, s[20:23], s3 offen offset:0 lds
v_exp_f32 v162, v162
v_exp_f32 v163, v163
v_exp_f32 v164, v164
v_exp_f32 v165, v165
v_exp_f32 v166, v166
v_exp_f32 v167, v167
v_exp_f32 v168, v168
v_exp_f32 v169, v169
v_exp_f32 v170, v170
v_exp_f32 v171, v171
v_exp_f32 v172, v172
buffer_load_dwordx4 v217, s[20:23], s3 offen offset:1024 lds
v_exp_f32 v173, v173
v_exp_f32 v174, v174
v_exp_f32 v175, v175
v_exp_f32 v176, v176
v_exp_f32 v177, v177
v_exp_f32 v178, v178
v_exp_f32 v179, v179
v_exp_f32 v180, v180
v_exp_f32 v181, v181
v_exp_f32 v182, v182
buffer_load_dwordx4 v218, s[20:23], s3 offen offset:2048 lds
v_exp_f32_e64 v183, v183
v_pk_add_f32 v[160:161], v[160:161], 1.0 op_sel_hi:[1,0]
v_pk_add_f32 v[162:163], v[162:163], 1.0 op_sel_hi:[1,0]
v_pk_add_f32 v[164:165], v[164:165], 1.0 op_sel_hi:[1,0]
v_pk_add_f32 v[166:167], v[166:167], 1.0 op_sel_hi:[1,0]
v_pk_add_f32 v[168:169], v[168:169], 1.0 op_sel_hi:[1,0]
v_pk_add_f32 v[170:171], v[170:171], 1.0 op_sel_hi:[1,0]
v_pk_add_f32 v[172:173], v[172:173], 1.0 op_sel_hi:[1,0]
v_pk_add_f32 v[174:175], v[174:175], 1.0 op_sel_hi:[1,0]
v_pk_add_f32 v[176:177], v[176:177], 1.0 op_sel_hi:[1,0]
v_pk_add_f32 v[178:179], v[178:179], 1.0 op_sel_hi:[1,0]
buffer_load_dwordx4 v219, s[20:23], s3 offen offset:3072 lds
v_pk_add_f32 v[180:181], v[180:181], 1.0 op_sel_hi:[1,0]
v_pk_add_f32 v[182:183], v[182:183], 1.0 op_sel_hi:[1,0]
v_rcp_f32 v160, v160
v_rcp_f32 v161, v161
v_rcp_f32 v162, v162
v_rcp_f32 v163, v163
v_rcp_f32 v164, v164
v_rcp_f32 v165, v165
v_rcp_f32 v166, v166
v_rcp_f32 v167, v167
s_waitcnt vmcnt(12)
ds_read_b128 a[48:51], v224 offset:32768
v_rcp_f32 v168, v168
v_rcp_f32 v169, v169
v_rcp_f32 v170, v170
ds_read_b128 a[52:55], v225 offset:32768
v_rcp_f32 v171, v171
v_rcp_f32 v172, v172
v_rcp_f32 v173, v173
ds_read_b128 a[56:59], v226 offset:32768
v_rcp_f32 v174, v174
v_rcp_f32 v175, v175
v_rcp_f32 v176, v176
ds_read_b128 a[60:63], v227 offset:32768
v_rcp_f32 v177, v177
v_rcp_f32 v178, v178
s_waitcnt lgkmcnt(4)
s_add_u32 m0, s65, 98304
s_xor_b32 s3, s24, 135424
buffer_load_dwordx4 v216, s[20:23], s3 offen offset:0 lds
v_rcp_f32 v179, v179
v_rcp_f32 v180, v180
v_rcp_f32 v181, v181
v_rcp_f32 v182, v182
v_rcp_f32 v183, v183
v_pk_mul_f32 v[40:41], v[160:161], v[40:41]
v_pk_mul_f32 v[42:43], v[162:163], v[42:43]
v_pk_mul_f32 v[44:45], v[164:165], v[44:45]
v_pk_mul_f32 v[46:47], v[166:167], v[46:47]
v_pk_mul_f32 v[48:49], v[168:169], v[48:49]
v_pk_mul_f32 v[50:51], v[170:171], v[50:51]
buffer_load_dwordx4 v217, s[20:23], s3 offen offset:1024 lds
v_pk_mul_f32 v[52:53], v[172:173], v[52:53]
v_pk_mul_f32 v[54:55], v[174:175], v[54:55]
v_pk_mul_f32 v[56:57], v[176:177], v[56:57]
v_pk_mul_f32 v[58:59], v[178:179], v[58:59]
v_pk_mul_f32 v[60:61], v[180:181], v[60:61]
v_pk_mul_f32 v[62:63], v[182:183], v[62:63]
v_pk_add_f32 v[184:185], v[40:41], v[44:45]
v_pk_mul_f32 v[192:193], v[40:41], v[40:41]
v_pk_add_f32 v[186:187], v[42:43], v[46:47]
v_pk_mul_f32 v[194:195], v[42:43], v[42:43]
buffer_load_dwordx4 v218, s[20:23], s3 offen offset:2048 lds
v_pk_add_f32 v[188:189], v[52:53], v[56:57]
v_pk_mul_f32 v[196:197], v[52:53], v[52:53]
v_pk_add_f32 v[190:191], v[54:55], v[58:59]
v_pk_mul_f32 v[198:199], v[54:55], v[54:55]
v_pk_add_f32 v[184:185], v[184:185], v[48:49]
v_pk_fma_f32 v[192:193], v[44:45], v[44:45], v[192:193]
v_pk_add_f32 v[186:187], v[186:187], v[50:51]
v_pk_fma_f32 v[194:195], v[46:47], v[46:47], v[194:195]
v_pk_add_f32 v[188:189], v[188:189], v[60:61]
v_pk_fma_f32 v[196:197], v[56:57], v[56:57], v[196:197]
v_pk_add_f32 v[190:191], v[190:191], v[62:63]
buffer_load_dwordx4 v219, s[20:23], s3 offen offset:3072 lds
v_pk_fma_f32 v[198:199], v[58:59], v[58:59], v[198:199]
v_pk_fma_f32 v[192:193], v[48:49], v[48:49], v[192:193]
v_pk_fma_f32 v[194:195], v[50:51], v[50:51], v[194:195]
v_pk_fma_f32 v[196:197], v[60:61], v[60:61], v[196:197]
v_pk_fma_f32 v[198:199], v[62:63], v[62:63], v[198:199]
v_add_f32_dpp v184, v184, v184 row_ror:8 row_mask:0xf bank_mask:0x3
v_add_f32_dpp v188, v188, v188 row_ror:8 row_mask:0xf bank_mask:0x3
v_add_f32_dpp v192, v192, v192 row_ror:8 row_mask:0xf bank_mask:0x3
v_add_f32_dpp v196, v196, v196 row_ror:8 row_mask:0xf bank_mask:0x3
v_add_f32_dpp v185, v185, v185 row_ror:8 row_mask:0xf bank_mask:0x3
s_waitcnt vmcnt(12)
ds_read_b128 a[64:67], v224 offset:49152
v_add_f32_dpp v189, v189, v189 row_ror:8 row_mask:0xf bank_mask:0x3
v_add_f32_dpp v193, v193, v193 row_ror:8 row_mask:0xf bank_mask:0x3
v_add_f32_dpp v197, v197, v197 row_ror:8 row_mask:0xf bank_mask:0x3
ds_read_b128 a[68:71], v225 offset:49152
v_add_f32_dpp v184, v186, v186 row_ror:8 row_mask:0xf bank_mask:0xc
v_add_f32_dpp v188, v190, v190 row_ror:8 row_mask:0xf bank_mask:0xc
v_add_f32_dpp v192, v194, v194 row_ror:8 row_mask:0xf bank_mask:0xc
ds_read_b128 a[72:75], v226 offset:49152
v_add_f32_dpp v196, v198, v198 row_ror:8 row_mask:0xf bank_mask:0xc
v_add_f32_dpp v185, v187, v187 row_ror:8 row_mask:0xf bank_mask:0xc
v_add_f32_dpp v189, v191, v191 row_ror:8 row_mask:0xf bank_mask:0xc
ds_read_b128 a[76:79], v227 offset:49152
v_add_f32_dpp v193, v195, v195 row_ror:8 row_mask:0xf bank_mask:0xc
v_add_f32_dpp v197, v199, v199 row_ror:8 row_mask:0xf bank_mask:0xc
s_waitcnt lgkmcnt(4)
s_add_u32 m0, s65, 114688
s_xor_b32 s3, s24, 512
buffer_load_dwordx4 v216, s[20:23], s3 offen offset:0 lds
v_add_f32_dpp v184, v184, v184 row_half_mirror row_mask:0xf bank_mask:0x5
v_add_f32_dpp v188, v188, v188 row_half_mirror row_mask:0xf bank_mask:0x5
v_add_f32_dpp v192, v192, v192 row_half_mirror row_mask:0xf bank_mask:0x5
v_add_f32_dpp v196, v196, v196 row_half_mirror row_mask:0xf bank_mask:0x5
v_add_f32_dpp v184, v185, v185 row_half_mirror row_mask:0xf bank_mask:0xa
v_add_f32_dpp v188, v189, v189 row_half_mirror row_mask:0xf bank_mask:0xa
v_add_f32_dpp v192, v193, v193 row_half_mirror row_mask:0xf bank_mask:0xa
v_add_f32_dpp v196, v197, v197 row_half_mirror row_mask:0xf bank_mask:0xa
v_add_f32_dpp v184, v184, v184 quad_perm:[1,0,3,2] row_mask:0xf bank_mask:0xf
v_add_f32_dpp v188, v188, v188 quad_perm:[1,0,3,2] row_mask:0xf bank_mask:0xf
v_add_f32_dpp v192, v192, v192 quad_perm:[1,0,3,2] row_mask:0xf bank_mask:0xf
buffer_load_dwordx4 v217, s[20:23], s3 offen offset:1024 lds
v_add_f32_dpp v196, v196, v196 quad_perm:[1,0,3,2] row_mask:0xf bank_mask:0xf
v_add_f32_dpp v184, v184, v184 quad_perm:[2,3,0,1] row_mask:0xf bank_mask:0xf
v_add_f32_dpp v188, v188, v188 quad_perm:[2,3,0,1] row_mask:0xf bank_mask:0xf
v_add_f32_dpp v192, v192, v192 quad_perm:[2,3,0,1] row_mask:0xf bank_mask:0xf
v_add_f32_dpp v196, v196, v196 quad_perm:[2,3,0,1] row_mask:0xf bank_mask:0xf
v_cndmask_b32 v200, v184, v188, s[90:91]
v_cndmask_b32 v201, v192, v196, s[90:91]
ds_write2_b32 v231, v200, v201 offset0:0 offset1:64
v_pk_mul_f32 v[160:161], v[64:65], v[64:65]
v_pk_mul_f32 v[162:163], v[66:67], v[66:67]
buffer_load_dwordx4 v218, s[20:23], s3 offen offset:2048 lds
v_pk_mul_f32 v[164:165], v[68:69], v[68:69]
v_pk_mul_f32 v[166:167], v[70:71], v[70:71]
v_pk_mul_f32 v[168:169], v[72:73], v[72:73]
v_pk_mul_f32 v[170:171], v[74:75], v[74:75]
v_pk_mul_f32 v[172:173], v[76:77], v[76:77]
v_pk_mul_f32 v[174:175], v[78:79], v[78:79]
v_pk_mul_f32 v[176:177], v[80:81], v[80:81]
v_pk_mul_f32 v[178:179], v[82:83], v[82:83]
v_pk_mul_f32 v[180:181], v[84:85], v[84:85]
v_pk_mul_f32 v[182:183], v[86:87], v[86:87]
v_pk_fma_f32 v[160:161], v[160:161], s[94:95], s[94:95] op_sel:[0,1,0] op_sel_hi:[1,1,0]
buffer_load_dwordx4 v219, s[20:23], s3 offen offset:3072 lds
v_pk_fma_f32 v[162:163], v[162:163], s[94:95], s[94:95] op_sel:[0,1,0] op_sel_hi:[1,1,0]
v_pk_fma_f32 v[164:165], v[164:165], s[94:95], s[94:95] op_sel:[0,1,0] op_sel_hi:[1,1,0]
v_pk_fma_f32 v[166:167], v[166:167], s[94:95], s[94:95] op_sel:[0,1,0] op_sel_hi:[1,1,0]
v_pk_fma_f32 v[168:169], v[168:169], s[94:95], s[94:95] op_sel:[0,1,0] op_sel_hi:[1,1,0]
v_pk_fma_f32 v[170:171], v[170:171], s[94:95], s[94:95] op_sel:[0,1,0] op_sel_hi:[1,1,0]
v_pk_fma_f32 v[172:173], v[172:173], s[94:95], s[94:95] op_sel:[0,1,0] op_sel_hi:[1,1,0]
v_pk_fma_f32 v[174:175], v[174:175], s[94:95], s[94:95] op_sel:[0,1,0] op_sel_hi:[1,1,0]
v_pk_fma_f32 v[176:177], v[176:177], s[94:95], s[94:95] op_sel:[0,1,0] op_sel_hi:[1,1,0]
v_pk_fma_f32 v[178:179], v[178:179], s[94:95], s[94:95] op_sel:[0,1,0] op_sel_hi:[1,1,0]
v_pk_fma_f32 v[180:181], v[180:181], s[94:95], s[94:95] op_sel:[0,1,0] op_sel_hi:[1,1,0]
v_pk_fma_f32 v[182:183], v[182:183], s[94:95], s[94:95] op_sel:[0,1,0] op_sel_hi:[1,1,0]
s_waitcnt vmcnt(12)
ds_read_b128 a[80:83], v220 offset:0
v_pk_mul_f32 v[160:161], v[160:161], v[64:65]
v_pk_mul_f32 v[162:163], v[162:163], v[66:67]
v_pk_mul_f32 v[164:165], v[164:165], v[68:69]
ds_read_b128 a[84:87], v221 offset:0
v_pk_mul_f32 v[166:167], v[166:167], v[70:71]
v_pk_mul_f32 v[168:169], v[168:169], v[72:73]
v_pk_mul_f32 v[170:171], v[170:171], v[74:75]
ds_read_b128 a[88:91], v222 offset:0
v_pk_mul_f32 v[172:173], v[172:173], v[76:77]
v_pk_mul_f32 v[174:175], v[174:175], v[78:79]
v_pk_mul_f32 v[176:177], v[176:177], v[80:81]
ds_read_b128 a[92:95], v223 offset:0
v_pk_mul_f32 v[178:179], v[178:179], v[82:83]
s_waitcnt lgkmcnt(5)
s_add_u32 m0, s65, 131072
s_xor_b32 s3, s24, 4608
buffer_load_dwordx4 v216, s[20:23], s3 offen offset:0 lds
v_pk_mul_f32 v[180:181], v[180:181], v[84:85]
v_pk_mul_f32 v[182:183], v[182:183], v[86:87]
v_exp_f32 v160, v160
v_exp_f32 v161, v161
v_exp_f32 v162, v162
v_exp_f32 v163, v163
v_exp_f32 v164, v164
v_exp_f32 v165, v165
v_exp_f32 v166, v166
v_exp_f32 v167, v167
v_exp_f32 v168, v168
buffer_load_dwordx4 v217, s[20:23], s3 offen offset:1024 lds
v_exp_f32 v169, v169
v_exp_f32 v170, v170
v_exp_f32 v171, v171
v_exp_f32 v172, v172
v_exp_f32 v173, v173
v_exp_f32 v174, v174
v_exp_f32 v175, v175
v_exp_f32 v176, v176
v_exp_f32 v177, v177
v_exp_f32_e64 v178, v178
buffer_load_dwordx4 v218, s[20:23], s3 offen offset:2048 lds
v_exp_f32 v179, v179
v_exp_f32 v180, v180
v_exp_f32 v181, v181
v_exp_f32 v182, v182
v_exp_f32_e64 v183, v183
v_pk_add_f32 v[160:161], v[160:161], 1.0 op_sel_hi:[1,0]
v_pk_add_f32 v[162:163], v[162:163], 1.0 op_sel_hi:[1,0]
v_pk_add_f32 v[164:165], v[164:165], 1.0 op_sel_hi:[1,0]
v_pk_add_f32 v[166:167], v[166:167], 1.0 op_sel_hi:[1,0]
v_pk_add_f32 v[168:169], v[168:169], 1.0 op_sel_hi:[1,0]
v_pk_add_f32 v[170:171], v[170:171], 1.0 op_sel_hi:[1,0]
buffer_load_dwordx4 v219, s[20:23], s3 offen offset:3072 lds
v_pk_add_f32 v[172:173], v[172:173], 1.0 op_sel_hi:[1,0]
v_pk_add_f32 v[174:175], v[174:175], 1.0 op_sel_hi:[1,0]
v_pk_add_f32 v[176:177], v[176:177], 1.0 op_sel_hi:[1,0]
v_pk_add_f32 v[178:179], v[178:179], 1.0 op_sel_hi:[1,0]
v_pk_add_f32 v[180:181], v[180:181], 1.0 op_sel_hi:[1,0]
v_pk_add_f32 v[182:183], v[182:183], 1.0 op_sel_hi:[1,0]
v_rcp_f32 v160, v160
v_rcp_f32 v161, v161
v_rcp_f32 v162, v162
v_rcp_f32 v163, v163
v_rcp_f32 v164, v164
s_waitcnt vmcnt(12)
ds_read_b128 a[96:99], v220 offset:16384
v_rcp_f32 v165, v165
v_rcp_f32 v166, v166
v_rcp_f32 v167, v167
ds_read_b128 a[100:103], v221 offset:16384
v_rcp_f32 v168, v168
v_rcp_f32 v169, v169
v_rcp_f32 v170, v170
ds_read_b128 a[104:107], v222 offset:16384
v_rcp_f32 v171, v171
v_rcp_f32 v172, v172
v_rcp_f32_e64 v173, v173
ds_read_b128 a[108:111], v223 offset:16384
v_rcp_f32 v174, v174
s_waitcnt lgkmcnt(4)
s_add_u32 m0, s65, 0
s_xor_b32 s3, s24, 131584
buffer_load_dwordx4 v216, s[20:23], s3 offen offset:0 lds
v_rcp_f32 v175, v175
v_rcp_f32 v176, v176
v_rcp_f32 v177, v177
v_rcp_f32 v178, v178
v_rcp_f32 v179, v179
v_rcp_f32 v180, v180
v_rcp_f32 v181, v181
v_rcp_f32 v182, v182
v_rcp_f32 v183, v183
v_pk_mul_f32 v[64:65], v[160:161], v[64:65]
v_pk_mul_f32 v[66:67], v[162:163], v[66:67]
buffer_load_dwordx4 v217, s[20:23], s3 offen offset:1024 lds
v_pk_mul_f32 v[68:69], v[164:165], v[68:69]
v_pk_mul_f32 v[70:71], v[166:167], v[70:71]
v_pk_mul_f32 v[72:73], v[168:169], v[72:73]
v_pk_mul_f32 v[74:75], v[170:171], v[74:75]
v_pk_mul_f32 v[76:77], v[172:173], v[76:77]
v_pk_mul_f32 v[78:79], v[174:175], v[78:79]
v_pk_mul_f32 v[80:81], v[176:177], v[80:81]
v_pk_mul_f32 v[82:83], v[178:179], v[82:83]
v_pk_mul_f32 v[84:85], v[180:181], v[84:85]
v_pk_mul_f32 v[86:87], v[182:183], v[86:87]
v_pk_add_f32 v[184:185], v[64:65], v[68:69]
buffer_load_dwordx4 v218, s[20:23], s3 offen offset:2048 lds
v_pk_mul_f32 v[192:193], v[64:65], v[64:65]
v_pk_add_f32 v[186:187], v[66:67], v[70:71]
v_pk_mul_f32 v[194:195], v[66:67], v[66:67]
v_pk_add_f32 v[188:189], v[76:77], v[80:81]
v_pk_mul_f32 v[196:197], v[76:77], v[76:77]
v_pk_add_f32 v[190:191], v[78:79], v[82:83]
v_pk_mul_f32 v[198:199], v[78:79], v[78:79]
v_pk_add_f32 v[184:185], v[184:185], v[72:73]
v_pk_fma_f32 v[192:193], v[68:69], v[68:69], v[192:193]
v_pk_add_f32 v[186:187], v[186:187], v[74:75]
buffer_load_dwordx4 v219, s[20:23], s3 offen offset:3072 lds
v_pk_fma_f32 v[194:195], v[70:71], v[70:71], v[194:195]
v_pk_add_f32 v[188:189], v[188:189], v[84:85]
v_pk_fma_f32 v[196:197], v[80:81], v[80:81], v[196:197]
v_pk_add_f32 v[190:191], v[190:191], v[86:87]
v_pk_fma_f32 v[198:199], v[82:83], v[82:83], v[198:199]
v_pk_fma_f32 v[192:193], v[72:73], v[72:73], v[192:193]
v_pk_fma_f32 v[194:195], v[74:75], v[74:75], v[194:195]
v_pk_fma_f32 v[196:197], v[84:85], v[84:85], v[196:197]
v_pk_fma_f32 v[198:199], v[86:87], v[86:87], v[198:199]
v_add_f32_dpp v184, v184, v184 row_ror:8 row_mask:0xf bank_mask:0x3
v_add_f32_dpp v188, v188, v188 row_ror:8 row_mask:0xf bank_mask:0x3
ds_read_b64_tr_b16 a[188:189], v21 offset:24576
v_add_f32_dpp v192, v192, v192 row_ror:8 row_mask:0xf bank_mask:0x3
v_add_f32_dpp v196, v196, v196 row_ror:8 row_mask:0xf bank_mask:0x3
v_add_f32_dpp v185, v185, v185 row_ror:8 row_mask:0xf bank_mask:0x3
ds_read_b64_tr_b16 a[190:191], v21 offset:25344
v_add_f32_dpp v189, v189, v189 row_ror:8 row_mask:0xf bank_mask:0x3
v_add_f32_dpp v193, v193, v193 row_ror:8 row_mask:0xf bank_mask:0x3
v_add_f32_dpp v197, v197, v197 row_ror:8 row_mask:0xf bank_mask:0x3
ds_read_b64_tr_b16 a[192:193], v22 offset:24576
v_add_f32_dpp v184, v186, v186 row_ror:8 row_mask:0xf bank_mask:0xc
v_add_f32_dpp v188, v190, v190 row_ror:8 row_mask:0xf bank_mask:0xc
v_add_f32_dpp v192, v194, v194 row_ror:8 row_mask:0xf bank_mask:0xc
v_add_f32_dpp v196, v198, v198 row_ror:8 row_mask:0xf bank_mask:0xc
ds_read_b64_tr_b16 a[194:195], v22 offset:25344
v_add_f32_dpp v185, v187, v187 row_ror:8 row_mask:0xf bank_mask:0xc
v_add_f32_dpp v189, v191, v191 row_ror:8 row_mask:0xf bank_mask:0xc
v_add_f32_dpp v193, v195, v195 row_ror:8 row_mask:0xf bank_mask:0xc
ds_read_b64_tr_b16 a[196:197], v23 offset:24576
v_add_f32_dpp v197, v199, v199 row_ror:8 row_mask:0xf bank_mask:0xc
v_add_f32_dpp v184, v184, v184 row_half_mirror row_mask:0xf bank_mask:0x5
v_add_f32_dpp v188, v188, v188 row_half_mirror row_mask:0xf bank_mask:0x5
ds_read_b64_tr_b16 a[198:199], v23 offset:25344
v_add_f32_dpp v192, v192, v192 row_half_mirror row_mask:0xf bank_mask:0x5
v_add_f32_dpp v196, v196, v196 row_half_mirror row_mask:0xf bank_mask:0x5
v_add_f32_dpp v184, v185, v185 row_half_mirror row_mask:0xf bank_mask:0xa
ds_read_b128 a[160:163], v14 offset:32768
v_add_f32_dpp v188, v189, v189 row_half_mirror row_mask:0xf bank_mask:0xa
v_add_f32_dpp v192, v193, v193 row_half_mirror row_mask:0xf bank_mask:0xa
v_add_f32_dpp v196, v197, v197 row_half_mirror row_mask:0xf bank_mask:0xa
ds_read_b128 a[164:167], v14 offset:33792
v_add_f32_dpp v184, v184, v184 quad_perm:[1,0,3,2] row_mask:0xf bank_mask:0xf
v_add_f32_dpp v188, v188, v188 quad_perm:[1,0,3,2] row_mask:0xf bank_mask:0xf
v_add_f32_dpp v192, v192, v192 quad_perm:[1,0,3,2] row_mask:0xf bank_mask:0xf
v_add_f32_dpp v196, v196, v196 quad_perm:[1,0,3,2] row_mask:0xf bank_mask:0xf
ds_read_b128 a[168:171], v14 offset:40960
v_add_f32_dpp v184, v184, v184 quad_perm:[2,3,0,1] row_mask:0xf bank_mask:0xf
v_add_f32_dpp v188, v188, v188 quad_perm:[2,3,0,1] row_mask:0xf bank_mask:0xf
v_add_f32_dpp v192, v192, v192 quad_perm:[2,3,0,1] row_mask:0xf bank_mask:0xf
ds_read_b128 a[172:175], v14 offset:41984
v_add_f32_dpp v196, v196, v196 quad_perm:[2,3,0,1] row_mask:0xf bank_mask:0xf
v_cndmask_b32 v202, v184, v188, s[90:91]
v_cndmask_b32 v203, v192, v196, s[90:91]
ds_write2_b32 v231, v202, v203 offset0:128 offset1:192
v_mov_b32 v165, v3
v_mov_b32 v167, v3
s_waitcnt lgkmcnt(0)
s_barrier
ds_read2_b32 v[160:161], v232 offset0:0 offset1:64
ds_read2_b32 v[162:163], v233 offset0:0 offset1:64
s_waitcnt lgkmcnt(0)
v_add_f32 v164, v160, v162
v_add_f32 v166, v161, v163
buffer_store_dwordx4 v[164:167], v228, s[36:39], s45 offen sc1
s_waitcnt vmcnt(13)
ds_read_b128 a[112:115], v224 offset:16384
ds_read_b128 a[116:119], v225 offset:16384
ds_read_b128 a[120:123], v226 offset:16384
ds_read_b128 a[124:127], v227 offset:16384
s_waitcnt vmcnt(9)
ds_read_b128 a[128:131], v224 offset:32768
ds_read_b128 a[132:135], v225 offset:32768
ds_read_b128 a[136:139], v226 offset:32768
ds_read_b128 a[140:143], v227 offset:32768
s_waitcnt vmcnt(5)
ds_read_b128 a[144:147], v224 offset:49152
ds_read_b128 a[148:151], v225 offset:49152
ds_read_b128 a[152:155], v226 offset:49152
ds_read_b128 a[156:159], v227 offset:49152
s_nop 0
s_waitcnt lgkmcnt(0)
v_mfma_f32_16x16x32_bf16 v[88:91], a[188:191], a[160:163], v[88:91]
s_add_u32 m0, s65, 16384
s_xor_b32 s3, s24, 135680
v_mfma_f32_16x16x32_bf16 v[100:103], a[188:191], a[164:167], v[100:103]
buffer_load_dwordx4 v216, s[20:23], s3 offen offset:0 lds
v_mfma_f32_16x16x32_bf16 v[112:115], a[188:191], a[168:171], v[112:115]
ds_read_b64_tr_b16 a[236:237], v27 offset:24576
ds_read_b64_tr_b16 a[238:239], v27 offset:25344
v_mfma_f32_16x16x32_bf16 v[124:127], a[188:191], a[172:175], v[124:127]
ds_read_b64_tr_b16 a[240:241], v28 offset:24576
v_mfma_f32_16x16x32_bf16 v[148:151], a[188:191], v[32:35], v[148:151]
ds_read_b64_tr_b16 a[242:243], v28 offset:25344
ds_read_b64_tr_b16 a[244:245], v29 offset:24576
v_mfma_f32_16x16x32_bf16 v[92:95], a[192:195], a[160:163], v[92:95]
buffer_load_dwordx4 v217, s[20:23], s3 offen offset:1024 lds
v_mfma_f32_16x16x32_bf16 v[104:107], a[192:195], a[164:167], v[104:107]
ds_read_b64_tr_b16 a[246:247], v29 offset:25344
ds_read_b128 a[208:211], v15 offset:32768
v_mfma_f32_16x16x32_bf16 v[116:119], a[192:195], a[168:171], v[116:119]
ds_read_b128 a[212:215], v15 offset:33792
v_mfma_f32_16x16x32_bf16 v[128:131], a[192:195], a[172:175], v[128:131]
ds_read_b128 a[216:219], v15 offset:40960
ds_read_b128 a[220:223], v15 offset:41984
v_mfma_f32_16x16x32_bf16 v[152:155], a[192:195], v[32:35], v[152:155]
buffer_load_dwordx4 v218, s[20:23], s3 offen offset:2048 lds
v_mfma_f32_16x16x32_bf16 v[96:99], a[196:199], a[160:163], v[96:99]
v_mfma_f32_16x16x32_bf16 v[108:111], a[196:199], a[164:167], v[108:111]
v_mfma_f32_16x16x32_bf16 v[120:123], a[196:199], a[168:171], v[120:123]
v_mfma_f32_16x16x32_bf16 v[132:135], a[196:199], a[172:175], v[132:135]
buffer_load_dwordx4 v219, s[20:23], s3 offen offset:3072 lds
v_mfma_f32_16x16x32_bf16 v[156:159], a[196:199], v[32:35], v[156:159]
s_nop 0
s_waitcnt lgkmcnt(0)
v_mfma_f32_16x16x32_bf16 v[88:91], a[236:239], a[208:211], v[88:91]
s_add_u32 m0, s65, 98304
s_xor_b32 s3, s24, 768
v_mfma_f32_16x16x32_bf16 v[100:103], a[236:239], a[212:215], v[100:103]
buffer_load_dwordx4 v216, s[20:23], s3 offen offset:0 lds
ds_read_b64_tr_b16 a[188:189], v18 offset:12288
v_mfma_f32_16x16x32_bf16 v[112:115], a[236:239], a[216:219], v[112:115]
ds_read_b64_tr_b16 a[190:191], v18 offset:13056
v_mfma_f32_16x16x32_bf16 v[124:127], a[236:239], a[220:223], v[124:127]
ds_read_b64_tr_b16 a[192:193], v19 offset:12288
ds_read_b64_tr_b16 a[194:195], v19 offset:13056
v_mfma_f32_16x16x32_bf16 v[92:95], a[240:243], a[208:211], v[92:95]
buffer_load_dwordx4 v217, s[20:23], s3 offen offset:1024 lds
v_mfma_f32_16x16x32_bf16 v[104:107], a[240:243], a[212:215], v[104:107]
ds_read_b64_tr_b16 a[196:197], v20 offset:12288
ds_read_b64_tr_b16 a[198:199], v20 offset:13056
v_mfma_f32_16x16x32_bf16 v[116:119], a[240:243], a[216:219], v[116:119]
ds_read_b128 a[160:163], v16 offset:32768
ds_read_b128 a[164:167], v16 offset:33792
v_mfma_f32_16x16x32_bf16 v[128:131], a[240:243], a[220:223], v[128:131]
buffer_load_dwordx4 v218, s[20:23], s3 offen offset:2048 lds
v_mfma_f32_16x16x32_bf16 v[96:99], a[244:247], a[208:211], v[96:99]
ds_read_b128 a[168:171], v16 offset:40960
ds_read_b128 a[172:175], v16 offset:41984
v_mfma_f32_16x16x32_bf16 v[108:111], a[244:247], a[212:215], v[108:111]
v_mfma_f32_16x16x32_bf16 v[120:123], a[244:247], a[216:219], v[120:123]
buffer_load_dwordx4 v219, s[20:23], s3 offen offset:3072 lds
v_mfma_f32_16x16x32_bf16 v[132:135], a[244:247], a[220:223], v[132:135]
s_nop 0
s_waitcnt lgkmcnt(0)
v_mfma_f32_16x16x32_bf16 v[88:91], a[188:191], a[160:163], v[88:91]
s_add_u32 m0, s65, 114688
s_xor_b32 s3, s24, 4864
v_mfma_f32_16x16x32_bf16 v[100:103], a[188:191], a[164:167], v[100:103]
buffer_load_dwordx4 v216, s[20:23], s3 offen offset:0 lds
ds_read_b64_tr_b16 a[236:237], v24 offset:12288
v_mfma_f32_16x16x32_bf16 v[112:115], a[188:191], a[168:171], v[112:115]
buffer_load_dwordx4 v217, s[20:23], s3 offen offset:1024 lds
v_mfma_f32_16x16x32_bf16 v[124:127], a[188:191], a[172:175], v[124:127]
ds_read_b64_tr_b16 a[238:239], v24 offset:13056
ds_read_b64_tr_b16 a[240:241], v25 offset:12288
ds_read_b64_tr_b16 a[242:243], v25 offset:13056
v_mfma_f32_16x16x32_bf16 v[148:151], a[188:191], v[32:35], v[148:151]
buffer_load_dwordx4 v218, s[20:23], s3 offen offset:2048 lds
v_mfma_f32_16x16x32_bf16 v[92:95], a[192:195], a[160:163], v[92:95]
ds_read_b64_tr_b16 a[244:245], v26 offset:12288
ds_read_b64_tr_b16 a[246:247], v26 offset:13056
v_mfma_f32_16x16x32_bf16 v[104:107], a[192:195], a[164:167], v[104:107]
buffer_load_dwordx4 v219, s[20:23], s3 offen offset:3072 lds
ds_read_b128 a[208:211], v17 offset:32768
v_mfma_f32_16x16x32_bf16 v[116:119], a[192:195], a[168:171], v[116:119]
ds_read_b128 a[212:215], v17 offset:33792
ds_read_b128 a[216:219], v17 offset:40960
v_mfma_f32_16x16x32_bf16 v[128:131], a[192:195], a[172:175], v[128:131]
buffer_load_dwordx4 v[160:163], v4, s[36:39], s44 offen offset:0 sc1
ds_read_b128 a[220:223], v17 offset:41984
v_mfma_f32_16x16x32_bf16 v[152:155], a[192:195], v[32:35], v[152:155]
v_mfma_f32_16x16x32_bf16 v[96:99], a[196:199], a[160:163], v[96:99]
buffer_load_dwordx4 v[164:167], v4, s[36:39], s44 offen offset:1024 sc1
v_mfma_f32_16x16x32_bf16 v[108:111], a[196:199], a[164:167], v[108:111]
v_mfma_f32_16x16x32_bf16 v[120:123], a[196:199], a[168:171], v[120:123]
buffer_load_dwordx4 v[168:171], v4, s[36:39], s44 offen offset:2048 sc1
v_mfma_f32_16x16x32_bf16 v[132:135], a[196:199], a[172:175], v[132:135]
v_mfma_f32_16x16x32_bf16 v[156:159], a[196:199], v[32:35], v[156:159]
buffer_load_dwordx4 v[172:175], v4, s[36:39], s44 offen offset:3072 sc1
s_nop 0
s_waitcnt lgkmcnt(0)
v_mfma_f32_16x16x32_bf16 v[88:91], a[236:239], a[208:211], v[88:91]
v_mfma_f32_16x16x32_bf16 v[100:103], a[236:239], a[212:215], v[100:103]
v_mfma_f32_16x16x32_bf16 v[112:115], a[236:239], a[216:219], v[112:115]
v_mfma_f32_16x16x32_bf16 v[124:127], a[236:239], a[220:223], v[124:127]
ds_write_b128 v235, v[148:151] offset:256
v_mfma_f32_16x16x32_bf16 v[92:95], a[240:243], a[208:211], v[92:95]
v_mfma_f32_16x16x32_bf16 v[104:107], a[240:243], a[212:215], v[104:107]
v_mfma_f32_16x16x32_bf16 v[116:119], a[240:243], a[216:219], v[116:119]
ds_write_b128 v235, v[152:155] offset:320
v_mfma_f32_16x16x32_bf16 v[128:131], a[240:243], a[220:223], v[128:131]
v_mfma_f32_16x16x32_bf16 v[96:99], a[244:247], a[208:211], v[96:99]
v_mfma_f32_16x16x32_bf16 v[108:111], a[244:247], a[212:215], v[108:111]
v_mfma_f32_16x16x32_bf16 v[120:123], a[244:247], a[216:219], v[120:123]
ds_write_b128 v235, v[156:159] offset:384
v_mfma_f32_16x16x32_bf16 v[132:135], a[244:247], a[220:223], v[132:135]
s_waitcnt vmcnt(17)
ds_read_b128 a[160:163], v220 offset:0
ds_read_b128 a[164:167], v221 offset:0
ds_read_b128 a[168:171], v222 offset:0
ds_read_b128 a[172:175], v223 offset:0
s_add_u32 m0, s65, 131072
s_xor_b32 s3, s24, 131840
buffer_load_dwordx4 v216, s[20:23], s3 offen offset:0 lds
buffer_load_dwordx4 v217, s[20:23], s3 offen offset:1024 lds
buffer_load_dwordx4 v218, s[20:23], s3 offen offset:2048 lds
buffer_load_dwordx4 v219, s[20:23], s3 offen offset:3072 lds
s_waitcnt vmcnt(16)
ds_read_b128 a[176:179], v220 offset:16384
ds_read_b128 a[180:183], v221 offset:16384
ds_read_b128 a[184:187], v222 offset:16384
ds_read_b128 a[188:191], v223 offset:16384
s_waitcnt lgkmcnt(4)
s_add_u32 m0, s65, 0
s_xor_b32 s3, s24, 135936
buffer_load_dwordx4 v216, s[20:23], s3 offen offset:0 lds
buffer_load_dwordx4 v217, s[20:23], s3 offen offset:1024 lds
buffer_load_dwordx4 v218, s[20:23], s3 offen offset:2048 lds
buffer_load_dwordx4 v219, s[20:23], s3 offen offset:3072 lds
s_waitcnt vmcnt(8)
v_xor_b32 v176, s69, v161
v_xor_b32_e64 v177, s69, v163
v_bitop3_b32 v176, v176, v165, s69 bitop3:0xf6
v_bitop3_b32 v177, v177, v167, s69 bitop3:0xf6
v_bitop3_b32 v176, v176, v169, s69 bitop3:0xf6
v_bitop3_b32 v177, v177, v171, s69 bitop3:0xf6
v_bitop3_b32 v176, v176, v173, s69 bitop3:0xf6
v_bitop3_b32 v177, v177, v175, s69 bitop3:0xf6
v_or_b32 v176, v176, v177
v_cmp_ne_u32 vcc, 0, v176
s_cbranch_vccnz L_h1_slow
L_h1_ok:
v_add_f32 v160, v160, v164
v_add_f32 v162, v162, v166
v_add_f32 v168, v168, v172
v_add_f32 v170, v170, v174
v_add_f32 v160, v160, v168
v_add_f32 v162, v162, v170
v_mov_b32 v161, v160
v_mov_b32 v163, v162
s_nop 0
v_permlane32_swap_b32 v160, v161
v_permlane32_swap_b32 v162, v163
v_add_f32 v160, v160, v161
v_add_f32 v162, v162, v163
v_mul_f32 v160, 0x3abe82fa, v160
v_mul_f32 v162, 0x3abe82fa, v162
v_fma_f32 v162, -v160, v160, v162
v_max_f32 v162, 0, v162
v_add_f32 v162, 0x3727c5ac, v162
v_rsq_f32 v162, v162
s_nop 0
v_mul_f32 v160, v160, v162
ds_write2_b32 v229, v160, v162 offset0:0 offset1:32
s_waitcnt lgkmcnt(0)
s_barrier
ds_read_b128 v[160:163], v230 offset:0
ds_read_b128 v[164:167], v230 offset:128
ds_read_b128 v[168:171], v230 offset:64
ds_read_b128 v[172:175], v230 offset:192
ds_read_b128 v[176:179], v230 offset:256
ds_read_b128 v[180:183], v230 offset:384
ds_read_b128 v[136:139], v230 offset:320
ds_read_b128 v[140:143], v230 offset:448
s_nop 0
s_waitcnt lgkmcnt(4)
v_pk_fma_f32 v[40:41], v[40:41], v[164:165], v[160:161] neg_lo:[0,0,1] neg_hi:[0,0,1]
v_pk_fma_f32 v[42:43], v[42:43], v[166:167], v[162:163] neg_lo:[0,0,1] neg_hi:[0,0,1]
v_pk_fma_f32 v[52:53], v[52:53], v[172:173], v[168:169] neg_lo:[0,0,1] neg_hi:[0,0,1]
v_pk_fma_f32 v[54:55], v[54:55], v[174:175], v[170:171] neg_lo:[0,0,1] neg_hi:[0,0,1]
v_cvt_pk_bf16_f32 v184, v40, v52
v_cvt_pk_bf16_f32 v185, v41, v53
v_cvt_pk_bf16_f32 v186, v42, v54
v_cvt_pk_bf16_f32 v187, v43, v55
buffer_store_dwordx4 v[184:187], v4, s[40:43], s46 offen offset:0 sc1
v_pk_fma_f32 v[44:45], v[44:45], v[164:165], v[160:161] neg_lo:[0,0,1] neg_hi:[0,0,1]
v_pk_fma_f32 v[46:47], v[46:47], v[166:167], v[162:163] neg_lo:[0,0,1] neg_hi:[0,0,1]
v_pk_fma_f32 v[56:57], v[56:57], v[172:173], v[168:169] neg_lo:[0,0,1] neg_hi:[0,0,1]
v_pk_fma_f32 v[58:59], v[58:59], v[174:175], v[170:171] neg_lo:[0,0,1] neg_hi:[0,0,1]
v_cvt_pk_bf16_f32 v188, v44, v56
v_cvt_pk_bf16_f32 v189, v45, v57
v_cvt_pk_bf16_f32 v190, v46, v58
v_cvt_pk_bf16_f32 v191, v47, v59
buffer_store_dwordx4 v[188:191], v4, s[40:43], s47 offen offset:0 sc1
v_pk_fma_f32 v[48:49], v[48:49], v[164:165], v[160:161] neg_lo:[0,0,1] neg_hi:[0,0,1]
v_pk_fma_f32 v[50:51], v[50:51], v[166:167], v[162:163] neg_lo:[0,0,1] neg_hi:[0,0,1]
v_pk_fma_f32 v[60:61], v[60:61], v[172:173], v[168:169] neg_lo:[0,0,1] neg_hi:[0,0,1]
v_pk_fma_f32 v[62:63], v[62:63], v[174:175], v[170:171] neg_lo:[0,0,1] neg_hi:[0,0,1]
v_cvt_pk_bf16_f32 v192, v48, v60
v_cvt_pk_bf16_f32 v193, v49, v61
v_cvt_pk_bf16_f32 v194, v50, v62
v_cvt_pk_bf16_f32 v195, v51, v63
buffer_store_dwordx4 v[192:195], v4, s[40:43], s48 offen offset:0 sc1
s_nop 0
s_waitcnt lgkmcnt(0)
v_pk_fma_f32 v[64:65], v[64:65], v[180:181], v[176:177] neg_lo:[0,0,1] neg_hi:[0,0,1]
v_pk_fma_f32 v[66:67], v[66:67], v[182:183], v[178:179] neg_lo:[0,0,1] neg_hi:[0,0,1]
v_pk_fma_f32 v[76:77], v[76:77], v[140:141], v[136:137] neg_lo:[0,0,1] neg_hi:[0,0,1]
v_pk_fma_f32 v[78:79], v[78:79], v[142:143], v[138:139] neg_lo:[0,0,1] neg_hi:[0,0,1]
v_cvt_pk_bf16_f32 v196, v64, v76
v_cvt_pk_bf16_f32 v197, v65, v77
v_cvt_pk_bf16_f32 v198, v66, v78
v_cvt_pk_bf16_f32 v199, v67, v79
buffer_store_dwordx4 v[196:199], v4, s[40:43], s46 offen offset:1024 sc1
v_pk_fma_f32 v[68:69], v[68:69], v[180:181], v[176:177] neg_lo:[0,0,1] neg_hi:[0,0,1]
v_pk_fma_f32 v[70:71], v[70:71], v[182:183], v[178:179] neg_lo:[0,0,1] neg_hi:[0,0,1]
v_pk_fma_f32 v[80:81], v[80:81], v[140:141], v[136:137] neg_lo:[0,0,1] neg_hi:[0,0,1]
v_pk_fma_f32 v[82:83], v[82:83], v[142:143], v[138:139] neg_lo:[0,0,1] neg_hi:[0,0,1]
v_cvt_pk_bf16_f32 v200, v68, v80
v_cvt_pk_bf16_f32 v201, v69, v81
v_cvt_pk_bf16_f32 v202, v70, v82
v_cvt_pk_bf16_f32 v203, v71, v83
buffer_store_dwordx4 v[200:203], v4, s[40:43], s47 offen offset:1024 sc1
v_pk_fma_f32 v[72:73], v[72:73], v[180:181], v[176:177] neg_lo:[0,0,1] neg_hi:[0,0,1]
v_pk_fma_f32 v[74:75], v[74:75], v[182:183], v[178:179] neg_lo:[0,0,1] neg_hi:[0,0,1]
v_pk_fma_f32 v[84:85], v[84:85], v[140:141], v[136:137] neg_lo:[0,0,1] neg_hi:[0,0,1]
v_pk_fma_f32 v[86:87], v[86:87], v[142:143], v[138:139] neg_lo:[0,0,1] neg_hi:[0,0,1]
v_cvt_pk_bf16_f32 v204, v72, v84
v_cvt_pk_bf16_f32 v205, v73, v85
v_cvt_pk_bf16_f32 v206, v74, v86
v_cvt_pk_bf16_f32 v207, v75, v87
buffer_store_dwordx4 v[204:207], v4, s[40:43], s48 offen offset:1024 sc1
s_add_u32 m0, s60, 32768
s_add_u32 s3, s64, 262144
buffer_load_dwordx4 v39, s[12:15], s3 offen lds
s_add_u32 m0, s60, 36864
s_add_u32 s3, s64, 294912
buffer_load_dwordx4 v39, s[12:15], s3 offen lds
s_add_u32 m0, s60, 40960
s_add_u32 s3, s64, 327680
buffer_load_dwordx4 v39, s[12:15], s3 offen lds
s_add_u32 m0, s60, 45056
s_add_u32 s3, s64, 360448
buffer_load_dwordx4 v39, s[12:15], s3 offen lds
s_add_u32 m0, s60, 49152
s_add_u32 s3, s64, 393216
buffer_load_dwordx4 v39, s[12:15], s3 offen lds
s_add_u32 m0, s60, 53248
s_add_u32 s3, s64, 425984
buffer_load_dwordx4 v39, s[12:15], s3 offen lds
s_add_u32 m0, s60, 57344
s_add_u32 s3, s64, 458752
buffer_load_dwordx4 v39, s[12:15], s3 offen lds
s_add_u32 m0, s60, 61440
s_add_u32 s3, s64, 491520
buffer_load_dwordx4 v39, s[12:15], s3 offen lds
v_xor_b32 v235, 1024, v235
ds_read_b128 v[160:163], v235 offset:256
ds_read_b128 v[164:167], v235 offset:320
ds_read_b128 v[168:171], v235 offset:384
s_nop 0
s_waitcnt lgkmcnt(0)
v_pk_add_f32 v[148:149], v[148:149], v[160:161]
v_pk_add_f32 v[150:151], v[150:151], v[162:163]
v_pk_add_f32 v[152:153], v[152:153], v[164:165]
v_pk_add_f32 v[154:155], v[154:155], v[166:167]
v_pk_add_f32 v[156:157], v[156:157], v[168:169]
v_pk_add_f32 v[158:159], v[158:159], v[170:171]
v_pk_fma_f32 v[88:89], v[208:209], v[148:149], v[88:89] op_sel_hi:[0,1,1] neg_lo:[1,0,0] neg_hi:[1,0,0]
ds_read_b128 a[192:195], v224 offset:16384
v_pk_fma_f32 v[90:91], v[208:209], v[150:151], v[90:91] op_sel_hi:[0,1,1] neg_lo:[1,0,0] neg_hi:[1,0,0]
v_pk_mul_f32 v[88:89], v[88:89], v[208:209] op_sel:[0,1] op_sel_hi:[1,1]
ds_read_b128 a[196:199], v225 offset:16384
v_pk_mul_f32 v[90:91], v[90:91], v[208:209] op_sel:[0,1] op_sel_hi:[1,1]
v_pk_fma_f32 v[92:93], v[208:209], v[152:153], v[92:93] op_sel_hi:[0,1,1] neg_lo:[1,0,0] neg_hi:[1,0,0]
ds_read_b128 a[200:203], v226 offset:16384
v_pk_fma_f32 v[94:95], v[208:209], v[154:155], v[94:95] op_sel_hi:[0,1,1] neg_lo:[1,0,0] neg_hi:[1,0,0]
v_pk_mul_f32 v[92:93], v[92:93], v[208:209] op_sel:[0,1] op_sel_hi:[1,1]
ds_read_b128 a[204:207], v227 offset:16384
v_pk_mul_f32 v[94:95], v[94:95], v[208:209] op_sel:[0,1] op_sel_hi:[1,1]
v_pk_fma_f32 v[96:97], v[208:209], v[156:157], v[96:97] op_sel_hi:[0,1,1] neg_lo:[1,0,0] neg_hi:[1,0,0]
v_pk_fma_f32 v[98:99], v[208:209], v[158:159], v[98:99] op_sel_hi:[0,1,1] neg_lo:[1,0,0] neg_hi:[1,0,0]
v_pk_mul_f32 v[96:97], v[96:97], v[208:209] op_sel:[0,1] op_sel_hi:[1,1]
v_pk_mul_f32 v[98:99], v[98:99], v[208:209] op_sel:[0,1] op_sel_hi:[1,1]
v_pk_fma_f32 v[100:101], v[210:211], v[148:149], v[100:101] op_sel_hi:[0,1,1] neg_lo:[1,0,0] neg_hi:[1,0,0]
v_pk_fma_f32 v[102:103], v[210:211], v[150:151], v[102:103] op_sel_hi:[0,1,1] neg_lo:[1,0,0] neg_hi:[1,0,0]
v_pk_mul_f32 v[100:101], v[100:101], v[210:211] op_sel:[0,1] op_sel_hi:[1,1]
ds_read_b128 a[208:211], v224 offset:32768
v_pk_mul_f32 v[102:103], v[102:103], v[210:211] op_sel:[0,1] op_sel_hi:[1,1]
v_pk_fma_f32 v[104:105], v[210:211], v[152:153], v[104:105] op_sel_hi:[0,1,1] neg_lo:[1,0,0] neg_hi:[1,0,0]
ds_read_b128 a[212:215], v225 offset:32768
v_pk_fma_f32 v[106:107], v[210:211], v[154:155], v[106:107] op_sel_hi:[0,1,1] neg_lo:[1,0,0] neg_hi:[1,0,0]
v_pk_mul_f32 v[104:105], v[104:105], v[210:211] op_sel:[0,1] op_sel_hi:[1,1]
ds_read_b128 a[216:219], v226 offset:32768
v_pk_mul_f32 v[106:107], v[106:107], v[210:211] op_sel:[0,1] op_sel_hi:[1,1]
v_pk_fma_f32 v[108:109], v[210:211], v[156:157], v[108:109] op_sel_hi:[0,1,1] neg_lo:[1,0,0] neg_hi:[1,0,0]
ds_read_b128 a[220:223], v227 offset:32768
v_pk_fma_f32 v[110:111], v[210:211], v[158:159], v[110:111] op_sel_hi:[0,1,1] neg_lo:[1,0,0] neg_hi:[1,0,0]
v_pk_mul_f32 v[108:109], v[108:109], v[210:211] op_sel:[0,1] op_sel_hi:[1,1]
v_pk_mul_f32 v[110:111], v[110:111], v[210:211] op_sel:[0,1] op_sel_hi:[1,1]
v_pk_fma_f32 v[112:113], v[212:213], v[148:149], v[112:113] op_sel_hi:[0,1,1] neg_lo:[1,0,0] neg_hi:[1,0,0]
v_pk_fma_f32 v[114:115], v[212:213], v[150:151], v[114:115] op_sel_hi:[0,1,1] neg_lo:[1,0,0] neg_hi:[1,0,0]
v_pk_mul_f32 v[112:113], v[112:113], v[212:213] op_sel:[0,1] op_sel_hi:[1,1]
v_pk_mul_f32 v[114:115], v[114:115], v[212:213] op_sel:[0,1] op_sel_hi:[1,1]
v_pk_fma_f32 v[116:117], v[212:213], v[152:153], v[116:117] op_sel_hi:[0,1,1] neg_lo:[1,0,0] neg_hi:[1,0,0]
s_nop 0
s_waitcnt vmcnt(18)
ds_read_b128 a[224:227], v224 offset:49152
v_pk_fma_f32 v[118:119], v[212:213], v[154:155], v[118:119] op_sel_hi:[0,1,1] neg_lo:[1,0,0] neg_hi:[1,0,0]
v_pk_mul_f32 v[116:117], v[116:117], v[212:213] op_sel:[0,1] op_sel_hi:[1,1]
ds_read_b128 a[228:231], v225 offset:49152
v_pk_mul_f32 v[118:119], v[118:119], v[212:213] op_sel:[0,1] op_sel_hi:[1,1]
v_pk_fma_f32 v[120:121], v[212:213], v[156:157], v[120:121] op_sel_hi:[0,1,1] neg_lo:[1,0,0] neg_hi:[1,0,0]
ds_read_b128 a[232:235], v226 offset:49152
v_pk_fma_f32 v[122:123], v[212:213], v[158:159], v[122:123] op_sel_hi:[0,1,1] neg_lo:[1,0,0] neg_hi:[1,0,0]
v_pk_mul_f32 v[120:121], v[120:121], v[212:213] op_sel:[0,1] op_sel_hi:[1,1]
ds_read_b128 a[236:239], v227 offset:49152
v_pk_mul_f32 v[122:123], v[122:123], v[212:213] op_sel:[0,1] op_sel_hi:[1,1]
v_pk_fma_f32 v[124:125], v[214:215], v[148:149], v[124:125] op_sel_hi:[0,1,1] neg_lo:[1,0,0] neg_hi:[1,0,0]
v_pk_fma_f32 v[126:127], v[214:215], v[150:151], v[126:127] op_sel_hi:[0,1,1] neg_lo:[1,0,0] neg_hi:[1,0,0]
v_pk_mul_f32 v[124:125], v[124:125], v[214:215] op_sel:[0,1] op_sel_hi:[1,1]
v_pk_mul_f32 v[126:127], v[126:127], v[214:215] op_sel:[0,1] op_sel_hi:[1,1]
v_pk_fma_f32 v[128:129], v[214:215], v[152:153], v[128:129] op_sel_hi:[0,1,1] neg_lo:[1,0,0] neg_hi:[1,0,0]
v_pk_fma_f32 v[130:131], v[214:215], v[154:155], v[130:131] op_sel_hi:[0,1,1] neg_lo:[1,0,0] neg_hi:[1,0,0]
v_pk_mul_f32 v[128:129], v[128:129], v[214:215] op_sel:[0,1] op_sel_hi:[1,1]
s_waitcnt vmcnt(14)
ds_read_b128 a[240:243], v220 offset:0
v_pk_mul_f32 v[130:131], v[130:131], v[214:215] op_sel:[0,1] op_sel_hi:[1,1]
v_pk_fma_f32 v[132:133], v[214:215], v[156:157], v[132:133] op_sel_hi:[0,1,1] neg_lo:[1,0,0] neg_hi:[1,0,0]
ds_read_b128 a[244:247], v221 offset:0
v_pk_fma_f32 v[134:135], v[214:215], v[158:159], v[134:135] op_sel_hi:[0,1,1] neg_lo:[1,0,0] neg_hi:[1,0,0]
v_pk_mul_f32 v[132:133], v[132:133], v[214:215] op_sel:[0,1] op_sel_hi:[1,1]
ds_read_b128 a[248:251], v222 offset:0
v_pk_mul_f32 v[134:135], v[134:135], v[214:215] op_sel:[0,1] op_sel_hi:[1,1]
ds_read_b128 a[252:255], v223 offset:0
s_waitcnt vmcnt(8) lgkmcnt(0)
s_barrier
s_mov_b64 exec, 1
buffer_store_dword v3, off, s[36:39], s93 offset:0 sc1
s_mov_b64 exec, -1
v_pk_mul_f32 v[160:161], v[88:89], v[88:89]
v_pk_mul_f32 v[162:163], v[90:91], v[90:91]
v_pk_mul_f32 v[164:165], v[92:93], v[92:93]
v_pk_mul_f32 v[166:167], v[94:95], v[94:95]
v_pk_mul_f32 v[168:169], v[96:97], v[96:97]
v_pk_mul_f32 v[170:171], v[98:99], v[98:99]
v_pk_mul_f32 v[172:173], v[100:101], v[100:101]
s_add_u32 m0, s60, 0
s_add_u32 s3, s64, 0
s_nop 0
buffer_load_dwordx4 v39, s[12:15], s3 offen lds
v_pk_mul_f32 v[174:175], v[102:103], v[102:103]
v_pk_mul_f32 v[176:177], v[104:105], v[104:105]
v_pk_mul_f32 v[178:179], v[106:107], v[106:107]
v_pk_mul_f32 v[180:181], v[108:109], v[108:109]
v_pk_mul_f32 v[182:183], v[110:111], v[110:111]
v_pk_fma_f32 v[160:161], v[160:161], s[94:95], s[94:95] op_sel:[0,1,0] op_sel_hi:[1,1,0]
v_pk_fma_f32 v[162:163], v[162:163], s[94:95], s[94:95] op_sel:[0,1,0] op_sel_hi:[1,1,0]
v_pk_fma_f32 v[164:165], v[164:165], s[94:95], s[94:95] op_sel:[0,1,0] op_sel_hi:[1,1,0]
v_pk_fma_f32 v[166:167], v[166:167], s[94:95], s[94:95] op_sel:[0,1,0] op_sel_hi:[1,1,0]
v_pk_fma_f32 v[168:169], v[168:169], s[94:95], s[94:95] op_sel:[0,1,0] op_sel_hi:[1,1,0]
v_pk_fma_f32 v[170:171], v[170:171], s[94:95], s[94:95] op_sel:[0,1,0] op_sel_hi:[1,1,0]
v_pk_fma_f32 v[172:173], v[172:173], s[94:95], s[94:95] op_sel:[0,1,0] op_sel_hi:[1,1,0]
s_add_u32 m0, s60, 4096
s_add_u32 s3, s64, 32768
buffer_load_dwordx4 v39, s[12:15], s3 offen lds
v_pk_fma_f32 v[174:175], v[174:175], s[94:95], s[94:95] op_sel:[0,1,0] op_sel_hi:[1,1,0]
v_pk_fma_f32 v[176:177], v[176:177], s[94:95], s[94:95] op_sel:[0,1,0] op_sel_hi:[1,1,0]
v_pk_fma_f32 v[178:179], v[178:179], s[94:95], s[94:95] op_sel:[0,1,0] op_sel_hi:[1,1,0]
v_pk_fma_f32 v[180:181], v[180:181], s[94:95], s[94:95] op_sel:[0,1,0] op_sel_hi:[1,1,0]
v_pk_fma_f32 v[182:183], v[182:183], s[94:95], s[94:95] op_sel:[0,1,0] op_sel_hi:[1,1,0]
v_pk_mul_f32 v[160:161], v[160:161], v[88:89]
v_pk_mul_f32 v[162:163], v[162:163], v[90:91]
v_pk_mul_f32 v[164:165], v[164:165], v[92:93]
v_pk_mul_f32 v[166:167], v[166:167], v[94:95]
v_pk_mul_f32 v[168:169], v[168:169], v[96:97]
v_pk_mul_f32 v[170:171], v[170:171], v[98:99]
v_pk_mul_f32 v[172:173], v[172:173], v[100:101]
s_add_u32 m0, s60, 8192
s_add_u32 s3, s64, 65536
buffer_load_dwordx4 v39, s[12:15], s3 offen lds
v_pk_mul_f32 v[174:175], v[174:175], v[102:103]
v_pk_mul_f32 v[176:177], v[176:177], v[104:105]
v_pk_mul_f32 v[178:179], v[178:179], v[106:107]
v_pk_mul_f32 v[180:181], v[180:181], v[108:109]
v_pk_mul_f32 v[182:183], v[182:183], v[110:111]
v_exp_f32 v160, v160
v_exp_f32 v161, v161
v_exp_f32 v162, v162
v_exp_f32 v163, v163
v_exp_f32 v164, v164
v_exp_f32 v165, v165
v_exp_f32_e64 v166, v166
s_add_u32 m0, s60, 12288
s_add_u32 s3, s64, 98304
buffer_load_dwordx4 v39, s[12:15], s3 offen lds
v_exp_f32 v167, v167
v_exp_f32 v168, v168
v_exp_f32 v169, v169
v_exp_f32 v170, v170
v_exp_f32 v171, v171
v_exp_f32 v172, v172
v_exp_f32 v173, v173
v_exp_f32 v174, v174
v_exp_f32 v175, v175
v_exp_f32 v176, v176
v_exp_f32 v177, v177
v_exp_f32 v178, v178
s_add_u32 m0, s60, 16384
s_add_u32 s3, s64, 131072
buffer_load_dwordx4 v39, s[12:15], s3 offen lds
v_exp_f32 v179, v179
v_exp_f32 v180, v180
v_exp_f32 v181, v181
v_exp_f32 v182, v182
v_exp_f32_e64 v183, v183
v_pk_add_f32 v[160:161], v[160:161], 1.0 op_sel_hi:[1,0]
v_pk_add_f32 v[162:163], v[162:163], 1.0 op_sel_hi:[1,0]
v_pk_add_f32 v[164:165], v[164:165], 1.0 op_sel_hi:[1,0]
v_pk_add_f32 v[166:167], v[166:167], 1.0 op_sel_hi:[1,0]
v_pk_add_f32 v[168:169], v[168:169], 1.0 op_sel_hi:[1,0]
v_pk_add_f32 v[170:171], v[170:171], 1.0 op_sel_hi:[1,0]
v_pk_add_f32 v[172:173], v[172:173], 1.0 op_sel_hi:[1,0]
s_add_u32 m0, s60, 20480
s_add_u32 s3, s64, 163840
buffer_load_dwordx4 v39, s[12:15], s3 offen lds
v_pk_add_f32 v[174:175], v[174:175], 1.0 op_sel_hi:[1,0]
v_pk_add_f32 v[176:177], v[176:177], 1.0 op_sel_hi:[1,0]
v_pk_add_f32 v[178:179], v[178:179], 1.0 op_sel_hi:[1,0]
v_pk_add_f32 v[180:181], v[180:181], 1.0 op_sel_hi:[1,0]
v_pk_add_f32 v[182:183], v[182:183], 1.0 op_sel_hi:[1,0]
v_rcp_f32 v160, v160
v_rcp_f32 v161, v161
v_rcp_f32 v162, v162
v_rcp_f32 v163, v163
v_rcp_f32 v164, v164
v_rcp_f32 v165, v165
v_rcp_f32 v166, v166
s_add_u32 m0, s60, 24576
s_add_u32 s3, s64, 196608
buffer_load_dwordx4 v39, s[12:15], s3 offen lds
v_rcp_f32 v167, v167
v_rcp_f32 v168, v168
v_rcp_f32 v169, v169
v_rcp_f32 v170, v170
v_rcp_f32 v171, v171
v_rcp_f32 v172, v172
v_rcp_f32 v173, v173
v_rcp_f32 v174, v174
v_rcp_f32 v175, v175
v_rcp_f32 v176, v176
v_rcp_f32 v177, v177
s_add_u32 m0, s60, 28672
s_add_u32 s3, s64, 229376
buffer_load_dwordx4 v39, s[12:15], s3 offen lds
v_rcp_f32 v178, v178
v_rcp_f32 v179, v179
v_rcp_f32 v180, v180
v_rcp_f32 v181, v181
v_rcp_f32 v182, v182
v_rcp_f32 v183, v183
v_pk_mul_f32 v[88:89], v[160:161], v[88:89]
v_pk_mul_f32 v[90:91], v[162:163], v[90:91]
v_pk_mul_f32 v[92:93], v[164:165], v[92:93]
v_pk_mul_f32 v[94:95], v[166:167], v[94:95]
v_pk_mul_f32 v[96:97], v[168:169], v[96:97]
v_pk_mul_f32 v[98:99], v[170:171], v[98:99]
s_add_u32 m0, s60, 90112
s_add_u32 s3, s64, 0
s_nop 0
buffer_load_dwordx4 v39, s[28:31], s3 offen lds
v_pk_mul_f32 v[100:101], v[172:173], v[100:101]
v_pk_mul_f32 v[102:103], v[174:175], v[102:103]
v_pk_mul_f32 v[104:105], v[176:177], v[104:105]
v_pk_mul_f32 v[106:107], v[178:179], v[106:107]
v_pk_mul_f32 v[108:109], v[180:181], v[108:109]
v_pk_mul_f32 v[110:111], v[182:183], v[110:111]
v_cvt_pk_bf16_f32 v184, v88, v89
v_cvt_pk_bf16_f32 v185, v90, v91
v_cvt_pk_bf16_f32 v186, v92, v93
v_cvt_pk_bf16_f32 v187, v94, v95
v_cvt_pk_bf16_f32 v192, v96, v97
v_cvt_pk_bf16_f32 v193, v98, v99
s_add_u32 m0, s60, 94208
s_add_u32 s3, s64, 98304
buffer_load_dwordx4 v39, s[28:31], s3 offen lds
v_cvt_pk_bf16_f32 v188, v100, v101
v_cvt_pk_bf16_f32 v189, v102, v103
v_cvt_pk_bf16_f32 v190, v104, v105
v_cvt_pk_bf16_f32 v191, v106, v107
v_cvt_pk_bf16_f32 v194, v108, v109
v_cvt_pk_bf16_f32 v195, v110, v111
buffer_store_dwordx4 v[184:187], v4, s[36:39], s16 offen offset:0 sc1
buffer_store_dwordx4 v[188:191], v4, s[36:39], s16 offen offset:1024 sc1
buffer_store_dwordx4 v[192:195], v4, s[36:39], s16 offen offset:2048 sc1
v_pk_mul_f32 v[160:161], v[112:113], v[112:113]
v_pk_mul_f32 v[162:163], v[114:115], v[114:115]
v_pk_mul_f32 v[164:165], v[116:117], v[116:117]
s_add_u32 m0, s60, 98304
s_add_u32 s3, s64, 196608
buffer_load_dwordx4 v39, s[28:31], s3 offen lds
v_pk_mul_f32 v[166:167], v[118:119], v[118:119]
v_pk_mul_f32 v[168:169], v[120:121], v[120:121]
v_pk_mul_f32 v[170:171], v[122:123], v[122:123]
v_pk_mul_f32 v[172:173], v[124:125], v[124:125]
v_pk_mul_f32 v[174:175], v[126:127], v[126:127]
v_pk_mul_f32 v[176:177], v[128:129], v[128:129]
v_pk_mul_f32 v[178:179], v[130:131], v[130:131]
v_pk_mul_f32 v[180:181], v[132:133], v[132:133]
v_pk_mul_f32 v[182:183], v[134:135], v[134:135]
v_pk_fma_f32 v[160:161], v[160:161], s[94:95], s[94:95] op_sel:[0,1,0] op_sel_hi:[1,1,0]
v_pk_fma_f32 v[162:163], v[162:163], s[94:95], s[94:95] op_sel:[0,1,0] op_sel_hi:[1,1,0]
v_pk_fma_f32 v[164:165], v[164:165], s[94:95], s[94:95] op_sel:[0,1,0] op_sel_hi:[1,1,0]
s_add_u32 m0, s60, 102400
s_add_u32 s3, s64, 294912
buffer_load_dwordx4 v39, s[28:31], s3 offen lds
v_pk_fma_f32 v[166:167], v[166:167], s[94:95], s[94:95] op_sel:[0,1,0] op_sel_hi:[1,1,0]
v_pk_fma_f32 v[168:169], v[168:169], s[94:95], s[94:95] op_sel:[0,1,0] op_sel_hi:[1,1,0]
v_pk_fma_f32 v[170:171], v[170:171], s[94:95], s[94:95] op_sel:[0,1,0] op_sel_hi:[1,1,0]
v_pk_fma_f32 v[172:173], v[172:173], s[94:95], s[94:95] op_sel:[0,1,0] op_sel_hi:[1,1,0]
v_pk_fma_f32 v[174:175], v[174:175], s[94:95], s[94:95] op_sel:[0,1,0] op_sel_hi:[1,1,0]
v_pk_fma_f32 v[176:177], v[176:177], s[94:95], s[94:95] op_sel:[0,1,0] op_sel_hi:[1,1,0]
v_pk_fma_f32 v[178:179], v[178:179], s[94:95], s[94:95] op_sel:[0,1,0] op_sel_hi:[1,1,0]
v_pk_fma_f32 v[180:181], v[180:181], s[94:95], s[94:95] op_sel:[0,1,0] op_sel_hi:[1,1,0]
v_pk_fma_f32 v[182:183], v[182:183], s[94:95], s[94:95] op_sel:[0,1,0] op_sel_hi:[1,1,0]
v_pk_mul_f32 v[160:161], v[160:161], v[112:113]
v_pk_mul_f32 v[162:163], v[162:163], v[114:115]
v_pk_mul_f32 v[164:165], v[164:165], v[116:117]
s_add_u32 m0, s60, 106496
s_add_u32 s3, s64, 393216
buffer_load_dwordx4 v39, s[28:31], s3 offen lds
v_pk_mul_f32 v[166:167], v[166:167], v[118:119]
v_pk_mul_f32 v[168:169], v[168:169], v[120:121]
v_pk_mul_f32 v[170:171], v[170:171], v[122:123]
v_pk_mul_f32 v[172:173], v[172:173], v[124:125]
v_pk_mul_f32 v[174:175], v[174:175], v[126:127]
v_pk_mul_f32 v[176:177], v[176:177], v[128:129]
v_pk_mul_f32 v[178:179], v[178:179], v[130:131]
v_pk_mul_f32 v[180:181], v[180:181], v[132:133]
v_pk_mul_f32 v[182:183], v[182:183], v[134:135]
v_exp_f32 v160, v160
v_exp_f32 v161, v161
s_add_u32 m0, s60, 110592
s_add_u32 s3, s64, 491520
buffer_load_dwordx4 v39, s[28:31], s3 offen lds
v_exp_f32 v162, v162
v_exp_f32 v163, v163
v_exp_f32 v164, v164
v_exp_f32 v165, v165
v_exp_f32 v166, v166
v_exp_f32 v167, v167
v_exp_f32 v168, v168
v_exp_f32 v169, v169
v_exp_f32 v170, v170
v_exp_f32 v171, v171
v_exp_f32 v172, v172
v_exp_f32 v173, v173
s_add_u32 m0, s60, 114688
s_add_u32 s3, s64, 589824
buffer_load_dwordx4 v39, s[28:31], s3 offen lds
v_exp_f32 v174, v174
v_exp_f32 v175, v175
v_exp_f32 v176, v176
v_exp_f32 v177, v177
v_exp_f32 v178, v178
v_exp_f32 v179, v179
v_exp_f32 v180, v180
v_exp_f32 v181, v181
v_exp_f32 v182, v182
v_exp_f32 v183, v183
v_pk_add_f32 v[160:161], v[160:161], 1.0 op_sel_hi:[1,0]
v_pk_add_f32 v[162:163], v[162:163], 1.0 op_sel_hi:[1,0]
s_add_u32 m0, s60, 118784
s_add_u32 s3, s64, 688128
buffer_load_dwordx4 v39, s[28:31], s3 offen lds
v_pk_add_f32 v[164:165], v[164:165], 1.0 op_sel_hi:[1,0]
v_pk_add_f32 v[166:167], v[166:167], 1.0 op_sel_hi:[1,0]
v_pk_add_f32 v[168:169], v[168:169], 1.0 op_sel_hi:[1,0]
v_pk_add_f32 v[170:171], v[170:171], 1.0 op_sel_hi:[1,0]
v_pk_add_f32 v[172:173], v[172:173], 1.0 op_sel_hi:[1,0]
v_pk_add_f32 v[174:175], v[174:175], 1.0 op_sel_hi:[1,0]
v_pk_add_f32 v[176:177], v[176:177], 1.0 op_sel_hi:[1,0]
v_pk_add_f32 v[178:179], v[178:179], 1.0 op_sel_hi:[1,0]
v_pk_add_f32 v[180:181], v[180:181], 1.0 op_sel_hi:[1,0]
v_pk_add_f32 v[182:183], v[182:183], 1.0 op_sel_hi:[1,0]
v_rcp_f32 v160, v160
v_rcp_f32 v161, v161
s_add_u32 m0, s60, 122880
s_add_u32 s3, s64, 32768
buffer_load_dwordx4 v39, s[28:31], s3 offen lds
v_rcp_f32 v162, v162
v_rcp_f32 v163, v163
v_rcp_f32 v164, v164
v_rcp_f32 v165, v165
v_rcp_f32 v166, v166
v_rcp_f32 v167, v167
v_rcp_f32 v168, v168
v_rcp_f32 v169, v169
v_rcp_f32 v170, v170
v_rcp_f32 v171, v171
v_rcp_f32 v172, v172
v_rcp_f32 v173, v173
s_add_u32 m0, s60, 126976
s_add_u32 s3, s64, 131072
buffer_load_dwordx4 v39, s[28:31], s3 offen lds
v_rcp_f32 v174, v174
v_rcp_f32 v175, v175
v_rcp_f32 v176, v176
v_rcp_f32 v177, v177
v_rcp_f32 v178, v178
v_rcp_f32 v179, v179
v_rcp_f32 v180, v180
v_rcp_f32 v181, v181
v_rcp_f32 v182, v182
v_rcp_f32 v183, v183
v_pk_mul_f32 v[112:113], v[160:161], v[112:113]
v_pk_mul_f32 v[114:115], v[162:163], v[114:115]
s_add_u32 m0, s60, 131072
s_add_u32 s3, s64, 229376
buffer_load_dwordx4 v39, s[28:31], s3 offen lds
v_pk_mul_f32 v[116:117], v[164:165], v[116:117]
v_pk_mul_f32 v[118:119], v[166:167], v[118:119]
v_pk_mul_f32 v[120:121], v[168:169], v[120:121]
v_pk_mul_f32 v[122:123], v[170:171], v[122:123]
v_pk_mul_f32 v[124:125], v[172:173], v[124:125]
v_pk_mul_f32 v[126:127], v[174:175], v[126:127]
v_pk_mul_f32 v[128:129], v[176:177], v[128:129]
v_pk_mul_f32 v[130:131], v[178:179], v[130:131]
v_pk_mul_f32 v[132:133], v[180:181], v[132:133]
v_pk_mul_f32 v[134:135], v[182:183], v[134:135]
v_cvt_pk_bf16_f32 v196, v112, v113
v_cvt_pk_bf16_f32 v197, v114, v115
s_add_u32 m0, s60, 135168
s_add_u32 s3, s64, 327680
buffer_load_dwordx4 v39, s[28:31], s3 offen lds
v_cvt_pk_bf16_f32 v198, v116, v117
v_cvt_pk_bf16_f32 v199, v118, v119
v_cvt_pk_bf16_f32 v204, v120, v121
v_cvt_pk_bf16_f32 v205, v122, v123
v_cvt_pk_bf16_f32 v200, v124, v125
v_cvt_pk_bf16_f32 v201, v126, v127
v_cvt_pk_bf16_f32 v202, v128, v129
v_cvt_pk_bf16_f32 v203, v130, v131
v_cvt_pk_bf16_f32 v206, v132, v133
v_cvt_pk_bf16_f32 v207, v134, v135
s_add_u32 s16, s16, 49152
buffer_store_dwordx4 v[196:199], v4, s[36:39], s16 offen offset:0 sc1
buffer_store_dwordx4 v[200:203], v4, s[36:39], s16 offen offset:1024 sc1
buffer_store_dwordx4 v[204:207], v4, s[36:39], s16 offen offset:2048 sc1
L_join:
buffer_load_dword v30, v37, s[36:39], s52 offen sc1
s_add_u32 m0, s60, 139264
s_add_u32 s3, s64, 425984
buffer_load_dwordx4 v39, s[28:31], s3 offen lds
s_add_u32 m0, s60, 143360
s_add_u32 s3, s64, 524288
buffer_load_dwordx4 v39, s[28:31], s3 offen lds
s_add_u32 m0, s60, 147456
s_add_u32 s3, s64, 622592
buffer_load_dwordx4 v39, s[28:31], s3 offen lds
s_add_u32 m0, s60, 151552
s_add_u32 s3, s64, 65536
buffer_load_dwordx4 v39, s[28:31], s3 offen lds
s_mul_i32 s74, s1, 393216
s_lshl4_add_u32 s74, s60, s74
s_add_u32 s75, s74, 65536
s_waitcnt vmcnt(4)
v_cmp_ne_u32 vcc, s69, v30
s_cbranch_vccnz L_h2_slow
L_h2_ok:
buffer_load_dwordx4 v[252:255], v4, s[40:43], s74 offen offset:0 sc1
buffer_load_dwordx4 v[248:251], v4, s[40:43], s75 offen offset:0 sc1
buffer_load_dwordx4 v[244:247], v4, s[40:43], s74 offen offset:1024 sc1
buffer_load_dwordx4 v[240:243], v4, s[40:43], s75 offen offset:1024 sc1
buffer_load_dwordx4 v[236:239], v4, s[40:43], s74 offen offset:2048 sc1
buffer_load_dwordx4 v[232:235], v4, s[40:43], s75 offen offset:2048 sc1
buffer_load_dwordx4 v[228:231], v4, s[40:43], s74 offen offset:3072 sc1
buffer_load_dwordx4 v[224:227], v4, s[40:43], s75 offen offset:3072 sc1
s_mov_b64 exec, 1
buffer_store_dword v3, off, s[36:39], s49 offset:0 sc1
s_mov_b64 exec, -1
s_xor_b32 s74, s74, 4096
buffer_load_dwordx4 v[220:223], v4, s[40:43], s74 offen offset:0 sc1
s_xor_b32 s75, s75, 4096
buffer_load_dwordx4 v[216:219], v4, s[40:43], s75 offen offset:0 sc1
buffer_load_dwordx4 v[212:215], v4, s[40:43], s74 offen offset:1024 sc1
buffer_load_dwordx4 v[208:211], v4, s[40:43], s75 offen offset:1024 sc1
v_lshlrev_b32 v8, 16, v31
v_mov_b32 v9, v8
v_mov_b32 v10, v8
v_mov_b32 v11, v8
s_lshl_b32 s97, s1, 5
s_add_u32 s97, s97, s0
s_lshl_b32 s97, s97, 8
s_add_u32 s50, s97, 13631488
v_and_b32 v29, 1, v0
v_lshlrev_b32 v29, 7, v29
s_lshr_b32 s97, s72, 1
s_lshl1_add_u32 s87, s0, s97
s_lshl3_add_u32 s87, s87, s1
s_mul_i32 s87, s87, 6144
s_add_u32 s87, s87, 10485760
s_and_b32 s97, s72, 1
s_lshl_b32 s88, s97, 10
s_add_u32 s17, s87, s88
s_lshl3_add_u32 s87, s97, s87
s_add_u32 s18, s87, 2048
s_lshl1_add_u32 s97, s0, s70
s_lshl_b32 s97, s97, 5
s_add_u32 s97, s97, s71
s_lshl3_add_u32 s97, s97, s85
s_lshl_b32 s59, s97, 7
v_lshrrev_b32 v16, 3, v0
v_lshlrev_b32 v16, 11, v16
v_and_b32 v36, 7, v0
v_lshl_add_u32 v16, v36, 4, v16
v_lshlrev_b32 v36, 7, v36
s_add_u32 s87, s84, 155648
v_lshlrev_b32 v17, 7, v1
v_lshl_add_u32 v17, v2, 3, v17
v_add_u32_e64 v17, s87, v17
s_add_u32 s87, s84, 65536
v_add_u32_e64 v23, s87, v4
v_xor_b32 v20, 2048, v23
v_xor_b32 v21, 4096, v23
v_xor_b32 v22, 6144, v23
s_lshl2_add_u32 s87, s0, s66
s_lshl_b32 s97, s87, 11
s_add_u32 s54, s97, 13893632
s_lshl_b32 s97, s87, 14
s_add_u32 s55, s97, 1048576
s_mul_i32 s97, s87, 24576
s_add_u32 s57, s97, 3145728
s_lshr_b32 s97, s0, 1
s_lshl_b32 s97, s97, 12
s_add_u32 s97, s97, s60
s_add_u32 s53, s97, 13697024
s_lshl2_add_u32 s87, s0, s72
s_lshl4_add_u32 s97, s87, s1
s_lshl_b32 s97, s97, 7
s_add_u32 s51, s97, 13893632
v_lshlrev_b32 v38, 11, v1
v_lshl_add_u32 v38, v2, 4, v38
v_bfe_u32 v24, v0, 2, 2
v_lshlrev_b32 v24, 6, v24
v_and_b32 v25, 3, v0
v_lshl_add_u32 v24, v25, 3, v24
v_lshl_add_u32 v24, v2, 9, v24
v_and_b32 v25, 1, v2
v_lshl_add_u32 v24, v25, 5, v24
v_xor_b32 v25, 32, v24
v_add_u32 v26, 90112, v24
v_add_u32 v27, 90112, v25
s_nop 0
s_waitcnt vmcnt(9)
v_mfma_f32_16x16x32_bf16 v[64:67], v[252:255], a[0:3], v[8:11]
v_mfma_f32_16x16x32_bf16 v[72:75], v[252:255], a[16:19], 0
v_mfma_f32_16x16x32_bf16 v[80:83], v[252:255], a[32:35], 0
buffer_load_dwordx4 v[204:207], v4, s[40:43], s74 offen offset:2048 sc1
v_mfma_f32_16x16x32_bf16 v[88:91], v[252:255], a[48:51], 0
v_mfma_f32_16x16x32_bf16 v[68:71], v[248:251], a[0:3], v[8:11]
v_mfma_f32_16x16x32_bf16 v[76:79], v[248:251], a[16:19], 0
v_mfma_f32_16x16x32_bf16 v[84:87], v[248:251], a[32:35], 0
buffer_load_dwordx4 v[200:203], v4, s[40:43], s75 offen offset:2048 sc1
v_mfma_f32_16x16x32_bf16 v[92:95], v[248:251], a[48:51], 0
v_mfma_f32_16x16x32_bf16 v[64:67], v[244:247], a[4:7], v[64:67]
v_mfma_f32_16x16x32_bf16 v[72:75], v[244:247], a[20:23], v[72:75]
v_mfma_f32_16x16x32_bf16 v[80:83], v[244:247], a[36:39], v[80:83]
buffer_load_dwordx4 v[196:199], v4, s[40:43], s74 offen offset:3072 sc1
v_mfma_f32_16x16x32_bf16 v[88:91], v[244:247], a[52:55], v[88:91]
v_mfma_f32_16x16x32_bf16 v[68:71], v[240:243], a[4:7], v[68:71]
v_mfma_f32_16x16x32_bf16 v[76:79], v[240:243], a[20:23], v[76:79]
v_mfma_f32_16x16x32_bf16 v[84:87], v[240:243], a[36:39], v[84:87]
buffer_load_dwordx4 v[192:195], v4, s[40:43], s75 offen offset:3072 sc1
v_mfma_f32_16x16x32_bf16 v[92:95], v[240:243], a[52:55], v[92:95]
s_nop 0
s_waitcnt vmcnt(9)
v_mfma_f32_16x16x32_bf16 v[64:67], v[236:239], a[8:11], v[64:67]
v_mfma_f32_16x16x32_bf16 v[72:75], v[236:239], a[24:27], v[72:75]
s_xor_b32 s74, s74, 12288
v_mfma_f32_16x16x32_bf16 v[80:83], v[236:239], a[40:43], v[80:83]
buffer_load_dwordx4 v[252:255], v4, s[40:43], s74 offen offset:0 sc1
v_mfma_f32_16x16x32_bf16 v[88:91], v[236:239], a[56:59], v[88:91]
v_mfma_f32_16x16x32_bf16 v[68:71], v[232:235], a[8:11], v[68:71]
v_mfma_f32_16x16x32_bf16 v[76:79], v[232:235], a[24:27], v[76:79]
s_xor_b32 s75, s75, 12288
v_mfma_f32_16x16x32_bf16 v[84:87], v[232:235], a[40:43], v[84:87]
buffer_load_dwordx4 v[248:251], v4, s[40:43], s75 offen offset:0 sc1
v_mfma_f32_16x16x32_bf16 v[92:95], v[232:235], a[56:59], v[92:95]
v_mfma_f32_16x16x32_bf16 v[64:67], v[228:231], a[12:15], v[64:67]
v_mfma_f32_16x16x32_bf16 v[72:75], v[228:231], a[28:31], v[72:75]
v_mfma_f32_16x16x32_bf16 v[80:83], v[228:231], a[44:47], v[80:83]
buffer_load_dwordx4 v[244:247], v4, s[40:43], s74 offen offset:1024 sc1
v_mfma_f32_16x16x32_bf16 v[88:91], v[228:231], a[60:63], v[88:91]
v_mfma_f32_16x16x32_bf16 v[68:71], v[224:227], a[12:15], v[68:71]
v_mfma_f32_16x16x32_bf16 v[76:79], v[224:227], a[28:31], v[76:79]
v_mfma_f32_16x16x32_bf16 v[84:87], v[224:227], a[44:47], v[84:87]
buffer_load_dwordx4 v[240:243], v4, s[40:43], s75 offen offset:1024 sc1
v_mfma_f32_16x16x32_bf16 v[92:95], v[224:227], a[60:63], v[92:95]
s_nop 0
s_waitcnt vmcnt(8)
v_mfma_f32_16x16x32_bf16 v[64:67], v[220:223], a[64:67], v[64:67]
v_mfma_f32_16x16x32_bf16 v[72:75], v[220:223], a[80:83], v[72:75]
v_mfma_f32_16x16x32_bf16 v[80:83], v[220:223], a[96:99], v[80:83]
buffer_load_dwordx4 v[236:239], v4, s[40:43], s74 offen offset:2048 sc1
v_mfma_f32_16x16x32_bf16 v[88:91], v[220:223], a[112:115], v[88:91]
v_mfma_f32_16x16x32_bf16 v[68:71], v[216:219], a[64:67], v[68:71]
v_mfma_f32_16x16x32_bf16 v[76:79], v[216:219], a[80:83], v[76:79]
v_mfma_f32_16x16x32_bf16 v[84:87], v[216:219], a[96:99], v[84:87]
buffer_load_dwordx4 v[232:235], v4, s[40:43], s75 offen offset:2048 sc1
v_mfma_f32_16x16x32_bf16 v[92:95], v[216:219], a[112:115], v[92:95]
v_mfma_f32_16x16x32_bf16 v[64:67], v[212:215], a[68:71], v[64:67]
v_mfma_f32_16x16x32_bf16 v[72:75], v[212:215], a[84:87], v[72:75]
v_mfma_f32_16x16x32_bf16 v[80:83], v[212:215], a[100:103], v[80:83]
buffer_load_dwordx4 v[228:231], v4, s[40:43], s74 offen offset:3072 sc1
v_mfma_f32_16x16x32_bf16 v[88:91], v[212:215], a[116:119], v[88:91]
v_mfma_f32_16x16x32_bf16 v[68:71], v[208:211], a[68:71], v[68:71]
v_mfma_f32_16x16x32_bf16 v[76:79], v[208:211], a[84:87], v[76:79]
v_mfma_f32_16x16x32_bf16 v[84:87], v[208:211], a[100:103], v[84:87]
buffer_load_dwordx4 v[224:227], v4, s[40:43], s75 offen offset:3072 sc1
v_mfma_f32_16x16x32_bf16 v[92:95], v[208:211], a[116:119], v[92:95]
s_nop 0
s_waitcnt vmcnt(8)
v_mfma_f32_16x16x32_bf16 v[64:67], v[204:207], a[72:75], v[64:67]
v_mfma_f32_16x16x32_bf16 v[72:75], v[204:207], a[88:91], v[72:75]
buffer_load_dword v30, v29, s[36:39], s50 offen sc1
v_mfma_f32_16x16x32_bf16 v[80:83], v[204:207], a[104:107], v[80:83]
v_mfma_f32_16x16x32_bf16 v[88:91], v[204:207], a[120:123], v[88:91]
s_xor_b32 s74, s74, 4096
v_mfma_f32_16x16x32_bf16 v[68:71], v[200:203], a[72:75], v[68:71]
buffer_load_dwordx4 v[220:223], v4, s[40:43], s74 offen offset:0 sc1
v_mfma_f32_16x16x32_bf16 v[76:79], v[200:203], a[88:91], v[76:79]
v_mfma_f32_16x16x32_bf16 v[84:87], v[200:203], a[104:107], v[84:87]
v_mfma_f32_16x16x32_bf16 v[92:95], v[200:203], a[120:123], v[92:95]
s_xor_b32 s75, s75, 4096
v_mfma_f32_16x16x32_bf16 v[64:67], v[196:199], a[76:79], v[64:67]
buffer_load_dwordx4 v[216:219], v4, s[40:43], s75 offen offset:0 sc1
v_mfma_f32_16x16x32_bf16 v[72:75], v[196:199], a[92:95], v[72:75]
v_mfma_f32_16x16x32_bf16 v[80:83], v[196:199], a[108:111], v[80:83]
v_mfma_f32_16x16x32_bf16 v[88:91], v[196:199], a[124:127], v[88:91]
buffer_load_dwordx4 v[212:215], v4, s[40:43], s74 offen offset:1024 sc1
v_mfma_f32_16x16x32_bf16 v[68:71], v[192:195], a[76:79], v[68:71]
v_mfma_f32_16x16x32_bf16 v[76:79], v[192:195], a[92:95], v[76:79]
v_mfma_f32_16x16x32_bf16 v[84:87], v[192:195], a[108:111], v[84:87]
buffer_load_dwordx4 v[208:211], v4, s[40:43], s75 offen offset:1024 sc1
v_mfma_f32_16x16x32_bf16 v[92:95], v[192:195], a[124:127], v[92:95]
s_nop 0
s_waitcnt vmcnt(9)
v_mfma_f32_16x16x32_bf16 v[64:67], v[252:255], a[128:131], v[64:67]
v_mfma_f32_16x16x32_bf16 v[72:75], v[252:255], a[144:147], v[72:75]
v_mfma_f32_16x16x32_bf16 v[80:83], v[252:255], a[160:163], v[80:83]
buffer_load_dwordx4 v[204:207], v4, s[40:43], s74 offen offset:2048 sc1
v_mfma_f32_16x16x32_bf16 v[88:91], v[252:255], a[176:179], v[88:91]
v_mfma_f32_16x16x32_bf16 v[68:71], v[248:251], a[128:131], v[68:71]
v_mfma_f32_16x16x32_bf16 v[76:79], v[248:251], a[144:147], v[76:79]
v_mfma_f32_16x16x32_bf16 v[84:87], v[248:251], a[160:163], v[84:87]
buffer_load_dwordx4 v[200:203], v4, s[40:43], s75 offen offset:2048 sc1
v_mfma_f32_16x16x32_bf16 v[92:95], v[248:251], a[176:179], v[92:95]
v_mfma_f32_16x16x32_bf16 v[64:67], v[244:247], a[132:135], v[64:67]
v_mfma_f32_16x16x32_bf16 v[72:75], v[244:247], a[148:151], v[72:75]
v_mfma_f32_16x16x32_bf16 v[80:83], v[244:247], a[164:167], v[80:83]
buffer_load_dwordx4 v[196:199], v4, s[40:43], s74 offen offset:3072 sc1
v_mfma_f32_16x16x32_bf16 v[88:91], v[244:247], a[180:183], v[88:91]
v_mfma_f32_16x16x32_bf16 v[68:71], v[240:243], a[132:135], v[68:71]
v_mfma_f32_16x16x32_bf16 v[76:79], v[240:243], a[148:151], v[76:79]
v_mfma_f32_16x16x32_bf16 v[84:87], v[240:243], a[164:167], v[84:87]
buffer_load_dwordx4 v[192:195], v4, s[40:43], s75 offen offset:3072 sc1
v_mfma_f32_16x16x32_bf16 v[92:95], v[240:243], a[180:183], v[92:95]
s_nop 0
s_waitcnt vmcnt(9)
v_mfma_f32_16x16x32_bf16 v[64:67], v[236:239], a[136:139], v[64:67]
s_xor_b32 s74, s74, 12288
v_mfma_f32_16x16x32_bf16 v[72:75], v[236:239], a[152:155], v[72:75]
s_add_u32 s74, s74, 131072
v_mfma_f32_16x16x32_bf16 v[80:83], v[236:239], a[168:171], v[80:83]
buffer_load_dwordx4 v[252:255], v4, s[40:43], s74 offen offset:0 sc1
v_mfma_f32_16x16x32_bf16 v[88:91], v[236:239], a[184:187], v[88:91]
v_mfma_f32_16x16x32_bf16 v[68:71], v[232:235], a[136:139], v[68:71]
s_xor_b32 s75, s75, 12288
v_mfma_f32_16x16x32_bf16 v[76:79], v[232:235], a[152:155], v[76:79]
s_add_u32 s75, s75, 131072
v_mfma_f32_16x16x32_bf16 v[84:87], v[232:235], a[168:171], v[84:87]
buffer_load_dwordx4 v[248:251], v4, s[40:43], s75 offen offset:0 sc1
v_mfma_f32_16x16x32_bf16 v[92:95], v[232:235], a[184:187], v[92:95]
v_mfma_f32_16x16x32_bf16 v[64:67], v[228:231], a[140:143], v[64:67]
v_mfma_f32_16x16x32_bf16 v[72:75], v[228:231], a[156:159], v[72:75]
v_mfma_f32_16x16x32_bf16 v[80:83], v[228:231], a[172:175], v[80:83]
buffer_load_dwordx4 v[244:247], v4, s[40:43], s74 offen offset:1024 sc1
v_mfma_f32_16x16x32_bf16 v[88:91], v[228:231], a[188:191], v[88:91]
v_mfma_f32_16x16x32_bf16 v[68:71], v[224:227], a[140:143], v[68:71]
v_mfma_f32_16x16x32_bf16 v[76:79], v[224:227], a[156:159], v[76:79]
v_mfma_f32_16x16x32_bf16 v[84:87], v[224:227], a[172:175], v[84:87]
buffer_load_dwordx4 v[240:243], v4, s[40:43], s75 offen offset:1024 sc1
v_mfma_f32_16x16x32_bf16 v[92:95], v[224:227], a[188:191], v[92:95]
s_waitcnt vmcnt(8)
v_cmp_ne_u32 vcc, s69, v30
s_nop 0
s_cbranch_vccnz L_h6_slow
L_h6_ok:
v_mfma_f32_16x16x32_bf16 v[64:67], v[220:223], a[192:195], v[64:67]
v_mfma_f32_16x16x32_bf16 v[72:75], v[220:223], a[208:211], v[72:75]
buffer_load_dwordx4 v[176:179], v4, s[36:39], s17 offen offset:0 sc1
v_mfma_f32_16x16x32_bf16 v[80:83], v[220:223], a[224:227], v[80:83]
v_mfma_f32_16x16x32_bf16 v[88:91], v[220:223], a[240:243], v[88:91]
v_mfma_f32_16x16x32_bf16 v[68:71], v[216:219], a[192:195], v[68:71]
buffer_load_dwordx4 v[236:239], v4, s[40:43], s74 offen offset:2048 sc1
v_mfma_f32_16x16x32_bf16 v[76:79], v[216:219], a[208:211], v[76:79]
v_mfma_f32_16x16x32_bf16 v[84:87], v[216:219], a[224:227], v[84:87]
buffer_load_dwordx2 v[180:181], v4, s[36:39], s18 offen offset:0 sc1
v_mfma_f32_16x16x32_bf16 v[92:95], v[216:219], a[240:243], v[92:95]
v_mfma_f32_16x16x32_bf16 v[64:67], v[212:215], a[196:199], v[64:67]
v_mfma_f32_16x16x32_bf16 v[72:75], v[212:215], a[212:215], v[72:75]
buffer_load_dwordx4 v[232:235], v4, s[40:43], s75 offen offset:2048 sc1
v_mfma_f32_16x16x32_bf16 v[80:83], v[212:215], a[228:231], v[80:83]
v_mfma_f32_16x16x32_bf16 v[88:91], v[212:215], a[244:247], v[88:91]
v_mfma_f32_16x16x32_bf16 v[68:71], v[208:211], a[196:199], v[68:71]
buffer_load_dwordx4 v[228:231], v4, s[40:43], s74 offen offset:3072 sc1
v_mfma_f32_16x16x32_bf16 v[76:79], v[208:211], a[212:215], v[76:79]
v_mfma_f32_16x16x32_bf16 v[84:87], v[208:211], a[228:231], v[84:87]
buffer_load_dwordx4 v[224:227], v4, s[40:43], s75 offen offset:3072 sc1
v_mfma_f32_16x16x32_bf16 v[92:95], v[208:211], a[244:247], v[92:95]
s_nop 0
s_waitcnt vmcnt(10)
v_mfma_f32_16x16x32_bf16 v[64:67], v[204:207], a[200:203], v[64:67]
v_mfma_f32_16x16x32_bf16 v[72:75], v[204:207], a[216:219], v[72:75]
buffer_load_dwordx4 v[182:185], v4, s[36:39], s17 offen offset:3072 sc1
v_mfma_f32_16x16x32_bf16 v[80:83], v[204:207], a[232:235], v[80:83]
v_mfma_f32_16x16x32_bf16 v[88:91], v[204:207], a[248:251], v[88:91]
s_xor_b32 s74, s74, 4096
v_mfma_f32_16x16x32_bf16 v[68:71], v[200:203], a[200:203], v[68:71]
buffer_load_dwordx4 v[220:223], v4, s[40:43], s74 offen offset:0 sc1
v_mfma_f32_16x16x32_bf16 v[76:79], v[200:203], a[216:219], v[76:79]
v_mfma_f32_16x16x32_bf16 v[84:87], v[200:203], a[232:235], v[84:87]
buffer_load_dwordx2 v[186:187], v4, s[36:39], s18 offen offset:3072 sc1
v_mfma_f32_16x16x32_bf16 v[92:95], v[200:203], a[248:251], v[92:95]
v_mfma_f32_16x16x32_bf16 v[64:67], v[196:199], a[204:207], v[64:67]
s_xor_b32 s75, s75, 4096
v_mfma_f32_16x16x32_bf16 v[72:75], v[196:199], a[220:223], v[72:75]
buffer_load_dwordx4 v[216:219], v4, s[40:43], s75 offen offset:0 sc1
v_mfma_f32_16x16x32_bf16 v[80:83], v[196:199], a[236:239], v[80:83]
v_mfma_f32_16x16x32_bf16 v[88:91], v[196:199], a[252:255], v[88:91]
v_mfma_f32_16x16x32_bf16 v[68:71], v[192:195], a[204:207], v[68:71]
buffer_load_dwordx4 v[212:215], v4, s[40:43], s74 offen offset:1024 sc1
v_mfma_f32_16x16x32_bf16 v[76:79], v[192:195], a[220:223], v[76:79]
v_mfma_f32_16x16x32_bf16 v[84:87], v[192:195], a[236:239], v[84:87]
buffer_load_dwordx4 v[208:211], v4, s[40:43], s75 offen offset:1024 sc1
v_mfma_f32_16x16x32_bf16 v[92:95], v[192:195], a[252:255], v[92:95]
s_nop 0
s_waitcnt vmcnt(12)
v_mfma_f32_16x16x32_bf16 v[96:99], v[252:255], a[0:3], v[8:11]
v_mfma_f32_16x16x32_bf16 v[104:107], v[252:255], a[16:19], 0
v_mfma_f32_16x16x32_bf16 v[112:115], v[252:255], a[32:35], 0
buffer_load_dwordx4 v[204:207], v4, s[40:43], s74 offen offset:2048 sc1
v_mfma_f32_16x16x32_bf16 v[120:123], v[252:255], a[48:51], 0
ds_write_b128 v20, v[72:75] offset:0
v_mfma_f32_16x16x32_bf16 v[100:103], v[248:251], a[0:3], v[8:11]
v_mfma_f32_16x16x32_bf16 v[108:111], v[248:251], a[16:19], 0
v_mfma_f32_16x16x32_bf16 v[116:119], v[248:251], a[32:35], 0
buffer_load_dwordx4 v[200:203], v4, s[40:43], s75 offen offset:2048 sc1
v_mfma_f32_16x16x32_bf16 v[124:127], v[248:251], a[48:51], 0
v_mfma_f32_16x16x32_bf16 v[96:99], v[244:247], a[4:7], v[96:99]
ds_write_b128 v20, v[76:79] offset:1024
v_mfma_f32_16x16x32_bf16 v[104:107], v[244:247], a[20:23], v[104:107]
v_mfma_f32_16x16x32_bf16 v[112:115], v[244:247], a[36:39], v[112:115]
buffer_load_dwordx4 v[196:199], v4, s[40:43], s74 offen offset:3072 sc1
v_mfma_f32_16x16x32_bf16 v[120:123], v[244:247], a[52:55], v[120:123]
v_mfma_f32_16x16x32_bf16 v[100:103], v[240:243], a[4:7], v[100:103]
v_mfma_f32_16x16x32_bf16 v[108:111], v[240:243], a[20:23], v[108:111]
ds_write_b128 v21, v[80:83] offset:8192
v_mfma_f32_16x16x32_bf16 v[116:119], v[240:243], a[36:39], v[116:119]
buffer_load_dwordx4 v[192:195], v4, s[40:43], s75 offen offset:3072 sc1
v_mfma_f32_16x16x32_bf16 v[124:127], v[240:243], a[52:55], v[124:127]
s_nop 0
s_waitcnt vmcnt(10)
v_mfma_f32_16x16x32_bf16 v[96:99], v[236:239], a[8:11], v[96:99]
v_mfma_f32_16x16x32_bf16 v[104:107], v[236:239], a[24:27], v[104:107]
s_xor_b32 s74, s74, 12288
ds_write_b128 v21, v[84:87] offset:9216
v_mfma_f32_16x16x32_bf16 v[112:115], v[236:239], a[40:43], v[112:115]
buffer_load_dwordx4 v[252:255], v4, s[40:43], s74 offen offset:0 sc1
v_mfma_f32_16x16x32_bf16 v[120:123], v[236:239], a[56:59], v[120:123]
v_mfma_f32_16x16x32_bf16 v[100:103], v[232:235], a[8:11], v[100:103]
v_mfma_f32_16x16x32_bf16 v[108:111], v[232:235], a[24:27], v[108:111]
s_xor_b32 s75, s75, 12288
v_mfma_f32_16x16x32_bf16 v[116:119], v[232:235], a[40:43], v[116:119]
buffer_load_dwordx4 v[248:251], v4, s[40:43], s75 offen offset:0 sc1
v_mfma_f32_16x16x32_bf16 v[124:127], v[232:235], a[56:59], v[124:127]
ds_write_b128 v22, v[88:91] offset:16384
v_mfma_f32_16x16x32_bf16 v[96:99], v[228:231], a[12:15], v[96:99]
v_mfma_f32_16x16x32_bf16 v[104:107], v[228:231], a[28:31], v[104:107]
v_mfma_f32_16x16x32_bf16 v[112:115], v[228:231], a[44:47], v[112:115]
buffer_load_dwordx4 v[244:247], v4, s[40:43], s74 offen offset:1024 sc1
v_mfma_f32_16x16x32_bf16 v[120:123], v[228:231], a[60:63], v[120:123]
ds_write_b128 v22, v[92:95] offset:17408
v_mfma_f32_16x16x32_bf16 v[100:103], v[224:227], a[12:15], v[100:103]
v_mfma_f32_16x16x32_bf16 v[108:111], v[224:227], a[28:31], v[108:111]
v_mfma_f32_16x16x32_bf16 v[116:119], v[224:227], a[44:47], v[116:119]
buffer_load_dwordx4 v[240:243], v4, s[40:43], s75 offen offset:1024 sc1
v_mfma_f32_16x16x32_bf16 v[124:127], v[224:227], a[60:63], v[124:127]
s_waitcnt vmcnt(8)
s_waitcnt lgkmcnt(0)
s_barrier
v_mfma_f32_16x16x32_bf16 v[96:99], v[220:223], a[64:67], v[96:99]
ds_read_b128 v[72:75], v23 offset:0
v_mfma_f32_16x16x32_bf16 v[104:107], v[220:223], a[80:83], v[104:107]
v_lshlrev_b32 v40, 16, v176
v_mfma_f32_16x16x32_bf16 v[112:115], v[220:223], a[96:99], v[112:115]
buffer_load_dwordx4 v[236:239], v4, s[40:43], s74 offen offset:2048 sc1
v_mfma_f32_16x16x32_bf16 v[120:123], v[220:223], a[112:115], v[120:123]
ds_read_b128 v[80:83], v23 offset:8192
v_and_b32 v41, 0xffff0000, v176
v_mfma_f32_16x16x32_bf16 v[100:103], v[216:219], a[64:67], v[100:103]
ds_read_b128 v[88:91], v23 offset:16384
v_lshlrev_b32_e64 v42, 16, v177
v_mfma_f32_16x16x32_bf16 v[108:111], v[216:219], a[80:83], v[108:111]
v_and_b32 v43, 0xffff0000, v177
v_mfma_f32_16x16x32_bf16 v[116:119], v[216:219], a[96:99], v[116:119]
buffer_load_dwordx4 v[232:235], v4, s[40:43], s75 offen offset:2048 sc1
v_mfma_f32_16x16x32_bf16 v[124:127], v[216:219], a[112:115], v[124:127]
ds_read_b128 v[76:79], v23 offset:1024
v_lshlrev_b32_e64 v44, 16, v178
v_mfma_f32_16x16x32_bf16 v[96:99], v[212:215], a[68:71], v[96:99]
ds_read_b128 v[84:87], v23 offset:9216
v_and_b32 v45, 0xffff0000, v178
v_mfma_f32_16x16x32_bf16 v[104:107], v[212:215], a[84:87], v[104:107]
v_lshlrev_b32_e64 v46, 16, v179
v_and_b32 v47, 0xffff0000, v179
v_mfma_f32_16x16x32_bf16 v[112:115], v[212:215], a[100:103], v[112:115]
buffer_load_dwordx4 v[228:231], v4, s[40:43], s74 offen offset:3072 sc1
v_mfma_f32_16x16x32_bf16 v[120:123], v[212:215], a[116:119], v[120:123]
ds_read_b128 v[92:95], v23 offset:17408
v_mfma_f32_16x16x32_bf16 v[100:103], v[208:211], a[68:71], v[100:103]
v_lshlrev_b32_e64 v48, 16, v180
v_and_b32 v49, 0xffff0000, v180
v_mfma_f32_16x16x32_bf16 v[108:111], v[208:211], a[84:87], v[108:111]
v_lshlrev_b32_e64 v50, 16, v181
v_mfma_f32_16x16x32_bf16 v[116:119], v[208:211], a[100:103], v[116:119]
buffer_load_dwordx4 v[224:227], v4, s[40:43], s75 offen offset:3072 sc1
v_mfma_f32_16x16x32_bf16 v[124:127], v[208:211], a[116:119], v[124:127]
v_and_b32 v51, 0xffff0000, v181
v_lshlrev_b32 v52, 16, v182
s_waitcnt vmcnt(8)
v_mfma_f32_16x16x32_bf16 v[96:99], v[204:207], a[72:75], v[96:99]
s_waitcnt lgkmcnt(0)
v_add_f32 v64, v64, v72
v_and_b32 v53, 0xffff0000, v182
v_mfma_f32_16x16x32_bf16 v[104:107], v[204:207], a[88:91], v[104:107]
s_xor_b32 s74, s74, 4096
v_add_f32 v65, v65, v73
v_mfma_f32_16x16x32_bf16 v[112:115], v[204:207], a[104:107], v[112:115]
buffer_load_dwordx4 v[220:223], v4, s[40:43], s74 offen offset:0 sc1
v_lshlrev_b32 v54, 16, v183
v_mfma_f32_16x16x32_bf16 v[120:123], v[204:207], a[120:123], v[120:123]
v_add_f32 v66, v66, v74
v_and_b32 v55, 0xffff0000, v183
v_mfma_f32_16x16x32_bf16 v[100:103], v[200:203], a[72:75], v[100:103]
v_add_f32 v67, v67, v75
v_add_f32_e64 v68, v68, v76
v_mfma_f32_16x16x32_bf16 v[108:111], v[200:203], a[88:91], v[108:111]
s_xor_b32 s75, s75, 4096
v_add_f32 v69, v69, v77
v_lshlrev_b32 v56, 16, v184
v_mfma_f32_16x16x32_bf16 v[116:119], v[200:203], a[104:107], v[116:119]
buffer_load_dwordx4 v[216:219], v4, s[40:43], s75 offen offset:0 sc1
v_and_b32 v57, 0xffff0000, v184
v_mfma_f32_16x16x32_bf16 v[124:127], v[200:203], a[120:123], v[124:127]
v_add_f32 v70, v70, v78
v_add_f32 v71, v71, v79
v_mfma_f32_16x16x32_bf16 v[96:99], v[196:199], a[76:79], v[96:99]
v_add_f32 v80, v80, v88
v_lshlrev_b32 v58, 16, v185
v_mfma_f32_16x16x32_bf16 v[104:107], v[196:199], a[92:95], v[104:107]
v_add_f32 v81, v81, v89
v_add_f32 v82, v82, v90
v_and_b32 v59, 0xffff0000, v185
v_mfma_f32_16x16x32_bf16 v[112:115], v[196:199], a[108:111], v[112:115]
buffer_load_dwordx4 v[212:215], v4, s[40:43], s74 offen offset:1024 sc1
v_lshlrev_b32_e64 v60, 16, v186
v_mfma_f32_16x16x32_bf16 v[120:123], v[196:199], a[124:127], v[120:123]
v_add_f32 v83, v83, v91
v_add_f32 v84, v84, v92
v_mfma_f32_16x16x32_bf16 v[100:103], v[192:195], a[76:79], v[100:103]
v_add_f32 v85, v85, v93
v_add_f32 v86, v86, v94
v_and_b32 v61, 0xffff0000, v186
v_mfma_f32_16x16x32_bf16 v[108:111], v[192:195], a[92:95], v[108:111]
v_add_f32 v87, v87, v95
v_lshlrev_b32 v62, 16, v187
v_mfma_f32_16x16x32_bf16 v[116:119], v[192:195], a[108:111], v[116:119]
buffer_load_dwordx4 v[208:211], v4, s[40:43], s75 offen offset:1024 sc1
v_mfma_f32_16x16x32_bf16 v[124:127], v[192:195], a[124:127], v[124:127]
v_add_f32 v64, v64, v80
v_add_f32 v65, v65, v81
v_and_b32 v63, 0xffff0000, v187
s_waitcnt vmcnt(8)
v_mfma_f32_16x16x32_bf16 v[96:99], v[252:255], a[128:131], v[96:99]
v_add_f32 v66, v66, v82
v_add_f32 v67, v67, v83
v_mfma_f32_16x16x32_bf16 v[104:107], v[252:255], a[144:147], v[104:107]
v_add_f32 v68, v68, v84
v_mfma_f32_16x16x32_bf16 v[112:115], v[252:255], a[160:163], v[112:115]
buffer_load_dwordx4 v[204:207], v4, s[40:43], s74 offen offset:2048 sc1
v_mfma_f32_16x16x32_bf16 v[120:123], v[252:255], a[176:179], v[120:123]
v_add_f32 v69, v69, v85
v_add_f32 v70, v70, v86
v_mfma_f32_16x16x32_bf16 v[100:103], v[248:251], a[128:131], v[100:103]
v_add_f32 v71, v71, v87
v_mfma_f32_16x16x32_bf16 v[108:111], v[248:251], a[144:147], v[108:111]
v_mul_f32 v64, v64, v40
v_mul_f32_e64 v65, v65, v41
v_mfma_f32_16x16x32_bf16 v[116:119], v[248:251], a[160:163], v[116:119]
buffer_load_dwordx4 v[200:203], v4, s[40:43], s75 offen offset:2048 sc1
v_mfma_f32_16x16x32_bf16 v[124:127], v[248:251], a[176:179], v[124:127]
v_mul_f32_e64 v66, v66, v42
v_mfma_f32_16x16x32_bf16 v[96:99], v[244:247], a[132:135], v[96:99]
v_mul_f32 v67, v67, v43
v_mul_f32 v68, v68, v44
v_mfma_f32_16x16x32_bf16 v[104:107], v[244:247], a[148:151], v[104:107]
v_mul_f32_e64 v69, v69, v45
v_mfma_f32_16x16x32_bf16 v[112:115], v[244:247], a[164:167], v[112:115]
buffer_load_dwordx4 v[196:199], v4, s[40:43], s74 offen offset:3072 sc1
v_mfma_f32_16x16x32_bf16 v[120:123], v[244:247], a[180:183], v[120:123]
v_mul_f32 v70, v70, v46
v_mul_f32 v71, v71, v47
v_mfma_f32_16x16x32_bf16 v[100:103], v[240:243], a[132:135], v[100:103]
v_cvt_pk_bf16_f32 v72, v64, v65
v_mfma_f32_16x16x32_bf16 v[108:111], v[240:243], a[148:151], v[108:111]
v_cvt_pk_bf16_f32 v73, v66, v67
v_cvt_pk_bf16_f32 v74, v68, v69
v_mfma_f32_16x16x32_bf16 v[116:119], v[240:243], a[164:167], v[116:119]
buffer_load_dwordx4 v[192:195], v4, s[40:43], s75 offen offset:3072 sc1
v_mfma_f32_16x16x32_bf16 v[124:127], v[240:243], a[180:183], v[124:127]
v_cvt_pk_bf16_f32 v75, v70, v71
s_nop 0
s_waitcnt vmcnt(8)
v_mfma_f32_16x16x32_bf16 v[96:99], v[236:239], a[136:139], v[96:99]
v_mfma_f32_16x16x32_bf16 v[104:107], v[236:239], a[152:155], v[104:107]
buffer_store_dwordx4 v[72:75], v4, s[36:39], s58 offen offset:0 sc1
v_mfma_f32_16x16x32_bf16 v[112:115], v[236:239], a[168:171], v[112:115]
s_xor_b32 s74, s74, 12288
v_mfma_f32_16x16x32_bf16 v[120:123], v[236:239], a[184:187], v[120:123]
s_add_u32 s74, s74, 131072
v_mfma_f32_16x16x32_bf16 v[100:103], v[232:235], a[136:139], v[100:103]
buffer_load_dwordx4 v[252:255], v4, s[40:43], s74 offen offset:0 sc1
v_mfma_f32_16x16x32_bf16 v[108:111], v[232:235], a[152:155], v[108:111]
v_mfma_f32_16x16x32_bf16 v[116:119], v[232:235], a[168:171], v[116:119]
s_xor_b32 s75, s75, 12288
v_mfma_f32_16x16x32_bf16 v[124:127], v[232:235], a[184:187], v[124:127]
s_add_u32 s75, s75, 131072
v_mfma_f32_16x16x32_bf16 v[96:99], v[228:231], a[140:143], v[96:99]
buffer_load_dwordx4 v[248:251], v4, s[40:43], s75 offen offset:0 sc1
v_mfma_f32_16x16x32_bf16 v[104:107], v[228:231], a[156:159], v[104:107]
v_mfma_f32_16x16x32_bf16 v[112:115], v[228:231], a[172:175], v[112:115]
v_mfma_f32_16x16x32_bf16 v[120:123], v[228:231], a[188:191], v[120:123]
buffer_load_dwordx4 v[244:247], v4, s[40:43], s74 offen offset:1024 sc1
v_mfma_f32_16x16x32_bf16 v[100:103], v[224:227], a[140:143], v[100:103]
v_mfma_f32_16x16x32_bf16 v[108:111], v[224:227], a[156:159], v[108:111]
v_mfma_f32_16x16x32_bf16 v[116:119], v[224:227], a[172:175], v[116:119]
buffer_load_dwordx4 v[240:243], v4, s[40:43], s75 offen offset:1024 sc1
v_mfma_f32_16x16x32_bf16 v[124:127], v[224:227], a[188:191], v[124:127]
s_nop 0
s_waitcnt vmcnt(9)
v_mfma_f32_16x16x32_bf16 v[96:99], v[220:223], a[192:195], v[96:99]
v_mfma_f32_16x16x32_bf16 v[104:107], v[220:223], a[208:211], v[104:107]
buffer_load_dword v30, v36, s[36:39], s53 offen offset:0 sc1
v_mfma_f32_16x16x32_bf16 v[112:115], v[220:223], a[224:227], v[112:115]
v_mfma_f32_16x16x32_bf16 v[120:123], v[220:223], a[240:243], v[120:123]
v_mfma_f32_16x16x32_bf16 v[100:103], v[216:219], a[192:195], v[100:103]
buffer_load_dwordx4 v[236:239], v4, s[40:43], s74 offen offset:2048 sc1
v_mfma_f32_16x16x32_bf16 v[108:111], v[216:219], a[208:211], v[108:111]
v_mfma_f32_16x16x32_bf16 v[116:119], v[216:219], a[224:227], v[116:119]
v_mfma_f32_16x16x32_bf16 v[124:127], v[216:219], a[240:243], v[124:127]
v_mfma_f32_16x16x32_bf16 v[96:99], v[212:215], a[196:199], v[96:99]
buffer_load_dwordx4 v[232:235], v4, s[40:43], s75 offen offset:2048 sc1
v_mfma_f32_16x16x32_bf16 v[104:107], v[212:215], a[212:215], v[104:107]
v_mfma_f32_16x16x32_bf16 v[112:115], v[212:215], a[228:231], v[112:115]
v_mfma_f32_16x16x32_bf16 v[120:123], v[212:215], a[244:247], v[120:123]
buffer_load_dwordx4 v[228:231], v4, s[40:43], s74 offen offset:3072 sc1
v_mfma_f32_16x16x32_bf16 v[100:103], v[208:211], a[196:199], v[100:103]
v_mfma_f32_16x16x32_bf16 v[108:111], v[208:211], a[212:215], v[108:111]
v_mfma_f32_16x16x32_bf16 v[116:119], v[208:211], a[228:231], v[116:119]
buffer_load_dwordx4 v[224:227], v4, s[40:43], s75 offen offset:3072 sc1
v_mfma_f32_16x16x32_bf16 v[124:127], v[208:211], a[244:247], v[124:127]
s_waitcnt vmcnt(10)
s_barrier
v_mfma_f32_16x16x32_bf16 v[96:99], v[204:207], a[200:203], v[96:99]
v_mfma_f32_16x16x32_bf16 v[104:107], v[204:207], a[216:219], v[104:107]
s_xor_b32 s74, s74, 4096
v_mfma_f32_16x16x32_bf16 v[112:115], v[204:207], a[232:235], v[112:115]
buffer_load_dwordx4 v[220:223], v4, s[40:43], s74 offen offset:0 sc1
v_mfma_f32_16x16x32_bf16 v[120:123], v[204:207], a[248:251], v[120:123]
v_mfma_f32_16x16x32_bf16 v[100:103], v[200:203], a[200:203], v[100:103]
v_mfma_f32_16x16x32_bf16 v[108:111], v[200:203], a[216:219], v[108:111]
s_xor_b32 s75, s75, 4096
v_mfma_f32_16x16x32_bf16 v[116:119], v[200:203], a[232:235], v[116:119]
buffer_load_dwordx4 v[216:219], v4, s[40:43], s75 offen offset:0 sc1
v_mfma_f32_16x16x32_bf16 v[124:127], v[200:203], a[248:251], v[124:127]
v_mfma_f32_16x16x32_bf16 v[96:99], v[196:199], a[204:207], v[96:99]
v_mfma_f32_16x16x32_bf16 v[104:107], v[196:199], a[220:223], v[104:107]
v_mfma_f32_16x16x32_bf16 v[112:115], v[196:199], a[236:239], v[112:115]
buffer_load_dwordx4 v[212:215], v4, s[40:43], s74 offen offset:1024 sc1
v_mfma_f32_16x16x32_bf16 v[120:123], v[196:199], a[252:255], v[120:123]
v_mfma_f32_16x16x32_bf16 v[100:103], v[192:195], a[204:207], v[100:103]
v_mfma_f32_16x16x32_bf16 v[108:111], v[192:195], a[220:223], v[108:111]
v_mfma_f32_16x16x32_bf16 v[116:119], v[192:195], a[236:239], v[116:119]
buffer_load_dwordx4 v[208:211], v4, s[40:43], s75 offen offset:1024 sc1
v_mfma_f32_16x16x32_bf16 v[124:127], v[192:195], a[252:255], v[124:127]
s_waitcnt vmcnt(9)
v_mfma_f32_16x16x32_bf16 v[64:67], v[252:255], a[0:3], v[8:11]
v_mfma_f32_16x16x32_bf16 v[72:75], v[252:255], a[16:19], 0
s_mov_b64 exec, 1
buffer_store_dword v3, off, s[36:39], s51 offset:0 sc1
s_mov_b64 exec, -1
s_nop 0
v_mfma_f32_16x16x32_bf16 v[80:83], v[252:255], a[32:35], 0
ds_write_b128 v20, v[104:107] offset:0
v_mfma_f32_16x16x32_bf16 v[88:91], v[252:255], a[48:51], 0
v_mfma_f32_16x16x32_bf16 v[68:71], v[248:251], a[0:3], v[8:11]
buffer_load_dwordx4 v[204:207], v4, s[40:43], s74 offen offset:2048 sc1
v_mfma_f32_16x16x32_bf16 v[76:79], v[248:251], a[16:19], 0
ds_write_b128 v20, v[108:111] offset:1024
v_mfma_f32_16x16x32_bf16 v[84:87], v[248:251], a[32:35], 0
ds_write_b128 v21, v[112:115] offset:8192
v_mfma_f32_16x16x32_bf16 v[92:95], v[248:251], a[48:51], 0
v_mfma_f32_16x16x32_bf16 v[64:67], v[244:247], a[4:7], v[64:67]
buffer_load_dwordx4 v[200:203], v4, s[40:43], s75 offen offset:2048 sc1
v_mfma_f32_16x16x32_bf16 v[72:75], v[244:247], a[20:23], v[72:75]
ds_write_b128 v21, v[116:119] offset:9216
v_mfma_f32_16x16x32_bf16 v[80:83], v[244:247], a[36:39], v[80:83]
v_mfma_f32_16x16x32_bf16 v[88:91], v[244:247], a[52:55], v[88:91]
buffer_load_dwordx4 v[196:199], v4, s[40:43], s74 offen offset:3072 sc1
ds_write_b128 v22, v[120:123] offset:16384
v_mfma_f32_16x16x32_bf16 v[68:71], v[240:243], a[4:7], v[68:71]
v_mfma_f32_16x16x32_bf16 v[76:79], v[240:243], a[20:23], v[76:79]
ds_write_b128 v22, v[124:127] offset:17408
v_mfma_f32_16x16x32_bf16 v[84:87], v[240:243], a[36:39], v[84:87]
buffer_load_dwordx4 v[192:195], v4, s[40:43], s75 offen offset:3072 sc1
v_mfma_f32_16x16x32_bf16 v[92:95], v[240:243], a[52:55], v[92:95]
s_waitcnt vmcnt(9)
s_waitcnt lgkmcnt(0)
s_barrier
v_cmp_ne_u32 vcc, s69, v30
s_nop 0
s_cbranch_vccnz L_h3_slow
L_h3_ok:
v_mfma_f32_16x16x32_bf16 v[64:67], v[236:239], a[8:11], v[64:67]
ds_read_b128 v[104:107], v23 offset:0
ds_read_b128 v[112:115], v23 offset:8192
v_mfma_f32_16x16x32_bf16 v[72:75], v[236:239], a[24:27], v[72:75]
buffer_load_dwordx4 v[128:131], v4, s[36:39], s55 offen offset:0 sc1
v_mfma_f32_16x16x32_bf16 v[80:83], v[236:239], a[40:43], v[80:83]
ds_read_b128 v[120:123], v23 offset:16384
ds_read_b128 v[108:111], v23 offset:1024
v_mfma_f32_16x16x32_bf16 v[88:91], v[236:239], a[56:59], v[88:91]
s_xor_b32 s74, s74, 12288
ds_read_b128 v[116:119], v23 offset:9216
v_mfma_f32_16x16x32_bf16 v[68:71], v[232:235], a[8:11], v[68:71]
buffer_load_dwordx4 v[252:255], v4, s[40:43], s74 offen offset:0 sc1
ds_read_b128 v[124:127], v23 offset:17408
v_mfma_f32_16x16x32_bf16 v[76:79], v[232:235], a[24:27], v[76:79]
v_mfma_f32_16x16x32_bf16 v[84:87], v[232:235], a[40:43], v[84:87]
v_mfma_f32_16x16x32_bf16 v[92:95], v[232:235], a[56:59], v[92:95]
s_xor_b32 s75, s75, 12288
v_mfma_f32_16x16x32_bf16 v[64:67], v[228:231], a[12:15], v[64:67]
buffer_load_dwordx4 v[248:251], v4, s[40:43], s75 offen offset:0 sc1
v_mfma_f32_16x16x32_bf16 v[72:75], v[228:231], a[28:31], v[72:75]
s_waitcnt lgkmcnt(0)
v_add_f32 v96, v96, v104
v_add_f32 v97, v97, v105
v_mfma_f32_16x16x32_bf16 v[80:83], v[228:231], a[44:47], v[80:83]
v_add_f32 v98, v98, v106
v_add_f32 v99, v99, v107
v_mfma_f32_16x16x32_bf16 v[88:91], v[228:231], a[60:63], v[88:91]
buffer_load_dwordx4 v[244:247], v4, s[40:43], s74 offen offset:1024 sc1
v_add_f32 v100, v100, v108
v_mfma_f32_16x16x32_bf16 v[68:71], v[224:227], a[12:15], v[68:71]
v_add_f32 v101, v101, v109
v_add_f32 v102, v102, v110
v_add_f32 v103, v103, v111
v_mfma_f32_16x16x32_bf16 v[76:79], v[224:227], a[28:31], v[76:79]
v_add_f32 v112, v112, v120
v_add_f32_e64 v113, v113, v121
v_mfma_f32_16x16x32_bf16 v[84:87], v[224:227], a[44:47], v[84:87]
buffer_load_dwordx4 v[240:243], v4, s[40:43], s75 offen offset:1024 sc1
v_add_f32 v114, v114, v122
v_mfma_f32_16x16x32_bf16 v[92:95], v[224:227], a[60:63], v[92:95]
v_add_f32 v115, v115, v123
v_add_f32 v116, v116, v124
v_add_f32 v117, v117, v125
s_waitcnt vmcnt(10)
v_mfma_f32_16x16x32_bf16 v[64:67], v[220:223], a[64:67], v[64:67]
v_add_f32 v118, v118, v126
v_add_f32_e64 v119, v119, v127
v_mfma_f32_16x16x32_bf16 v[72:75], v[220:223], a[80:83], v[72:75]
buffer_load_dwordx4 v[132:135], v4, s[36:39], s55 offen offset:1024 sc1
v_add_f32 v96, v96, v112
v_mfma_f32_16x16x32_bf16 v[80:83], v[220:223], a[96:99], v[80:83]
v_add_f32 v97, v97, v113
v_add_f32 v98, v98, v114
v_mfma_f32_16x16x32_bf16 v[88:91], v[220:223], a[112:115], v[88:91]
v_add_f32 v99, v99, v115
v_add_f32_e64 v100, v100, v116
v_mfma_f32_16x16x32_bf16 v[68:71], v[216:219], a[64:67], v[68:71]
buffer_load_dwordx4 v[236:239], v4, s[40:43], s74 offen offset:2048 sc1
v_add_f32 v101, v101, v117
v_mfma_f32_16x16x32_bf16 v[76:79], v[216:219], a[80:83], v[76:79]
v_add_f32 v102, v102, v118
v_add_f32_e64 v103, v103, v119
v_mfma_f32_16x16x32_bf16 v[84:87], v[216:219], a[96:99], v[84:87]
v_mul_f32 v96, v96, v48
v_mul_f32 v97, v97, v49
v_mul_f32 v98, v98, v50
v_mfma_f32_16x16x32_bf16 v[92:95], v[216:219], a[112:115], v[92:95]
v_mul_f32 v99, v99, v51
v_mul_f32 v100, v100, v52
v_mfma_f32_16x16x32_bf16 v[64:67], v[212:215], a[68:71], v[64:67]
buffer_load_dwordx4 v[232:235], v4, s[40:43], s75 offen offset:2048 sc1
v_mfma_f32_16x16x32_bf16 v[72:75], v[212:215], a[84:87], v[72:75]
v_mul_f32 v101, v101, v53
v_mul_f32 v102, v102, v54
v_mul_f32 v103, v103, v55
v_mfma_f32_16x16x32_bf16 v[80:83], v[212:215], a[100:103], v[80:83]
v_cvt_pk_bf16_f32 v104, v96, v97
v_cvt_pk_bf16_f32 v105, v98, v99
v_mfma_f32_16x16x32_bf16 v[88:91], v[212:215], a[116:119], v[88:91]
buffer_load_dwordx4 v[228:231], v4, s[40:43], s74 offen offset:3072 sc1
v_cvt_pk_bf16_f32 v106, v100, v101
v_mfma_f32_16x16x32_bf16 v[68:71], v[208:211], a[68:71], v[68:71]
v_cvt_pk_bf16_f32 v107, v102, v103
v_min_u32 v104, -2, v104
v_mfma_f32_16x16x32_bf16 v[76:79], v[208:211], a[84:87], v[76:79]
v_min_u32 v105, -2, v105
v_min_u32_e64 v106, -2, v106
v_mfma_f32_16x16x32_bf16 v[84:87], v[208:211], a[100:103], v[84:87]
buffer_load_dwordx4 v[224:227], v4, s[40:43], s75 offen offset:3072 sc1
v_min_u32_e64 v107, -2, v107
v_mfma_f32_16x16x32_bf16 v[92:95], v[208:211], a[116:119], v[92:95]
buffer_store_dwordx4 v[104:107], v4, s[36:39], s58 offen offset:1024 sc1
s_nop 0
s_waitcnt vmcnt(11)
v_mfma_f32_16x16x32_bf16 v[64:67], v[204:207], a[72:75], v[64:67]
v_mfma_f32_16x16x32_bf16 v[72:75], v[204:207], a[88:91], v[72:75]
buffer_load_dwordx4 v[136:139], v4, s[36:39], s55 offen offset:2048 sc1
ds_read_b64_tr_b16 a[0:1], v24 offset:0
v_mfma_f32_16x16x32_bf16 v[80:83], v[204:207], a[104:107], v[80:83]
ds_read_b64_tr_b16 a[2:3], v24 offset:2048
ds_read_b64_tr_b16 a[16:17], v25 offset:0
v_mfma_f32_16x16x32_bf16 v[88:91], v[204:207], a[120:123], v[88:91]
s_xor_b32 s74, s74, 4096
ds_read_b64_tr_b16 a[18:19], v25 offset:2048
v_mfma_f32_16x16x32_bf16 v[68:71], v[200:203], a[72:75], v[68:71]
buffer_load_dwordx4 v[220:223], v4, s[40:43], s74 offen offset:0 sc1
ds_read_b64_tr_b16 a[32:33], v24 offset:256
v_mfma_f32_16x16x32_bf16 v[76:79], v[200:203], a[88:91], v[76:79]
ds_read_b64_tr_b16 a[34:35], v24 offset:2304
ds_read_b64_tr_b16 a[48:49], v25 offset:256
v_mfma_f32_16x16x32_bf16 v[84:87], v[200:203], a[104:107], v[84:87]
ds_read_b64_tr_b16 a[50:51], v25 offset:2304
ds_read_b64_tr_b16 a[4:5], v24 offset:4096
v_mfma_f32_16x16x32_bf16 v[92:95], v[200:203], a[120:123], v[92:95]
s_xor_b32 s75, s75, 4096
ds_read_b64_tr_b16 a[6:7], v24 offset:6144
ds_read_b64_tr_b16 a[20:21], v25 offset:4096
v_mfma_f32_16x16x32_bf16 v[64:67], v[196:199], a[76:79], v[64:67]
buffer_load_dwordx4 v[216:219], v4, s[40:43], s75 offen offset:0 sc1
ds_read_b64_tr_b16 a[22:23], v25 offset:6144
v_mfma_f32_16x16x32_bf16 v[72:75], v[196:199], a[92:95], v[72:75]
ds_read_b64_tr_b16 a[36:37], v24 offset:4352
ds_read_b64_tr_b16 a[38:39], v24 offset:6400
v_mfma_f32_16x16x32_bf16 v[80:83], v[196:199], a[108:111], v[80:83]
ds_read_b64_tr_b16 a[52:53], v25 offset:4352
ds_read_b64_tr_b16 a[54:55], v25 offset:6400
v_mfma_f32_16x16x32_bf16 v[88:91], v[196:199], a[124:127], v[88:91]
buffer_load_dwordx4 v[212:215], v4, s[40:43], s74 offen offset:1024 sc1
ds_read_b64_tr_b16 a[8:9], v24 offset:8192
v_mfma_f32_16x16x32_bf16 v[68:71], v[192:195], a[76:79], v[68:71]
ds_read_b64_tr_b16 a[10:11], v24 offset:10240
ds_read_b64_tr_b16 a[24:25], v25 offset:8192
v_mfma_f32_16x16x32_bf16 v[76:79], v[192:195], a[92:95], v[76:79]
ds_read_b64_tr_b16 a[26:27], v25 offset:10240
ds_read_b64_tr_b16 a[40:41], v24 offset:8448
v_mfma_f32_16x16x32_bf16 v[84:87], v[192:195], a[108:111], v[84:87]
buffer_load_dwordx4 v[208:211], v4, s[40:43], s75 offen offset:1024 sc1
ds_read_b64_tr_b16 a[42:43], v24 offset:10496
v_mfma_f32_16x16x32_bf16 v[92:95], v[192:195], a[124:127], v[92:95]
ds_read_b64_tr_b16 a[56:57], v25 offset:8448
ds_read_b64_tr_b16 a[58:59], v25 offset:10496
s_waitcnt vmcnt(11)
s_barrier
v_mfma_f32_16x16x32_bf16 v[64:67], v[252:255], a[128:131], v[64:67]
v_mfma_f32_16x16x32_bf16 v[72:75], v[252:255], a[144:147], v[72:75]
buffer_load_dword v30, v36, s[36:39], s54 offen offset:0 sc1
ds_read_b64_tr_b16 a[12:13], v24 offset:12288
v_mfma_f32_16x16x32_bf16 v[80:83], v[252:255], a[160:163], v[80:83]
ds_read_b64_tr_b16 a[14:15], v24 offset:14336
ds_read_b64_tr_b16 a[28:29], v25 offset:12288
v_mfma_f32_16x16x32_bf16 v[88:91], v[252:255], a[176:179], v[88:91]
ds_read_b64_tr_b16 a[30:31], v25 offset:14336
ds_read_b64_tr_b16 a[44:45], v24 offset:12544
v_mfma_f32_16x16x32_bf16 v[68:71], v[248:251], a[128:131], v[68:71]
buffer_load_dwordx4 v[204:207], v4, s[40:43], s74 offen offset:2048 sc1
ds_read_b64_tr_b16 a[46:47], v24 offset:14592
v_mfma_f32_16x16x32_bf16 v[76:79], v[248:251], a[144:147], v[76:79]
ds_read_b64_tr_b16 a[60:61], v25 offset:12544
ds_read_b64_tr_b16 a[62:63], v25 offset:14592
v_mfma_f32_16x16x32_bf16 v[84:87], v[248:251], a[160:163], v[84:87]
buffer_load_dwordx4 v[140:143], v4, s[36:39], s55 offen offset:3072 sc1
ds_read_b64_tr_b16 a[64:65], v24 offset:16384
v_mfma_f32_16x16x32_bf16 v[92:95], v[248:251], a[176:179], v[92:95]
ds_read_b64_tr_b16 a[66:67], v24 offset:18432
ds_read_b64_tr_b16 a[80:81], v25 offset:16384
v_mfma_f32_16x16x32_bf16 v[64:67], v[244:247], a[132:135], v[64:67]
ds_read_b64_tr_b16 a[82:83], v25 offset:18432
ds_read_b64_tr_b16 a[96:97], v24 offset:16640
v_mfma_f32_16x16x32_bf16 v[72:75], v[244:247], a[148:151], v[72:75]
buffer_load_dwordx4 v[200:203], v4, s[40:43], s75 offen offset:2048 sc1
ds_read_b64_tr_b16 a[98:99], v24 offset:18688
v_mfma_f32_16x16x32_bf16 v[80:83], v[244:247], a[164:167], v[80:83]
ds_read_b64_tr_b16 a[112:113], v25 offset:16640
ds_read_b64_tr_b16 a[114:115], v25 offset:18688
v_mfma_f32_16x16x32_bf16 v[88:91], v[244:247], a[180:183], v[88:91]
ds_read_b64_tr_b16 a[68:69], v24 offset:20480
ds_read_b64_tr_b16 a[70:71], v24 offset:22528
v_mfma_f32_16x16x32_bf16 v[68:71], v[240:243], a[132:135], v[68:71]
buffer_load_dwordx4 v[196:199], v4, s[40:43], s74 offen offset:3072 sc1
ds_read_b64_tr_b16 a[84:85], v25 offset:20480
v_mfma_f32_16x16x32_bf16 v[76:79], v[240:243], a[148:151], v[76:79]
ds_read_b64_tr_b16 a[86:87], v25 offset:22528
ds_read_b64_tr_b16 a[100:101], v24 offset:20736
v_mfma_f32_16x16x32_bf16 v[84:87], v[240:243], a[164:167], v[84:87]
buffer_load_dwordx4 v[192:195], v4, s[40:43], s75 offen offset:3072 sc1
ds_read_b64_tr_b16 a[102:103], v24 offset:22784
v_mfma_f32_16x16x32_bf16 v[92:95], v[240:243], a[180:183], v[92:95]
ds_read_b64_tr_b16 a[116:117], v25 offset:20736
ds_read_b64_tr_b16 a[118:119], v25 offset:22784
s_nop 0
s_waitcnt vmcnt(12)
v_mfma_f32_16x16x32_bf16 v[64:67], v[236:239], a[136:139], v[64:67]
v_mfma_f32_16x16x32_bf16 v[72:75], v[236:239], a[152:155], v[72:75]
s_add_u32 s55, s55, 4096
ds_read_b64_tr_b16 a[72:73], v24 offset:24576
v_mfma_f32_16x16x32_bf16 v[80:83], v[236:239], a[168:171], v[80:83]
buffer_load_dwordx4 v[144:147], v4, s[36:39], s55 offen offset:0 sc1
ds_read_b64_tr_b16 a[74:75], v24 offset:26624
v_mfma_f32_16x16x32_bf16 v[88:91], v[236:239], a[184:187], v[88:91]
ds_read_b64_tr_b16 a[88:89], v25 offset:24576
ds_read_b64_tr_b16 a[90:91], v25 offset:26624
v_mfma_f32_16x16x32_bf16 v[68:71], v[232:235], a[136:139], v[68:71]
ds_read_b64_tr_b16 a[104:105], v24 offset:24832
ds_read_b64_tr_b16 a[106:107], v24 offset:26880
v_mfma_f32_16x16x32_bf16 v[76:79], v[232:235], a[152:155], v[76:79]
ds_read_b64_tr_b16 a[120:121], v25 offset:24832
ds_read_b64_tr_b16 a[122:123], v25 offset:26880
v_mfma_f32_16x16x32_bf16 v[84:87], v[232:235], a[168:171], v[84:87]
buffer_load_dwordx4 v[148:151], v4, s[36:39], s55 offen offset:1024 sc1
ds_read_b64_tr_b16 a[76:77], v24 offset:28672
v_mfma_f32_16x16x32_bf16 v[92:95], v[232:235], a[184:187], v[92:95]
ds_read_b64_tr_b16 a[78:79], v24 offset:30720
ds_read_b64_tr_b16 a[92:93], v25 offset:28672
v_mfma_f32_16x16x32_bf16 v[64:67], v[228:231], a[140:143], v[64:67]
ds_read_b64_tr_b16 a[94:95], v25 offset:30720
ds_read_b64_tr_b16 a[108:109], v24 offset:28928
v_mfma_f32_16x16x32_bf16 v[72:75], v[228:231], a[156:159], v[72:75]
ds_read_b64_tr_b16 a[110:111], v24 offset:30976
ds_read_b64_tr_b16 a[124:125], v25 offset:28928
v_mfma_f32_16x16x32_bf16 v[80:83], v[228:231], a[172:175], v[80:83]
buffer_load_dwordx4 v[152:155], v4, s[36:39], s55 offen offset:2048 sc1
v_mfma_f32_16x16x32_bf16 v[88:91], v[228:231], a[188:191], v[88:91]
ds_read_b64_tr_b16 a[126:127], v25 offset:30976
ds_read_b64_tr_b16 a[128:129], v24 offset:32768
v_mfma_f32_16x16x32_bf16 v[68:71], v[224:227], a[140:143], v[68:71]
ds_read_b64_tr_b16 a[130:131], v24 offset:34816
ds_read_b64_tr_b16 a[144:145], v25 offset:32768
v_mfma_f32_16x16x32_bf16 v[76:79], v[224:227], a[156:159], v[76:79]
ds_read_b64_tr_b16 a[146:147], v25 offset:34816
ds_read_b64_tr_b16 a[160:161], v24 offset:33024
v_mfma_f32_16x16x32_bf16 v[84:87], v[224:227], a[172:175], v[84:87]
buffer_load_dwordx4 v[156:159], v4, s[36:39], s55 offen offset:3072 sc1
ds_read_b64_tr_b16 a[162:163], v24 offset:35072
v_mfma_f32_16x16x32_bf16 v[92:95], v[224:227], a[188:191], v[92:95]
ds_read_b64_tr_b16 a[176:177], v25 offset:33024
ds_read_b64_tr_b16 a[178:179], v25 offset:35072
s_waitcnt vmcnt(10)
v_mfma_f32_16x16x32_bf16 v[88:91], v[220:223], a[240:243], v[88:91]
v_mfma_f32_16x16x32_bf16 v[92:95], v[216:219], a[240:243], v[92:95]
v_mfma_f32_16x16x32_bf16 v[88:91], v[212:215], a[244:247], v[88:91]
v_mfma_f32_16x16x32_bf16 v[92:95], v[208:211], a[244:247], v[92:95]
s_waitcnt vmcnt(4)
v_mfma_f32_16x16x32_bf16 v[88:91], v[204:207], a[248:251], v[88:91]
s_add_u32 s55, s55, 4096
ds_read_b64_tr_b16 a[132:133], v24 offset:36864
v_mfma_f32_16x16x32_bf16 v[92:95], v[200:203], a[248:251], v[92:95]
buffer_load_dwordx4 v[160:163], v4, s[36:39], s55 offen offset:0 sc1
ds_read_b64_tr_b16 a[134:135], v24 offset:38912
v_mfma_f32_16x16x32_bf16 v[88:91], v[196:199], a[252:255], v[88:91]
ds_read_b64_tr_b16 a[148:149], v25 offset:36864
v_mfma_f32_16x16x32_bf16 v[92:95], v[192:195], a[252:255], v[92:95]
ds_read_b64_tr_b16 a[150:151], v25 offset:38912
ds_read_b64_tr_b16 a[164:165], v24 offset:37120
v_mfma_f32_16x16x32_bf16 v[80:83], v[220:223], a[224:227], v[80:83]
buffer_load_dwordx4 v[164:167], v4, s[36:39], s55 offen offset:1024 sc1
v_mfma_f32_16x16x32_bf16 v[84:87], v[216:219], a[224:227], v[84:87]
ds_read_b64_tr_b16 a[166:167], v24 offset:39168
ds_read_b64_tr_b16 a[180:181], v25 offset:37120
v_mfma_f32_16x16x32_bf16 v[80:83], v[212:215], a[228:231], v[80:83]
ds_read_b64_tr_b16 a[182:183], v25 offset:39168
v_mfma_f32_16x16x32_bf16 v[84:87], v[208:211], a[228:231], v[84:87]
buffer_load_dwordx4 v[168:171], v4, s[36:39], s55 offen offset:2048 sc1
ds_write_b128 v22, v[88:91] offset:16384
v_mfma_f32_16x16x32_bf16 v[80:83], v[204:207], a[232:235], v[80:83]
ds_read_b64_tr_b16 a[136:137], v24 offset:40960
ds_read_b64_tr_b16 a[138:139], v24 offset:43008
v_mfma_f32_16x16x32_bf16 v[84:87], v[200:203], a[232:235], v[84:87]
buffer_load_dwordx4 v[172:175], v4, s[36:39], s55 offen offset:3072 sc1
v_mfma_f32_16x16x32_bf16 v[80:83], v[196:199], a[236:239], v[80:83]
ds_write_b128 v22, v[92:95] offset:17408
v_mfma_f32_16x16x32_bf16 v[84:87], v[192:195], a[236:239], v[84:87]
s_add_u32 m0, s84, 155648
ds_read_b64_tr_b16 a[152:153], v25 offset:40960
v_mfma_f32_16x16x32_bf16 v[72:75], v[220:223], a[208:211], v[72:75]
buffer_load_dwordx4 v16, s[4:7], s59 offen lds
ds_read_b64_tr_b16 a[154:155], v25 offset:43008
v_mfma_f32_16x16x32_bf16 v[76:79], v[216:219], a[208:211], v[76:79]
ds_read_b64_tr_b16 a[168:169], v24 offset:41216
v_mfma_f32_16x16x32_bf16 v[72:75], v[212:215], a[212:215], v[72:75]
s_add_u32 s3, s59, 15360
ds_read_b64_tr_b16 a[170:171], v24 offset:43264
v_mfma_f32_16x16x32_bf16 v[76:79], v[208:211], a[212:215], v[76:79]
buffer_load_dwordx4 v16, s[4:7], s3 offen offset:1024 lds
ds_write_b128 v21, v[80:83] offset:8192
v_mfma_f32_16x16x32_bf16 v[72:75], v[204:207], a[216:219], v[72:75]
ds_read_b64_tr_b16 a[184:185], v25 offset:41216
ds_read_b64_tr_b16 a[186:187], v25 offset:43264
v_mfma_f32_16x16x32_bf16 v[76:79], v[200:203], a[216:219], v[76:79]
s_add_u32 s55, s55, 4096
ds_read_b64_tr_b16 a[140:141], v24 offset:45056
v_mfma_f32_16x16x32_bf16 v[72:75], v[196:199], a[220:223], v[72:75]
buffer_load_dwordx4 v[176:179], v4, s[36:39], s55 offen offset:0 sc1
ds_write_b128 v21, v[84:87] offset:9216
v_mfma_f32_16x16x32_bf16 v[76:79], v[192:195], a[220:223], v[76:79]
ds_read_b64_tr_b16 a[142:143], v24 offset:47104
v_mfma_f32_16x16x32_bf16 v[64:67], v[220:223], a[192:195], v[64:67]
ds_read_b64_tr_b16 a[156:157], v25 offset:45056
ds_read_b64_tr_b16 a[158:159], v25 offset:47104
v_mfma_f32_16x16x32_bf16 v[68:71], v[216:219], a[192:195], v[68:71]
buffer_load_dwordx4 v[180:183], v4, s[36:39], s55 offen offset:1024 sc1
v_mfma_f32_16x16x32_bf16 v[64:67], v[212:215], a[196:199], v[64:67]
ds_write_b128 v20, v[72:75] offset:0
v_mfma_f32_16x16x32_bf16 v[68:71], v[208:211], a[196:199], v[68:71]
buffer_load_dwordx4 v[184:187], v4, s[36:39], s55 offen offset:2048 sc1
ds_read_b64_tr_b16 a[172:173], v24 offset:45312
v_mfma_f32_16x16x32_bf16 v[64:67], v[204:207], a[200:203], v[64:67]
ds_read_b64_tr_b16 a[174:175], v24 offset:47360
v_mfma_f32_16x16x32_bf16 v[68:71], v[200:203], a[200:203], v[68:71]
ds_write_b128 v20, v[76:79] offset:1024
v_mfma_f32_16x16x32_bf16 v[64:67], v[196:199], a[204:207], v[64:67]
buffer_load_dwordx4 v[188:191], v4, s[36:39], s55 offen offset:3072 sc1
ds_read_b64_tr_b16 a[188:189], v25 offset:45312
v_mfma_f32_16x16x32_bf16 v[68:71], v[192:195], a[204:207], v[68:71]
ds_read_b64_tr_b16 a[190:191], v25 offset:47360
s_waitcnt lgkmcnt(0)
s_barrier
ds_read_b128 v[72:75], v23 offset:0
ds_read_b128 v[80:83], v23 offset:8192
ds_read_b128 v[88:91], v23 offset:16384
ds_read_b128 v[76:79], v23 offset:1024
ds_read_b128 v[84:87], v23 offset:9216
ds_read_b128 v[92:95], v23 offset:17408
ds_read_b64_tr_b16 a[192:193], v24 offset:49152
ds_read_b64_tr_b16 a[194:195], v24 offset:51200
ds_read_b64_tr_b16 a[208:209], v25 offset:49152
ds_read_b64_tr_b16 a[210:211], v25 offset:51200
ds_read_b64_tr_b16 a[224:225], v24 offset:49408
ds_read_b64_tr_b16 a[226:227], v24 offset:51456
ds_read_b64_tr_b16 a[240:241], v25 offset:49408
ds_read_b64_tr_b16 a[242:243], v25 offset:51456
s_waitcnt lgkmcnt(11)
v_pk_add_f32 v[64:65], v[64:65], v[72:73]
v_pk_add_f32 v[66:67], v[66:67], v[74:75]
v_pk_add_f32 v[80:81], v[80:81], v[88:89]
v_pk_add_f32 v[82:83], v[82:83], v[90:91]
v_pk_add_f32 v[64:65], v[64:65], v[80:81]
v_pk_add_f32 v[66:67], v[66:67], v[82:83]
v_pk_mul_f32 v[64:65], v[64:65], v[56:57]
v_pk_mul_f32 v[66:67], v[66:67], v[58:59]
s_waitcnt lgkmcnt(8)
v_pk_add_f32 v[68:69], v[68:69], v[76:77]
v_pk_add_f32 v[70:71], v[70:71], v[78:79]
v_pk_add_f32 v[84:85], v[84:85], v[92:93]
v_pk_add_f32 v[86:87], v[86:87], v[94:95]
v_pk_add_f32 v[68:69], v[68:69], v[84:85]
v_pk_add_f32 v[70:71], v[70:71], v[86:87]
v_pk_mul_f32 v[68:69], v[68:69], v[60:61]
v_pk_mul_f32 v[70:71], v[70:71], v[62:63]
v_cvt_pk_bf16_f32 v72, v64, v65
v_cvt_pk_bf16_f32 v73, v66, v67
v_cvt_pk_bf16_f32 v74, v68, v69
v_cvt_pk_bf16_f32 v75, v70, v71
v_min_u32 v72, -2, v72
v_min_u32 v73, -2, v73
v_min_u32 v74, -2, v74
v_min_u32 v75, -2, v75
buffer_store_dwordx4 v[72:75], v4, s[36:39], s58 offen offset:2048 sc1
s_waitcnt vmcnt(11)
v_cmp_ne_u32 vcc, s69, v30
s_cbranch_vccnz L_h4_slow
L_h4_ok:
v_mfma_f32_16x16x32_bf16 v[40:43], a[0:3], v[128:131], 0
ds_read_b64_tr_b16 a[196:197], v24 offset:53248
ds_read_b64_tr_b16 a[198:199], v24 offset:55296
v_mfma_f32_16x16x32_bf16 v[44:47], a[16:19], v[128:131], 0
s_add_u32 s97, s57, 0
ds_read_b64_tr_b16 a[212:213], v25 offset:53248
v_mfma_f32_16x16x32_bf16 v[48:51], a[32:35], v[128:131], 0
buffer_load_dwordx4 v[96:99], v4, s[36:39], s97 offen sc1
v_mfma_f32_16x16x32_bf16 v[52:55], a[48:51], v[128:131], 0
ds_read_b64_tr_b16 a[214:215], v25 offset:55296
ds_read_b64_tr_b16 a[228:229], v24 offset:53504
v_mfma_f32_16x16x32_bf16 v[40:43], a[4:7], v[132:135], v[40:43]
ds_read_b64_tr_b16 a[230:231], v24 offset:55552
ds_read_b64_tr_b16 a[244:245], v25 offset:53504
v_mfma_f32_16x16x32_bf16 v[44:47], a[20:23], v[132:135], v[44:47]
s_add_u32 s97, s57, 3072
ds_read_b64_tr_b16 a[246:247], v25 offset:55552
v_mfma_f32_16x16x32_bf16 v[48:51], a[36:39], v[132:135], v[48:51]
buffer_load_dwordx4 v[100:103], v4, s[36:39], s97 offen sc1
v_mfma_f32_16x16x32_bf16 v[52:55], a[52:55], v[132:135], v[52:55]
ds_read_b64_tr_b16 a[200:201], v24 offset:57344
ds_read_b64_tr_b16 a[202:203], v24 offset:59392
v_mfma_f32_16x16x32_bf16 v[40:43], a[8:11], v[136:139], v[40:43]
ds_read_b64_tr_b16 a[216:217], v25 offset:57344
ds_read_b64_tr_b16 a[218:219], v25 offset:59392
v_mfma_f32_16x16x32_bf16 v[44:47], a[24:27], v[136:139], v[44:47]
s_add_u32 s97, s57, 6144
ds_read_b64_tr_b16 a[232:233], v24 offset:57600
v_mfma_f32_16x16x32_bf16 v[48:51], a[40:43], v[136:139], v[48:51]
buffer_load_dwordx4 v[104:107], v4, s[36:39], s97 offen sc1
v_mfma_f32_16x16x32_bf16 v[52:55], a[56:59], v[136:139], v[52:55]
ds_read_b64_tr_b16 a[234:235], v24 offset:59648
ds_read_b64_tr_b16 a[248:249], v25 offset:57600
v_mfma_f32_16x16x32_bf16 v[40:43], a[12:15], v[140:143], v[40:43]
ds_read_b64_tr_b16 a[250:251], v25 offset:59648
ds_read_b64_tr_b16 a[204:205], v24 offset:61440
v_mfma_f32_16x16x32_bf16 v[44:47], a[28:31], v[140:143], v[44:47]
s_add_u32 s97, s57, 9216
ds_read_b64_tr_b16 a[206:207], v24 offset:63488
v_mfma_f32_16x16x32_bf16 v[48:51], a[44:47], v[140:143], v[48:51]
buffer_load_dwordx4 v[108:111], v4, s[36:39], s97 offen sc1
v_mfma_f32_16x16x32_bf16 v[52:55], a[60:63], v[140:143], v[52:55]
ds_read_b64_tr_b16 a[220:221], v25 offset:61440
ds_read_b64_tr_b16 a[222:223], v25 offset:63488
v_mfma_f32_16x16x32_bf16 v[40:43], a[64:67], v[144:147], v[40:43]
ds_read_b64_tr_b16 a[236:237], v24 offset:61696
ds_read_b64_tr_b16 a[238:239], v24 offset:63744
v_mfma_f32_16x16x32_bf16 v[44:47], a[80:83], v[144:147], v[44:47]
s_add_u32 s97, s57, 12288
ds_read_b64_tr_b16 a[252:253], v25 offset:61696
v_mfma_f32_16x16x32_bf16 v[48:51], a[96:99], v[144:147], v[48:51]
buffer_load_dwordx4 v[112:115], v4, s[36:39], s97 offen sc1
v_mfma_f32_16x16x32_bf16 v[52:55], a[112:115], v[144:147], v[52:55]
ds_read_b64_tr_b16 a[254:255], v25 offset:63744
ds_read_b64_tr_b16 a[0:1], v26 offset:0
v_mfma_f32_16x16x32_bf16 v[40:43], a[68:71], v[148:151], v[40:43]
ds_read_b64_tr_b16 a[2:3], v26 offset:2048
ds_read_b64_tr_b16 a[16:17], v27 offset:0
v_mfma_f32_16x16x32_bf16 v[44:47], a[84:87], v[148:151], v[44:47]
s_add_u32 s97, s57, 15360
ds_read_b64_tr_b16 a[18:19], v27 offset:2048
v_mfma_f32_16x16x32_bf16 v[48:51], a[100:103], v[148:151], v[48:51]
buffer_load_dwordx4 v[116:119], v4, s[36:39], s97 offen sc1
v_mfma_f32_16x16x32_bf16 v[52:55], a[116:119], v[148:151], v[52:55]
ds_read_b64_tr_b16 a[32:33], v26 offset:256
ds_read_b64_tr_b16 a[34:35], v26 offset:2304
v_mfma_f32_16x16x32_bf16 v[40:43], a[72:75], v[152:155], v[40:43]
ds_read_b64_tr_b16 a[48:49], v27 offset:256
ds_read_b64_tr_b16 a[50:51], v27 offset:2304
v_mfma_f32_16x16x32_bf16 v[44:47], a[88:91], v[152:155], v[44:47]
s_add_u32 s97, s57, 18432
ds_read_b64_tr_b16 a[4:5], v26 offset:4096
v_mfma_f32_16x16x32_bf16 v[48:51], a[104:107], v[152:155], v[48:51]
buffer_load_dwordx4 v[120:123], v4, s[36:39], s97 offen sc1
v_mfma_f32_16x16x32_bf16 v[52:55], a[120:123], v[152:155], v[52:55]
ds_read_b64_tr_b16 a[6:7], v26 offset:6144
ds_read_b64_tr_b16 a[20:21], v27 offset:4096
v_mfma_f32_16x16x32_bf16 v[40:43], a[76:79], v[156:159], v[40:43]
ds_read_b64_tr_b16 a[22:23], v27 offset:6144
ds_read_b64_tr_b16 a[36:37], v26 offset:4352
v_mfma_f32_16x16x32_bf16 v[44:47], a[92:95], v[156:159], v[44:47]
s_add_u32 s97, s57, 21504
ds_read_b64_tr_b16 a[38:39], v26 offset:6400
v_mfma_f32_16x16x32_bf16 v[48:51], a[108:111], v[156:159], v[48:51]
buffer_load_dwordx4 v[124:127], v4, s[36:39], s97 offen sc1
v_mfma_f32_16x16x32_bf16 v[52:55], a[124:127], v[156:159], v[52:55]
ds_read_b64_tr_b16 a[52:53], v27 offset:4352
ds_read_b64_tr_b16 a[54:55], v27 offset:6400
s_waitcnt vmcnt(9) lgkmcnt(15)
ds_read_b64 v[6:7], v17 offset:0
ds_read_b64 v[14:15], v17 offset:32
ds_read_b64 v[32:33], v17 offset:64
ds_read_b64 v[34:35], v17 offset:96
v_mfma_f32_16x16x32_bf16 v[40:43], a[128:131], v[160:163], v[40:43]
s_add_u32 m0, s60, 0
s_add_u32 s3, s64, 163840
ds_read_b64_tr_b16 a[8:9], v26 offset:8192
v_mfma_f32_16x16x32_bf16 v[44:47], a[144:147], v[160:163], v[44:47]
buffer_load_dwordx4 v39, s[28:31], s3 offen lds
ds_read_b64_tr_b16 a[10:11], v26 offset:10240
v_mfma_f32_16x16x32_bf16 v[48:51], a[160:163], v[160:163], v[48:51]
ds_read_b64_tr_b16 a[24:25], v27 offset:8192
ds_read_b64_tr_b16 a[26:27], v27 offset:10240
v_mfma_f32_16x16x32_bf16 v[52:55], a[176:179], v[160:163], v[52:55]
s_add_u32 m0, s60, 4096
ds_read_b64_tr_b16 a[40:41], v26 offset:8448
v_mfma_f32_16x16x32_bf16 v[40:43], a[132:135], v[164:167], v[40:43]
s_add_u32 s3, s64, 262144
ds_read_b64_tr_b16 a[42:43], v26 offset:10496
ds_read_b64_tr_b16 a[56:57], v27 offset:8448
v_mfma_f32_16x16x32_bf16 v[44:47], a[148:151], v[164:167], v[44:47]
buffer_load_dwordx4 v39, s[28:31], s3 offen lds
ds_read_b64_tr_b16 a[58:59], v27 offset:10496
v_mfma_f32_16x16x32_bf16 v[48:51], a[164:167], v[164:167], v[48:51]
s_add_u32 m0, s60, 8192
ds_read_b64_tr_b16 a[12:13], v26 offset:12288
v_mfma_f32_16x16x32_bf16 v[52:55], a[180:183], v[164:167], v[52:55]
s_add_u32 s3, s64, 360448
ds_read_b64_tr_b16 a[14:15], v26 offset:14336
ds_read_b64_tr_b16 a[28:29], v27 offset:12288
v_mfma_f32_16x16x32_bf16 v[40:43], a[136:139], v[168:171], v[40:43]
buffer_load_dwordx4 v39, s[28:31], s3 offen lds
v_mfma_f32_16x16x32_bf16 v[44:47], a[152:155], v[168:171], v[44:47]
ds_read_b64_tr_b16 a[30:31], v27 offset:14336
ds_read_b64_tr_b16 a[44:45], v26 offset:12544
ds_read_b64_tr_b16 a[46:47], v26 offset:14592
v_mfma_f32_16x16x32_bf16 v[48:51], a[168:171], v[168:171], v[48:51]
s_add_u32 m0, s60, 12288
ds_read_b64_tr_b16 a[60:61], v27 offset:12544
v_mfma_f32_16x16x32_bf16 v[52:55], a[184:187], v[168:171], v[52:55]
s_add_u32 s3, s64, 458752
ds_read_b64_tr_b16 a[62:63], v27 offset:14592
ds_read_b64_tr_b16 a[64:65], v26 offset:16384
v_mfma_f32_16x16x32_bf16 v[40:43], a[140:143], v[172:175], v[40:43]
buffer_load_dwordx4 v39, s[28:31], s3 offen lds
ds_read_b64_tr_b16 a[66:67], v26 offset:18432
v_mfma_f32_16x16x32_bf16 v[44:47], a[156:159], v[172:175], v[44:47]
ds_read_b64_tr_b16 a[80:81], v27 offset:16384
ds_read_b64_tr_b16 a[82:83], v27 offset:18432
v_mfma_f32_16x16x32_bf16 v[48:51], a[172:175], v[172:175], v[48:51]
s_add_u32 m0, s60, 16384
ds_read_b64_tr_b16 a[96:97], v26 offset:16640
v_mfma_f32_16x16x32_bf16 v[52:55], a[188:191], v[172:175], v[52:55]
s_add_u32 s3, s64, 557056
ds_read_b64_tr_b16 a[98:99], v26 offset:18688
ds_read_b64_tr_b16 a[112:113], v27 offset:16640
v_mfma_f32_16x16x32_bf16 v[40:43], a[192:195], v[176:179], v[40:43]
buffer_load_dwordx4 v39, s[28:31], s3 offen lds
ds_read_b64_tr_b16 a[114:115], v27 offset:18688
v_mfma_f32_16x16x32_bf16 v[44:47], a[208:211], v[176:179], v[44:47]
s_add_u32 m0, s60, 20480
ds_read_b64_tr_b16 a[68:69], v26 offset:20480
v_mfma_f32_16x16x32_bf16 v[48:51], a[224:227], v[176:179], v[48:51]
s_add_u32 s3, s64, 655360
ds_read_b64_tr_b16 a[70:71], v26 offset:22528
ds_read_b64_tr_b16 a[84:85], v27 offset:20480
v_mfma_f32_16x16x32_bf16 v[52:55], a[240:243], v[176:179], v[52:55]
buffer_load_dwordx4 v39, s[28:31], s3 offen lds
v_mfma_f32_16x16x32_bf16 v[40:43], a[196:199], v[180:183], v[40:43]
ds_read_b64_tr_b16 a[86:87], v27 offset:22528
ds_read_b64_tr_b16 a[100:101], v26 offset:20736
ds_read_b64_tr_b16 a[102:103], v26 offset:22784
v_mfma_f32_16x16x32_bf16 v[44:47], a[212:215], v[180:183], v[44:47]
ds_read_b64_tr_b16 a[116:117], v27 offset:20736
ds_read_b64_tr_b16 a[118:119], v27 offset:22784
v_mfma_f32_16x16x32_bf16 v[48:51], a[228:231], v[180:183], v[48:51]
s_add_u32 s97, s57, 1024
ds_read_b64_tr_b16 a[72:73], v26 offset:24576
ds_read_b64_tr_b16 a[74:75], v26 offset:26624
v_mfma_f32_16x16x32_bf16 v[52:55], a[244:247], v[180:183], v[52:55]
buffer_load_dwordx4 v[192:195], v4, s[36:39], s97 offen sc1
v_mfma_f32_16x16x32_bf16 v[40:43], a[200:203], v[184:187], v[40:43]
ds_read_b64_tr_b16 a[88:89], v27 offset:24576
ds_read_b64_tr_b16 a[90:91], v27 offset:26624
ds_read_b64_tr_b16 a[104:105], v26 offset:24832
v_mfma_f32_16x16x32_bf16 v[44:47], a[216:219], v[184:187], v[44:47]
s_add_u32 s97, s57, 4096
ds_read_b64_tr_b16 a[106:107], v26 offset:26880
v_mfma_f32_16x16x32_bf16 v[48:51], a[232:235], v[184:187], v[48:51]
buffer_load_dwordx4 v[196:199], v4, s[36:39], s97 offen sc1
ds_read_b64_tr_b16 a[120:121], v27 offset:24832
v_mfma_f32_16x16x32_bf16 v[52:55], a[248:251], v[184:187], v[52:55]
ds_read_b64_tr_b16 a[122:123], v27 offset:26880
ds_read_b64_tr_b16 a[76:77], v26 offset:28672
v_mfma_f32_16x16x32_bf16 v[40:43], a[204:207], v[188:191], v[40:43]
ds_read_b64_tr_b16 a[78:79], v26 offset:30720
ds_read_b64_tr_b16 a[92:93], v27 offset:28672
v_mfma_f32_16x16x32_bf16 v[44:47], a[220:223], v[188:191], v[44:47]
s_add_u32 s97, s57, 7168
ds_read_b64_tr_b16 a[94:95], v27 offset:30720
ds_read_b64_tr_b16 a[108:109], v26 offset:28928
v_mfma_f32_16x16x32_bf16 v[48:51], a[236:239], v[188:191], v[48:51]
buffer_load_dwordx4 v[200:203], v4, s[36:39], s97 offen sc1
ds_read_b64_tr_b16 a[110:111], v26 offset:30976
v_mfma_f32_16x16x32_bf16 v[52:55], a[252:255], v[188:191], v[52:55]
ds_read_b64_tr_b16 a[124:125], v27 offset:28928
ds_read_b64_tr_b16 a[126:127], v27 offset:30976
s_nop 0
s_waitcnt vmcnt(9) lgkmcnt(0)
v_mfma_f32_16x16x32_bf16 v[56:59], a[0:3], v[96:99], 0
ds_read_b64_tr_b16 a[128:129], v26 offset:32768
ds_read_b64_tr_b16 a[130:131], v26 offset:34816
ds_read_b64_tr_b16 a[144:145], v27 offset:32768
v_mfma_f32_16x16x32_bf16 v[60:63], a[16:19], v[96:99], 0
s_add_u32 s97, s57, 10240
ds_read_b64_tr_b16 a[146:147], v27 offset:34816
ds_read_b64_tr_b16 a[160:161], v26 offset:33024
v_mfma_f32_16x16x32_bf16 v[64:67], a[32:35], v[96:99], 0
buffer_load_dwordx4 v[204:207], v4, s[36:39], s97 offen sc1
ds_read_b64_tr_b16 a[162:163], v26 offset:35072
v_mfma_f32_16x16x32_bf16 v[68:71], a[48:51], v[96:99], 0
ds_read_b64_tr_b16 a[176:177], v27 offset:33024
ds_read_b64_tr_b16 a[178:179], v27 offset:35072
v_mfma_f32_16x16x32_bf16 v[56:59], a[4:7], v[100:103], v[56:59]
ds_read_b64_tr_b16 a[132:133], v26 offset:36864
ds_read_b64_tr_b16 a[134:135], v26 offset:38912
ds_read_b64_tr_b16 a[148:149], v27 offset:36864
v_mfma_f32_16x16x32_bf16 v[60:63], a[20:23], v[100:103], v[60:63]
s_add_u32 s97, s57, 13312
ds_read_b64_tr_b16 a[150:151], v27 offset:38912
ds_read_b64_tr_b16 a[164:165], v26 offset:37120
v_mfma_f32_16x16x32_bf16 v[64:67], a[36:39], v[100:103], v[64:67]
buffer_load_dwordx4 v[208:211], v4, s[36:39], s97 offen sc1
ds_read_b64_tr_b16 a[166:167], v26 offset:39168
v_mfma_f32_16x16x32_bf16 v[68:71], a[52:55], v[100:103], v[68:71]
ds_read_b64_tr_b16 a[180:181], v27 offset:37120
ds_read_b64_tr_b16 a[182:183], v27 offset:39168
ds_read_b64_tr_b16 a[136:137], v26 offset:40960
v_mfma_f32_16x16x32_bf16 v[56:59], a[8:11], v[104:107], v[56:59]
ds_read_b64_tr_b16 a[138:139], v26 offset:43008
ds_read_b64_tr_b16 a[152:153], v27 offset:40960
ds_read_b64_tr_b16 a[154:155], v27 offset:43008
v_mfma_f32_16x16x32_bf16 v[60:63], a[24:27], v[104:107], v[60:63]
s_add_u32 s97, s57, 16384
ds_read_b64_tr_b16 a[168:169], v26 offset:41216
ds_read_b64_tr_b16 a[170:171], v26 offset:43264
v_mfma_f32_16x16x32_bf16 v[64:67], a[40:43], v[104:107], v[64:67]
buffer_load_dwordx4 v[212:215], v4, s[36:39], s97 offen sc1
ds_read_b64_tr_b16 a[184:185], v27 offset:41216
v_mfma_f32_16x16x32_bf16 v[68:71], a[56:59], v[104:107], v[68:71]
ds_read_b64_tr_b16 a[186:187], v27 offset:43264
ds_read_b64_tr_b16 a[140:141], v26 offset:45056
v_mfma_f32_16x16x32_bf16 v[56:59], a[12:15], v[108:111], v[56:59]
ds_read_b64_tr_b16 a[142:143], v26 offset:47104
ds_read_b64_tr_b16 a[156:157], v27 offset:45056
ds_read_b64_tr_b16 a[158:159], v27 offset:47104
v_mfma_f32_16x16x32_bf16 v[60:63], a[28:31], v[108:111], v[60:63]
s_add_u32 s97, s57, 19456
ds_read_b64_tr_b16 a[172:173], v26 offset:45312
ds_read_b64_tr_b16 a[174:175], v26 offset:47360
v_mfma_f32_16x16x32_bf16 v[64:67], a[44:47], v[108:111], v[64:67]
buffer_load_dwordx4 v[216:219], v4, s[36:39], s97 offen sc1
ds_read_b64_tr_b16 a[188:189], v27 offset:45312
v_mfma_f32_16x16x32_bf16 v[68:71], a[60:63], v[108:111], v[68:71]
ds_read_b64_tr_b16 a[190:191], v27 offset:47360
ds_read_b64_tr_b16 a[192:193], v26 offset:49152
ds_read_b64_tr_b16 a[194:195], v26 offset:51200
v_mfma_f32_16x16x32_bf16 v[56:59], a[64:67], v[112:115], v[56:59]
ds_read_b64_tr_b16 a[208:209], v27 offset:49152
ds_read_b64_tr_b16 a[210:211], v27 offset:51200
ds_read_b64_tr_b16 a[224:225], v26 offset:49408
v_mfma_f32_16x16x32_bf16 v[60:63], a[80:83], v[112:115], v[60:63]
s_add_u32 s97, s57, 2048
ds_read_b64_tr_b16 a[226:227], v26 offset:51456
ds_read_b64_tr_b16 a[240:241], v27 offset:49408
v_mfma_f32_16x16x32_bf16 v[64:67], a[96:99], v[112:115], v[64:67]
buffer_load_dwordx4 v[220:223], v4, s[36:39], s97 offen sc1
ds_read_b64_tr_b16 a[242:243], v27 offset:51456
v_mfma_f32_16x16x32_bf16 v[68:71], a[112:115], v[112:115], v[68:71]
ds_read_b64_tr_b16 a[196:197], v26 offset:53248
ds_read_b64_tr_b16 a[198:199], v26 offset:55296
v_mfma_f32_16x16x32_bf16 v[56:59], a[68:71], v[116:119], v[56:59]
ds_read_b64_tr_b16 a[212:213], v27 offset:53248
ds_read_b64_tr_b16 a[214:215], v27 offset:55296
ds_read_b64_tr_b16 a[228:229], v26 offset:53504
v_mfma_f32_16x16x32_bf16 v[60:63], a[84:87], v[116:119], v[60:63]
s_add_u32 s97, s57, 5120
ds_read_b64_tr_b16 a[230:231], v26 offset:55552
ds_read_b64_tr_b16 a[244:245], v27 offset:53504
v_mfma_f32_16x16x32_bf16 v[64:67], a[100:103], v[116:119], v[64:67]
buffer_load_dwordx4 v[224:227], v4, s[36:39], s97 offen sc1
ds_read_b64_tr_b16 a[246:247], v27 offset:55552
v_mfma_f32_16x16x32_bf16 v[68:71], a[116:119], v[116:119], v[68:71]
ds_read_b64_tr_b16 a[200:201], v26 offset:57344
ds_read_b64_tr_b16 a[202:203], v26 offset:59392
ds_read_b64_tr_b16 a[216:217], v27 offset:57344
v_mfma_f32_16x16x32_bf16 v[56:59], a[72:75], v[120:123], v[56:59]
ds_read_b64_tr_b16 a[218:219], v27 offset:59392
ds_read_b64_tr_b16 a[232:233], v26 offset:57600
ds_read_b64_tr_b16 a[234:235], v26 offset:59648
v_mfma_f32_16x16x32_bf16 v[60:63], a[88:91], v[120:123], v[60:63]
s_add_u32 s97, s57, 8192
ds_read_b64_tr_b16 a[248:249], v27 offset:57600
ds_read_b64_tr_b16 a[250:251], v27 offset:59648
v_mfma_f32_16x16x32_bf16 v[64:67], a[104:107], v[120:123], v[64:67]
buffer_load_dwordx4 v[228:231], v4, s[36:39], s97 offen sc1
v_mfma_f32_16x16x32_bf16 v[68:71], a[120:123], v[120:123], v[68:71]
ds_read_b64_tr_b16 a[204:205], v26 offset:61440
ds_read_b64_tr_b16 a[206:207], v26 offset:63488
ds_read_b64_tr_b16 a[220:221], v27 offset:61440
v_mfma_f32_16x16x32_bf16 v[56:59], a[76:79], v[124:127], v[56:59]
ds_read_b64_tr_b16 a[222:223], v27 offset:63488
ds_read_b64_tr_b16 a[236:237], v26 offset:61696
ds_read_b64_tr_b16 a[238:239], v26 offset:63744
v_mfma_f32_16x16x32_bf16 v[60:63], a[92:95], v[124:127], v[60:63]
s_add_u32 s97, s57, 11264
ds_read_b64_tr_b16 a[252:253], v27 offset:61696
ds_read_b64_tr_b16 a[254:255], v27 offset:63744
v_mfma_f32_16x16x32_bf16 v[64:67], a[108:111], v[124:127], v[64:67]
buffer_load_dwordx4 v[232:235], v4, s[36:39], s97 offen sc1
v_mfma_f32_16x16x32_bf16 v[68:71], a[124:127], v[124:127], v[68:71]
s_add_u32 s97, s57, 14336
buffer_load_dwordx4 v[236:239], v4, s[36:39], s97 offen sc1
s_add_u32 s97, s57, 17408
buffer_load_dwordx4 v[240:243], v4, s[36:39], s97 offen sc1
s_add_u32 s97, s57, 20480
buffer_load_dwordx4 v[244:247], v4, s[36:39], s97 offen sc1
s_waitcnt vmcnt(7) lgkmcnt(0)
s_barrier
v_max3_u32 v16, v192, v193, v194
v_max3_u32 v17, v195, v196, v197
v_max3_u32 v16, v16, v198, v199
v_max3_u32 v17, v17, v200, v201
v_max3_u32 v16, v16, v202, v203
v_max3_u32 v17, v17, v204, v205
v_max3_u32 v16, v16, v206, v207
v_max3_u32 v17, v17, v208, v209
v_max3_u32 v16, v16, v210, v211
v_max3_u32 v17, v17, v212, v213
v_max3_u32 v16, v16, v214, v215
v_max3_u32 v17, v17, v216, v217
v_max3_u32 v16, v16, v218, v219
v_max_u32 v16, v16, v17
v_cmp_eq_u32 vcc, -1, v16
s_nop 0
s_cbranch_vccnz L_h5_slow
L_h5_ok:
v_mfma_f32_16x16x32_bf16 v[56:59], a[128:131], v[192:195], v[56:59]
ds_read_b64_tr_b16 a[0:1], v24 offset:0
ds_read_b64_tr_b16 a[2:3], v24 offset:2048
v_mfma_f32_16x16x32_bf16 v[60:63], a[144:147], v[192:195], v[60:63]
ds_read_b64_tr_b16 a[16:17], v25 offset:0
ds_read_b64_tr_b16 a[18:19], v25 offset:2048
v_mfma_f32_16x16x32_bf16 v[64:67], a[160:163], v[192:195], v[64:67]
ds_read_b64_tr_b16 a[32:33], v24 offset:256
ds_read_b64_tr_b16 a[34:35], v24 offset:2304
v_mfma_f32_16x16x32_bf16 v[68:71], a[176:179], v[192:195], v[68:71]
ds_read_b64_tr_b16 a[48:49], v25 offset:256
v_mfma_f32_16x16x32_bf16 v[56:59], a[132:135], v[196:199], v[56:59]
ds_read_b64_tr_b16 a[50:51], v25 offset:2304
ds_read_b64_tr_b16 a[4:5], v24 offset:4096
v_mfma_f32_16x16x32_bf16 v[60:63], a[148:151], v[196:199], v[60:63]
ds_read_b64_tr_b16 a[6:7], v24 offset:6144
ds_read_b64_tr_b16 a[20:21], v25 offset:4096
v_mfma_f32_16x16x32_bf16 v[64:67], a[164:167], v[196:199], v[64:67]
ds_read_b64_tr_b16 a[22:23], v25 offset:6144
ds_read_b64_tr_b16 a[36:37], v24 offset:4352
v_mfma_f32_16x16x32_bf16 v[68:71], a[180:183], v[196:199], v[68:71]
ds_read_b64_tr_b16 a[38:39], v24 offset:6400
ds_read_b64_tr_b16 a[52:53], v25 offset:4352
v_mfma_f32_16x16x32_bf16 v[56:59], a[136:139], v[200:203], v[56:59]
ds_read_b64_tr_b16 a[54:55], v25 offset:6400
ds_read_b64_tr_b16 a[8:9], v24 offset:8192
v_mfma_f32_16x16x32_bf16 v[60:63], a[152:155], v[200:203], v[60:63]
ds_read_b64_tr_b16 a[10:11], v24 offset:10240
v_mfma_f32_16x16x32_bf16 v[64:67], a[168:171], v[200:203], v[64:67]
ds_read_b64_tr_b16 a[24:25], v25 offset:8192
ds_read_b64_tr_b16 a[26:27], v25 offset:10240
v_mfma_f32_16x16x32_bf16 v[68:71], a[184:187], v[200:203], v[68:71]
ds_read_b64_tr_b16 a[40:41], v24 offset:8448
ds_read_b64_tr_b16 a[42:43], v24 offset:10496
v_mfma_f32_16x16x32_bf16 v[56:59], a[140:143], v[204:207], v[56:59]
ds_read_b64_tr_b16 a[56:57], v25 offset:8448
ds_read_b64_tr_b16 a[58:59], v25 offset:10496
v_mfma_f32_16x16x32_bf16 v[60:63], a[156:159], v[204:207], v[60:63]
ds_read_b64_tr_b16 a[12:13], v24 offset:12288
ds_read_b64_tr_b16 a[14:15], v24 offset:14336
v_mfma_f32_16x16x32_bf16 v[64:67], a[172:175], v[204:207], v[64:67]
ds_read_b64_tr_b16 a[28:29], v25 offset:12288
ds_read_b64_tr_b16 a[30:31], v25 offset:14336
v_mfma_f32_16x16x32_bf16 v[68:71], a[188:191], v[204:207], v[68:71]
ds_read_b64_tr_b16 a[44:45], v24 offset:12544
ds_read_b64_tr_b16 a[46:47], v24 offset:14592
v_mfma_f32_16x16x32_bf16 v[56:59], a[192:195], v[208:211], v[56:59]
ds_read_b64_tr_b16 a[60:61], v25 offset:12544
v_mfma_f32_16x16x32_bf16 v[60:63], a[208:211], v[208:211], v[60:63]
ds_read_b64_tr_b16 a[62:63], v25 offset:14592
ds_read_b64_tr_b16 a[64:65], v24 offset:16384
v_mfma_f32_16x16x32_bf16 v[64:67], a[224:227], v[208:211], v[64:67]
ds_read_b64_tr_b16 a[66:67], v24 offset:18432
ds_read_b64_tr_b16 a[80:81], v25 offset:16384
v_mfma_f32_16x16x32_bf16 v[68:71], a[240:243], v[208:211], v[68:71]
ds_read_b64_tr_b16 a[82:83], v25 offset:18432
ds_read_b64_tr_b16 a[96:97], v24 offset:16640
v_mfma_f32_16x16x32_bf16 v[56:59], a[196:199], v[212:215], v[56:59]
ds_read_b64_tr_b16 a[98:99], v24 offset:18688
ds_read_b64_tr_b16 a[112:113], v25 offset:16640
v_mfma_f32_16x16x32_bf16 v[60:63], a[212:215], v[212:215], v[60:63]
ds_read_b64_tr_b16 a[114:115], v25 offset:18688
ds_read_b64_tr_b16 a[68:69], v24 offset:20480
v_mfma_f32_16x16x32_bf16 v[64:67], a[228:231], v[212:215], v[64:67]
ds_read_b64_tr_b16 a[70:71], v24 offset:22528
v_mfma_f32_16x16x32_bf16 v[68:71], a[244:247], v[212:215], v[68:71]
ds_read_b64_tr_b16 a[84:85], v25 offset:20480
ds_read_b64_tr_b16 a[86:87], v25 offset:22528
v_mfma_f32_16x16x32_bf16 v[56:59], a[200:203], v[216:219], v[56:59]
ds_read_b64_tr_b16 a[100:101], v24 offset:20736
ds_read_b64_tr_b16 a[102:103], v24 offset:22784
v_mfma_f32_16x16x32_bf16 v[60:63], a[216:219], v[216:219], v[60:63]
ds_read_b64_tr_b16 a[116:117], v25 offset:20736
ds_read_b64_tr_b16 a[118:119], v25 offset:22784
v_mfma_f32_16x16x32_bf16 v[64:67], a[232:235], v[216:219], v[64:67]
v_mfma_f32_16x16x32_bf16 v[68:71], a[248:251], v[216:219], v[68:71]
v_lshlrev_b32 v76, 16, v6
v_and_b32 v77, 0xffff0000, v6
v_lshlrev_b32 v78, 16, v7
v_and_b32 v79, 0xffff0000, v7
v_lshlrev_b32 v80, 16, v14
v_and_b32 v81, 0xffff0000, v14
v_lshlrev_b32 v82, 16, v15
v_and_b32 v83, 0xffff0000, v15
v_lshlrev_b32 v84, 16, v32
v_and_b32 v85, 0xffff0000, v32
v_lshlrev_b32 v86, 16, v33
v_and_b32 v87, 0xffff0000, v33
v_lshlrev_b32_e64 v88, 16, v34
v_and_b32 v89, 0xffff0000, v34
v_lshlrev_b32 v90, 16, v35
v_and_b32 v91, 0xffff0000, v35
s_mov_b32 s98, 0xbfb8aa3b
s_waitcnt vmcnt(0) lgkmcnt(0)
v_max3_u32 v16, v220, v221, v222
v_max3_u32 v17, v223, v224, v225
v_max3_u32 v16, v16, v226, v227
v_max3_u32 v17, v17, v228, v229
v_max3_u32 v16, v16, v230, v231
v_max3_u32 v17, v17, v232, v233
v_max3_u32 v16, v16, v234, v235
v_max3_u32 v17, v17, v236, v237
v_max3_u32 v16, v16, v238, v239
v_max3_u32 v17, v17, v240, v241
v_max3_u32 v16, v16, v242, v243
v_max3_u32 v17, v17, v244, v245
v_max3_u32 v16, v16, v246, v247
v_max_u32 v16, v16, v17
v_cmp_eq_u32 vcc, -1, v16
s_nop 0
s_cbranch_vccnz L_h7_slow
L_h7_ok:
v_mfma_f32_16x16x32_bf16 v[56:59], a[204:207], v[220:223], v[56:59]
v_mfma_f32_16x16x32_bf16 v[60:63], a[220:223], v[220:223], v[60:63]
v_mfma_f32_16x16x32_bf16 v[64:67], a[236:239], v[220:223], v[64:67]
v_mfma_f32_16x16x32_bf16 v[68:71], a[252:255], v[220:223], v[68:71]
v_mfma_f32_16x16x32_bf16 v[56:59], a[0:3], v[224:227], v[56:59]
v_mfma_f32_16x16x32_bf16 v[60:63], a[16:19], v[224:227], v[60:63]
v_mfma_f32_16x16x32_bf16 v[64:67], a[32:35], v[224:227], v[64:67]
v_mfma_f32_16x16x32_bf16 v[68:71], a[48:51], v[224:227], v[68:71]
v_mfma_f32_16x16x32_bf16 v[56:59], a[4:7], v[228:231], v[56:59]
v_mfma_f32_16x16x32_bf16 v[60:63], a[20:23], v[228:231], v[60:63]
v_mfma_f32_16x16x32_bf16 v[64:67], a[36:39], v[228:231], v[64:67]
v_mfma_f32_16x16x32_bf16 v[68:71], a[52:55], v[228:231], v[68:71]
v_mfma_f32_16x16x32_bf16 v[56:59], a[8:11], v[232:235], v[56:59]
v_mfma_f32_16x16x32_bf16 v[60:63], a[24:27], v[232:235], v[60:63]
v_mfma_f32_16x16x32_bf16 v[64:67], a[40:43], v[232:235], v[64:67]
v_mfma_f32_16x16x32_bf16 v[68:71], a[56:59], v[232:235], v[68:71]
v_mfma_f32_16x16x32_bf16 v[56:59], a[12:15], v[236:239], v[56:59]
v_mfma_f32_16x16x32_bf16 v[60:63], a[28:31], v[236:239], v[60:63]
v_mfma_f32_16x16x32_bf16 v[64:67], a[44:47], v[236:239], v[64:67]
v_mfma_f32_16x16x32_bf16 v[68:71], a[60:63], v[236:239], v[68:71]
v_mfma_f32_16x16x32_bf16 v[56:59], a[64:67], v[240:243], v[56:59]
v_mfma_f32_16x16x32_bf16 v[60:63], a[80:83], v[240:243], v[60:63]
v_mfma_f32_16x16x32_bf16 v[64:67], a[96:99], v[240:243], v[64:67]
v_mfma_f32_16x16x32_bf16 v[68:71], a[112:115], v[240:243], v[68:71]
v_mfma_f32_16x16x32_bf16 v[56:59], a[68:71], v[244:247], v[56:59]
v_mfma_f32_16x16x32_bf16 v[60:63], a[84:87], v[244:247], v[60:63]
v_mfma_f32_16x16x32_bf16 v[64:67], a[100:103], v[244:247], v[64:67]
v_mfma_f32_16x16x32_bf16 v[68:71], a[116:119], v[244:247], v[68:71]
s_nop 4
v_pk_mul_f32 v[128:129], v[56:57], s[98:99] op_sel_hi:[1,0]
v_pk_mul_f32 v[130:131], v[58:59], s[98:99] op_sel_hi:[1,0]
v_pk_mul_f32 v[132:133], v[60:61], s[98:99] op_sel_hi:[1,0]
v_pk_mul_f32 v[134:135], v[62:63], s[98:99] op_sel_hi:[1,0]
v_pk_mul_f32 v[136:137], v[64:65], s[98:99] op_sel_hi:[1,0]
v_pk_mul_f32 v[138:139], v[66:67], s[98:99] op_sel_hi:[1,0]
v_pk_mul_f32 v[140:141], v[68:69], s[98:99] op_sel_hi:[1,0]
v_pk_mul_f32 v[142:143], v[70:71], s[98:99] op_sel_hi:[1,0]
v_exp_f32 v128, v128
v_exp_f32 v129, v129
v_exp_f32 v130, v130
v_exp_f32 v131, v131
v_exp_f32 v132, v132
v_exp_f32 v133, v133
v_exp_f32 v134, v134
v_exp_f32 v135, v135
v_exp_f32 v136, v136
v_exp_f32 v137, v137
v_exp_f32 v138, v138
v_exp_f32 v139, v139
v_exp_f32 v140, v140
v_exp_f32 v141, v141
v_exp_f32 v142, v142
v_exp_f32_e64 v143, v143
v_pk_add_f32 v[128:129], v[128:129], 1.0 op_sel_hi:[1,0]
v_pk_add_f32 v[130:131], v[130:131], 1.0 op_sel_hi:[1,0]
v_pk_add_f32 v[132:133], v[132:133], 1.0 op_sel_hi:[1,0]
v_pk_add_f32 v[134:135], v[134:135], 1.0 op_sel_hi:[1,0]
v_pk_add_f32 v[136:137], v[136:137], 1.0 op_sel_hi:[1,0]
v_pk_add_f32 v[138:139], v[138:139], 1.0 op_sel_hi:[1,0]
v_pk_add_f32 v[140:141], v[140:141], 1.0 op_sel_hi:[1,0]
v_pk_add_f32 v[142:143], v[142:143], 1.0 op_sel_hi:[1,0]
v_pk_mul_f32 v[56:57], v[56:57], v[40:41]
v_pk_mul_f32 v[58:59], v[58:59], v[42:43]
v_pk_mul_f32 v[60:61], v[60:61], v[44:45]
v_pk_mul_f32 v[62:63], v[62:63], v[46:47]
v_pk_mul_f32 v[64:65], v[64:65], v[48:49]
v_pk_mul_f32 v[66:67], v[66:67], v[50:51]
v_pk_mul_f32 v[68:69], v[68:69], v[52:53]
v_pk_mul_f32 v[70:71], v[70:71], v[54:55]
v_rcp_f32 v128, v128
v_rcp_f32 v129, v129
v_rcp_f32 v130, v130
v_rcp_f32 v131, v131
v_rcp_f32 v132, v132
v_rcp_f32 v133, v133
v_rcp_f32 v134, v134
v_rcp_f32 v135, v135
v_pk_fma_f32 v[56:57], v[56:57], v[128:129], v[76:77]
v_pk_fma_f32 v[58:59], v[58:59], v[130:131], v[78:79]
v_pk_fma_f32 v[60:61], v[60:61], v[132:133], v[80:81]
v_pk_fma_f32 v[62:63], v[62:63], v[134:135], v[82:83]
v_cvt_pk_bf16_f32 v144, v56, v57
v_cvt_pk_bf16_f32 v145, v58, v59
v_cvt_pk_bf16_f32 v146, v60, v61
v_cvt_pk_bf16_f32 v147, v62, v63
s_nop 0
v_permlane32_swap_b32 v144, v146
v_permlane32_swap_b32 v145, v147
s_nop 0
v_permlane16_swap_b32 v144, v146
v_permlane16_swap_b32 v145, v147
buffer_store_dwordx4 v[144:147], v38, s[32:35], s59 offen offset:0 sc1
v_rcp_f32 v136, v136
v_rcp_f32 v137, v137
v_rcp_f32 v138, v138
v_rcp_f32 v139, v139
v_rcp_f32 v140, v140
v_rcp_f32 v141, v141
v_rcp_f32 v142, v142
v_rcp_f32 v143, v143
v_pk_fma_f32 v[64:65], v[64:65], v[136:137], v[84:85]
v_pk_fma_f32 v[66:67], v[66:67], v[138:139], v[86:87]
v_pk_fma_f32 v[68:69], v[68:69], v[140:141], v[88:89]
v_pk_fma_f32 v[70:71], v[70:71], v[142:143], v[90:91]
v_cvt_pk_bf16_f32 v148, v64, v65
v_cvt_pk_bf16_f32 v149, v66, v67
v_cvt_pk_bf16_f32 v150, v68, v69
v_cvt_pk_bf16_f32 v151, v70, v71
s_nop 0
v_permlane32_swap_b32 v148, v150
v_permlane32_swap_b32 v149, v151
s_nop 0
v_permlane16_swap_b32 v148, v150
v_permlane16_swap_b32 v149, v151
buffer_store_dwordx4 v[148:151], v38, s[32:35], s59 offen offset:64 sc1
s_or_b32 s3, s2, s66
s_cmp_eq_u32 s3, 0
s_cselect_b32 s3, 0, 16777216
s_mov_b64 exec, 1
buffer_store_dword v3, off, s[36:39], s3 sc1
L_end:
s_endpgm
L_roleA:
s_mov_b64 s[8:9], s[46:47]
s_mov_b32 s10, 1572864
s_mov_b32 s11, 0x20000
s_lshl_b32 s87, s68, 7
s_lshl_b32 s88, s66, 3
s_add_u32 s3, s88, s78
s_mul_i32 s3, s3, 3072
s_add_u32 s78, s3, s87
s_add_u32 s3, s88, s79
s_mul_i32 s3, s3, 3072
s_add_u32 s79, s3, s87
s_add_u32 s3, s88, s80
s_mul_i32 s3, s3, 3072
s_add_u32 s80, s3, s87
s_add_u32 s3, s88, s81
s_mul_i32 s3, s3, 3072
s_add_u32 s81, s3, s87
v_and_b32 v162, 7, v171
v_lshrrev_b32 v163, 3, v171
v_lshl_add_u32 v162, v162, 1, v163
v_lshl_add_u32 v6, v162, 10, v161
s_cmp_eq_u32 s82, 0
s_cselect_b32 s3, 0x80000000, 0
v_or_b32 v6, s3, v6
s_cmp_eq_u32 s66, 0
s_cselect_b32 s61, 0xffff0000, -1
v_lshrrev_b32_e64 v160, 1, v2
v_lshl_add_u32 v160, v160, 2, v168
v_mul_u32_u24 v160, 3072, v160
v_and_b32 v161, 1, v2
v_lshl_add_u32 v160, v161, 6, v160
s_lshl_b32 s3, s71, 1
v_xor_b32_e64 v162, s3, v169
v_lshl_add_u32 v7, v162, 4, v160
s_add_u32 m0, s84, 65536
s_sub_u32 s3, s74, 16384
s_max_i32 s3, s3, 0
s_mov_b32 exec_lo, s61
buffer_load_dwordx4 v6, s[4:7], s3 offen lds
s_mov_b32 exec_lo, -1
s_lshl3_add_u32 s18, s82, s68
s_lshl2_add_u32 s18, s18, s66
s_lshl_b32 s3, s18, 12
v_lshlrev_b32_e64 v163, 4, v1
v_lshl_add_u32 v163, v2, 10, v163
buffer_load_dwordx4 v[184:187], v163, s[4:7], s3 offen offset:0
buffer_load_dwordx4 v[188:191], v163, s[4:7], s3 offen offset:256
buffer_load_dwordx4 v[192:195], v163, s[4:7], s3 offen offset:512
buffer_load_dwordx4 v[196:199], v163, s[4:7], s3 offen offset:768
s_add_u32 m0, s86, 0
s_add_u32 s3, s78, 0
buffer_load_dwordx4 v7, s[8:11], s3 offen offset:0 lds
buffer_load_dwordx4 v7, s[8:11], s3 offen offset:1024 lds
buffer_load_dwordx4 v7, s[8:11], s3 offen offset:2048 lds
s_add_u32 m0, s86, 12288
s_add_u32 s3, s78, 98304
buffer_load_dwordx4 v7, s[8:11], s3 offen offset:0 lds
buffer_load_dwordx4 v7, s[8:11], s3 offen offset:1024 lds
buffer_load_dwordx4 v7, s[8:11], s3 offen offset:2048 lds
v_lshlrev_b32 v4, 4, v0
v_add_u32 v160, 0, v2
v_xor_b32 v162, v160, v1
v_lshlrev_b32 v162, 4, v162
v_lshl_add_u32 v220, v1, 8, v162
v_lshl_add_u32 v216, v160, 13, v162
v_add_u32 v160, 4, v2
v_xor_b32 v162, v160, v1
v_lshlrev_b32_e64 v162, 4, v162
v_lshl_add_u32 v221, v1, 8, v162
v_lshl_add_u32 v217, v160, 13, v162
v_add_u32 v160, 8, v2
v_xor_b32 v162, v160, v1
v_lshlrev_b32_e64 v162, 4, v162
v_lshl_add_u32 v222, v1, 8, v162
v_lshl_add_u32 v218, v160, 13, v162
v_add_u32 v160, 12, v2
v_xor_b32 v162, v160, v1
v_lshlrev_b32_e64 v162, 4, v162
v_lshl_add_u32 v223, v1, 8, v162
v_lshl_add_u32 v219, v160, 13, v162
v_lshrrev_b32 v160, 2, v1
v_lshlrev_b32 v160, 10, v160
v_add_u32_e64 v14, v160, v220
v_add_u32 v24, 65536, v14
v_add_u32 v15, v160, v221
v_add_u32 v25, 65536, v15
v_add_u32 v16, v160, v222
v_add_u32 v26, 65536, v16
v_add_u32 v17, v160, v223
v_add_u32 v27, 65536, v17
v_lshlrev_b32 v160, 6, v168
v_lshl_add_u32 v160, v169, 3, v160
v_mul_u32_u24 v162, 3072, v2
v_add_u32 v162, v162, v160
v_xor_b32 v163, s71, v161
v_lshl_add_u32 v163, v163, 5, v162
s_lshl_b32 s3, s70, 8
s_add_u32 s3, s3, 73728
v_add_u32 v18, s3, v163
v_add_u32 v21, 49152, v18
v_mov_b32 v32, 0x3f803f80
v_mov_b32 v33, 0x3f803f80
v_mov_b32 v34, 0x3f803f80
v_mov_b32 v35, 0x3f803f80
s_mov_b64 s[12:13], s[48:49]
s_mov_b32 s14, 524288
s_mov_b32 s15, 0x20000
s_mov_b64 s[20:21], s[54:55]
s_mov_b32 s22, 8388608
s_mov_b32 s23, 0x20000
s_mov_b64 s[24:25], s[56:57]
s_mov_b32 s26, 4096
s_mov_b32 s27, 0x20000
s_mov_b64 s[28:29], s[58:59]
s_mov_b32 s30, 704512
s_mov_b32 s31, 0x20000
s_mov_b64 s[36:37], s[64:65]
s_mov_b32 s38, 16777216
s_mov_b32 s39, 0x20000
s_mov_b32 s34, 2097152
s_mov_b32 s35, 0x20000
s_add_u32 s40, s64, 6291456
s_addc_u32 s41, s65, 0
s_mov_b32 s42, 2818048
s_mov_b32 s43, 0x20000
s_waitcnt lgkmcnt(0)
s_mul_i32 s69, s69, 0x0019660d
s_add_u32 s69, s69, 0x3c6ef35f
v_mov_b32 v3, s69
v_lshlrev_b32_e64 v160, 10, v161
v_lshl_add_u32 v160, v1, 4, v160
v_add_u32 v160, 65536, v160
ds_write_b128 v160, v[32:35]
s_nop 0
s_waitcnt vmcnt(6)
v_dot2_f32_bf16 v176, v184, v32, 0
v_dot2_f32_bf16 v178, v184, v184, 0
v_dot2_f32_bf16 v177, v185, v32, 0
v_dot2_f32_bf16 v179, v185, v185, 0
v_dot2_f32_bf16 v176, v186, v32, v176
v_dot2_f32_bf16 v178, v186, v186, v178
v_dot2_f32_bf16 v177, v187, v32, v177
v_dot2_f32_bf16 v179, v187, v187, v179
v_dot2_f32_bf16 v176, v188, v32, v176
v_dot2_f32_bf16 v178, v188, v188, v178
v_dot2_f32_bf16 v177, v189, v32, v177
v_dot2_f32_bf16 v179, v189, v189, v179
v_dot2_f32_bf16 v176, v190, v32, v176
v_dot2_f32_bf16 v178, v190, v190, v178
v_dot2_f32_bf16 v177, v191, v32, v177
v_dot2_f32_bf16 v179, v191, v191, v179
v_dot2_f32_bf16 v176, v192, v32, v176
v_dot2_f32_bf16 v178, v192, v192, v178
v_dot2_f32_bf16 v177, v193, v32, v177
v_dot2_f32_bf16 v179, v193, v193, v179
v_dot2_f32_bf16 v176, v194, v32, v176
v_dot2_f32_bf16 v178, v194, v194, v178
v_dot2_f32_bf16 v177, v195, v32, v177
v_dot2_f32_bf16 v179, v195, v195, v179
v_dot2_f32_bf16 v176, v196, v32, v176
v_dot2_f32_bf16 v178, v196, v196, v178
v_dot2_f32_bf16 v177, v197, v32, v177
v_dot2_f32_bf16 v179, v197, v197, v179
v_dot2_f32_bf16 v176, v198, v32, v176
v_dot2_f32_bf16 v178, v198, v198, v178
v_dot2_f32_bf16 v177, v199, v32, v177
v_dot2_f32_bf16 v179, v199, v199, v179
s_nop 2
v_add_f32 v176, v176, v177
v_add_f32 v178, v178, v179
s_nop 0
v_add_f32_dpp v176, v176, v176 row_ror:8 row_mask:0xf bank_mask:0xf
v_add_f32_dpp v178, v178, v178 row_ror:8 row_mask:0xf bank_mask:0xf
s_nop 0
v_add_f32_dpp v176, v176, v176 row_ror:4 row_mask:0xf bank_mask:0xf
v_add_f32_dpp v178, v178, v178 row_ror:4 row_mask:0xf bank_mask:0xf
s_nop 0
v_add_f32_dpp v176, v176, v176 row_ror:2 row_mask:0xf bank_mask:0xf
v_add_f32_dpp v178, v178, v178 row_ror:2 row_mask:0xf bank_mask:0xf
s_nop 0
v_add_f32_dpp v176, v176, v176 row_ror:1 row_mask:0xf bank_mask:0xf
v_add_f32_dpp v178, v178, v178 row_ror:1 row_mask:0xf bank_mask:0xf
v_mul_f32 v176, 0x3b000000, v176
v_mul_f32 v178, 0x3b000000, v178
v_fma_f32 v178, -v176, v176, v178
v_max_f32 v178, 0, v178
v_cvt_pk_bf16_f32 v178, v178, v178
v_and_b32 v178, 0xffff0000, v178
v_cvt_pk_bf16_f32 v176, v176, v176
v_and_b32 v176, 0xffff0000, v176
v_add_f32 v178, 0x3727c5ac, v178
v_cvt_pk_bf16_f32 v178, v178, v178
v_and_b32 v178, 0xffff0000, v178
v_sqrt_f32 v178, v178
s_nop 0
v_cvt_pk_bf16_f32 v178, v178, v178
v_and_b32 v178, 0xffff0000, v178
v_rcp_f32 v178, v178
v_mov_b32 v177, v3
v_mov_b32 v179, v3
v_lshrrev_b32 v160, 4, v0
v_lshlrev_b32 v160, 4, v160
s_lshl_b32 s3, s18, 6
s_add_u32 s3, s3, 393216
s_mov_b32 exec_lo, 65537
s_mov_b32 exec_hi, 65537
buffer_store_dwordx4 v[176:179], v160, s[36:39], s3 offen sc1
s_mov_b64 exec, -1
s_bfe_u32 s0, s2, 0x20001
s_lshr_b32 s3, s2, 5
s_lshl3_add_u32 s0, s0, s3
s_and_b32 s1, s2, 1
s_bfe_u32 s3, s2, 0x20003
s_lshl2_add_u32 s1, s1, s3
s_xor_b32 s72, s66, s3
s_lshr_b32 s3, s72, 1
s_lshl1_add_u32 s3, s0, s3
s_lshl_b32 s3, s3, 5
s_and_b32 s87, s72, 1
s_add_u32 s83, s3, s87
s_lshl_b32 s3, s83, 1
v_lshlrev_b32_e64 v251, 2, v1
buffer_load_ushort v31, v251, s[24:27], s3 offen
s_add_u32 m0, s86, 24576
s_add_u32 s3, s78, 196608
buffer_load_dwordx4 v7, s[8:11], s3 offen offset:0 lds
buffer_load_dwordx4 v7, s[8:11], s3 offen offset:1024 lds
buffer_load_dwordx4 v7, s[8:11], s3 offen offset:2048 lds
s_add_u32 m0, s86, 36864
s_add_u32 s3, s78, 294912
buffer_load_dwordx4 v7, s[8:11], s3 offen offset:0 lds
buffer_load_dwordx4 v7, s[8:11], s3 offen offset:1024 lds
buffer_load_dwordx4 v7, s[8:11], s3 offen offset:2048 lds
s_lshl_b32 s65, s66, 12
s_xor_b32 s85, s1, 4
s_lshl_b32 s89, s85, 7
v_lshlrev_b32 v244, 7, v0
s_lshr_b32 s87, s1, 1
s_or_b32 s97, s87, s1
s_and_b32 s97, s97, 3
s_lshl2_add_u32 s97, s97, s66
s_lshl4_add_u32 s97, s0, s97
s_lshl_b32 s19, s97, 14
s_and_b32 s87, s0, 7
s_lshl2_add_u32 s87, s87, s66
s_mul_i32 s87, s87, 22
v_and_b32 v245, 31, v0
v_min_u32 v245, 21, v245
v_add_u32 v245, s87, v245
v_lshl_add_u32 v245, v245, 10, s89
v_lshrrev_b32 v160, 5, v0
v_lshl_add_u32 v245, v160, 8, v245
s_lshl_b32 s97, s66, 6
v_add_u32 v160, s97, v0
v_min_u32 v160, 143, v160
s_lshl_b32 s97, s82, 7
s_sub_u32 s97, s97, 16
v_add_u32 v162, s97, v160
v_max_i32 v162, 0, v162
v_lshlrev_b32 v249, 4, v162
v_add_u32 v249, 393216, v249
v_subrev_u32 v162, 16, v160
v_lshrrev_b32 v163, 5, v162
v_lshlrev_b32 v163, 8, v163
v_and_b32 v250, 1, v162
v_lshl_add_u32 v163, v250, 7, v163
v_bfe_u32 v162, v162, 1, 4
v_lshl_add_u32 v163, v162, 2, v163
v_lshrrev_b32 v162, 1, v160
v_lshl_add_u32 v162, v250, 3, v162
v_lshlrev_b32 v162, 2, v162
v_add_u32 v162, 1024, v162
v_cmp_gt_u32 vcc, 16, v160
s_nop 1
v_cndmask_b32 v250, v163, v162, vcc
v_add_u32 v250, 159744, v250
v_add_u32 v220, s65, v220
v_add_u32 v224, 81920, v220
v_subrev_u32 v217, 1024, v217
v_add_u32 v221, s65, v221
v_add_u32 v225, 81920, v221
v_subrev_u32 v218, 2048, v218
v_add_u32 v222, s65, v222
v_add_u32 v226, 81920, v222
v_subrev_u32 v219, 3072, v219
v_add_u32 v223, s65, v223
v_add_u32 v227, 81920, v223
s_lshl_b32 s97, s83, 12
s_add_u32 s24, s97, s60
s_lshl2_add_u32 s97, s0, s72
s_lshl3_add_u32 s97, s97, s1
s_mul_i32 s97, s97, 3072
s_add_u32 s58, s97, 3145728
v_mov_b32 v188, -1
s_waitcnt vmcnt(8) lgkmcnt(0)
s_barrier
ds_read_b64_tr_b16 a[196:197], v18 offset:0
ds_read_b64_tr_b16 a[198:199], v18 offset:512
ds_read_b64_tr_b16 a[200:201], v18 offset:1024
ds_read_b64_tr_b16 a[202:203], v18 offset:1536
ds_read_b64_tr_b16 a[204:205], v18 offset:2048
ds_read_b64_tr_b16 a[206:207], v18 offset:2560
ds_read_b128 a[160:163], v14 offset:0
ds_read_b128 a[164:167], v14 offset:1024
ds_read_b128 a[168:171], v14 offset:8192
ds_read_b128 a[172:175], v14 offset:9216
ds_read_b128 a[176:179], v14 offset:16384
ds_read_b128 a[180:183], v14 offset:17408
ds_read_b128 a[184:187], v14 offset:24576
ds_read_b128 a[188:191], v14 offset:25600
ds_read_b128 a[192:195], v24 offset:0
s_waitcnt lgkmcnt(0)
v_mfma_f32_16x16x32_bf16 v[40:43], a[196:199], a[160:163], 0
s_add_u32 m0, s84, 32768
s_add_u32 s3, s75, 0
v_mfma_f32_16x16x32_bf16 v[44:47], a[196:199], a[164:167], 0
buffer_load_dwordx4 v5, s[4:7], s3 offen lds
v_mfma_f32_16x16x32_bf16 v[48:51], a[196:199], a[168:171], 0
ds_read_b64_tr_b16 a[244:245], v18 offset:12288
v_mov_b32_e64 v189, -1
v_mfma_f32_16x16x32_bf16 v[52:55], a[196:199], a[172:175], 0
ds_read_b64_tr_b16 a[246:247], v18 offset:12800
ds_read_b64_tr_b16 a[248:249], v18 offset:13312
v_mfma_f32_16x16x32_bf16 v[56:59], a[196:199], a[176:179], 0
ds_read_b64_tr_b16 a[250:251], v18 offset:13824
v_mov_b32_e64 v190, -1
v_mfma_f32_16x16x32_bf16 v[60:63], a[196:199], a[180:183], 0
buffer_load_dwordx4 v5, s[4:7], s3 offen offset:1024 lds
v_mfma_f32_16x16x32_bf16 v[64:67], a[196:199], a[184:187], 0
s_add_u32 m0, s84, 40960
v_mfma_f32_16x16x32_bf16 v[68:71], a[196:199], a[188:191], 0
s_add_u32 s3, s75, 32768
ds_read_b64_tr_b16 a[252:253], v18 offset:14336
v_mfma_f32_16x16x32_bf16 v[144:147], a[196:199], v[32:35], 0
buffer_load_dwordx4 v5, s[4:7], s3 offen lds
v_mfma_f32_16x16x32_bf16 v[72:75], a[200:203], a[160:163], 0
ds_read_b64_tr_b16 a[254:255], v18 offset:14848
v_mov_b32_e64 v191, -1
v_mfma_f32_16x16x32_bf16 v[76:79], a[200:203], a[164:167], 0
ds_read_b128 a[208:211], v15 offset:0
ds_read_b128 a[212:215], v15 offset:1024
v_mfma_f32_16x16x32_bf16 v[80:83], a[200:203], a[168:171], 0
buffer_load_dwordx4 v5, s[4:7], s3 offen offset:1024 lds
v_mfma_f32_16x16x32_bf16 v[84:87], a[200:203], a[172:175], 0
ds_read_b128 a[216:219], v15 offset:8192
s_mov_b32 s97, 0
v_mfma_f32_16x16x32_bf16 v[88:91], a[200:203], a[176:179], 0
s_add_u32 m0, s84, 49152
s_add_u32 s97, s97, 159744
v_mfma_f32_16x16x32_bf16 v[92:95], a[200:203], a[180:183], 0
s_add_u32 s3, s75, 65536
ds_read_b128 a[220:223], v15 offset:9216
v_mfma_f32_16x16x32_bf16 v[96:99], a[200:203], a[184:187], 0
buffer_load_dwordx4 v5, s[4:7], s3 offen lds
v_mfma_f32_16x16x32_bf16 v[100:103], a[200:203], a[188:191], 0
ds_read_b128 a[224:227], v15 offset:16384
v_add_u32 v251, s97, v251
v_mfma_f32_16x16x32_bf16 v[104:107], a[200:203], a[192:195], 0
ds_read_b128 a[228:231], v15 offset:17408
ds_read_b128 a[232:235], v15 offset:24576
v_mfma_f32_16x16x32_bf16 v[108:111], a[160:163], a[204:207], 0
buffer_load_dwordx4 v5, s[4:7], s3 offen offset:1024 lds
v_mfma_f32_16x16x32_bf16 v[112:115], a[164:167], a[204:207], 0
s_add_u32 m0, s84, 57344
v_mfma_f32_16x16x32_bf16 v[116:119], a[168:171], a[204:207], 0
s_add_u32 s3, s75, 98304
ds_read_b128 a[236:239], v15 offset:25600
v_mfma_f32_16x16x32_bf16 v[120:123], a[172:175], a[204:207], 0
buffer_load_dwordx4 v5, s[4:7], s3 offen lds
v_mfma_f32_16x16x32_bf16 v[124:127], a[176:179], a[204:207], 0
ds_read_b128 a[240:243], v25 offset:0
v_lshl_add_u32 v252, v2, 4, s97
v_mfma_f32_16x16x32_bf16 v[128:131], a[180:183], a[204:207], 0
s_lshl2_add_u32 s97, s82, s66
s_lshl3_add_u32 s97, s97, s68
v_mfma_f32_16x16x32_bf16 v[132:135], a[184:187], a[204:207], 0
s_lshl_b32 s97, s97, 7
v_mfma_f32_16x16x32_bf16 v[136:139], a[188:191], a[204:207], 0
buffer_load_dwordx4 v5, s[4:7], s3 offen offset:1024 lds
v_mfma_f32_16x16x32_bf16 v[140:143], a[192:195], a[204:207], 0
s_add_u32 s49, s97, 13697024
s_lshl_b32 s97, s66, 13
s_waitcnt lgkmcnt(0)
s_waitcnt vmcnt(8)
s_barrier
v_mfma_f32_16x16x32_bf16 v[40:43], a[244:247], a[208:211], v[40:43]
s_add_u32 m0, s84, 66560
s_sub_u32 s3, s75, 16384
s_max_i32 s3, s3, 0
v_mfma_f32_16x16x32_bf16 v[44:47], a[244:247], a[212:215], v[44:47]
s_mov_b32 exec_lo, s61
buffer_load_dwordx4 v6, s[4:7], s3 offen lds
s_mov_b32 exec_lo, -1
v_mfma_f32_16x16x32_bf16 v[48:51], a[244:247], a[216:219], v[48:51]
ds_read_b64_tr_b16 a[196:197], v18 offset:24576
s_add_u32 s64, s97, s89
v_mfma_f32_16x16x32_bf16 v[52:55], a[244:247], a[220:223], v[52:55]
s_add_u32 m0, s86, 49152
ds_read_b64_tr_b16 a[198:199], v18 offset:25088
v_mfma_f32_16x16x32_bf16 v[56:59], a[244:247], a[224:227], v[56:59]
s_add_u32 s3, s79, 0
v_mfma_f32_16x16x32_bf16 v[60:63], a[244:247], a[228:231], v[60:63]
buffer_load_dwordx4 v7, s[8:11], s3 offen offset:0 lds
v_mfma_f32_16x16x32_bf16 v[64:67], a[244:247], a[232:235], v[64:67]
ds_read_b64_tr_b16 a[200:201], v18 offset:25600
v_bfe_u32 v160, v0, 2, 1
v_mfma_f32_16x16x32_bf16 v[68:71], a[244:247], a[236:239], v[68:71]
ds_read_b64_tr_b16 a[202:203], v18 offset:26112
v_add_u32_e64 v160, s1, v160
v_mfma_f32_16x16x32_bf16 v[144:147], a[244:247], v[32:35], v[144:147]
ds_read_b64_tr_b16 a[204:205], v18 offset:26624
v_mfma_f32_16x16x32_bf16 v[72:75], a[248:251], a[208:211], v[72:75]
buffer_load_dwordx4 v7, s[8:11], s3 offen offset:1024 lds
v_mfma_f32_16x16x32_bf16 v[76:79], a[248:251], a[212:215], v[76:79]
ds_read_b64_tr_b16 a[206:207], v18 offset:27136
v_min_u32_e64 v160, 7, v160
v_mfma_f32_16x16x32_bf16 v[80:83], a[248:251], a[216:219], v[80:83]
ds_read_b128 a[160:163], v16 offset:0
ds_read_b128 a[164:167], v16 offset:1024
v_mfma_f32_16x16x32_bf16 v[84:87], a[248:251], a[220:223], v[84:87]
ds_read_b128 a[168:171], v16 offset:8192
v_lshl_add_u32 v160, v160, 4, v169
v_mfma_f32_16x16x32_bf16 v[88:91], a[248:251], a[224:227], v[88:91]
buffer_load_dwordx4 v7, s[8:11], s3 offen offset:2048 lds
v_mfma_f32_16x16x32_bf16 v[92:95], a[248:251], a[228:231], v[92:95]
ds_read_b128 a[172:175], v16 offset:9216
v_mfma_f32_16x16x32_bf16 v[96:99], a[248:251], a[232:235], v[96:99]
s_add_u32 m0, s86, 61440
s_add_u32 s52, s60, 458752
v_mfma_f32_16x16x32_bf16 v[100:103], a[248:251], a[236:239], v[100:103]
s_add_u32 s3, s79, 98304
ds_read_b128 a[176:179], v16 offset:16384
v_mfma_f32_16x16x32_bf16 v[104:107], a[248:251], a[240:243], v[104:107]
buffer_load_dwordx4 v7, s[8:11], s3 offen offset:0 lds
v_mfma_f32_16x16x32_bf16 v[108:111], a[208:211], a[252:255], v[108:111]
ds_read_b128 a[180:183], v16 offset:17408
v_lshlrev_b32 v37, 8, v160
v_mfma_f32_16x16x32_bf16 v[112:115], a[212:215], a[252:255], v[112:115]
ds_read_b128 a[184:187], v16 offset:24576
v_lshrrev_b32 v160, 1, v2
v_mfma_f32_16x16x32_bf16 v[116:119], a[216:219], a[252:255], v[116:119]
ds_read_b128 a[188:191], v16 offset:25600
v_mfma_f32_16x16x32_bf16 v[120:123], a[220:223], a[252:255], v[120:123]
buffer_load_dwordx4 v7, s[8:11], s3 offen offset:1024 lds
v_mfma_f32_16x16x32_bf16 v[124:127], a[224:227], a[252:255], v[124:127]
ds_read_b128 a[192:195], v26 offset:0
v_lshl_add_u32 v39, v160, 2, v168
v_mfma_f32_16x16x32_bf16 v[128:131], a[228:231], a[252:255], v[128:131]
v_lshlrev_b32_e64 v39, 10, v39
v_mfma_f32_16x16x32_bf16 v[132:135], a[232:235], a[252:255], v[132:135]
v_lshl_add_u32 v39, v161, 6, v39
v_lshlrev_b32_e64 v160, 1, v160
v_mfma_f32_16x16x32_bf16 v[136:139], a[236:239], a[252:255], v[136:139]
buffer_load_dwordx4 v7, s[8:11], s3 offen offset:2048 lds
v_mfma_f32_16x16x32_bf16 v[140:143], a[240:243], a[252:255], v[140:143]
v_xor_b32 v160, v169, v160
s_waitcnt lgkmcnt(0)
v_mfma_f32_16x16x32_bf16 v[40:43], a[196:199], a[160:163], v[40:43]
s_add_u32 m0, s86, 73728
v_lshl_add_u32 v39, v160, 4, v39
v_mfma_f32_16x16x32_bf16 v[44:47], a[196:199], a[164:167], v[44:47]
s_add_u32 s3, s79, 196608
ds_read_b64_tr_b16 a[244:245], v18 offset:36864
v_mfma_f32_16x16x32_bf16 v[48:51], a[196:199], a[168:171], v[48:51]
buffer_load_dwordx4 v7, s[8:11], s3 offen offset:0 lds
v_mfma_f32_16x16x32_bf16 v[52:55], a[196:199], a[172:175], v[52:55]
ds_read_b64_tr_b16 a[246:247], v18 offset:37376
v_mfma_f32_16x16x32_bf16 v[56:59], a[196:199], a[176:179], v[56:59]
ds_read_b64_tr_b16 a[248:249], v18 offset:37888
s_lshl_b32 s97, s82, 3
v_mfma_f32_16x16x32_bf16 v[60:63], a[196:199], a[180:183], v[60:63]
ds_read_b64_tr_b16 a[250:251], v18 offset:38400
v_mfma_f32_16x16x32_bf16 v[64:67], a[196:199], a[184:187], v[64:67]
buffer_load_dwordx4 v7, s[8:11], s3 offen offset:1024 lds
v_mfma_f32_16x16x32_bf16 v[68:71], a[196:199], a[188:191], v[68:71]
ds_read_b64_tr_b16 a[252:253], v18 offset:38912
s_add_u32 s97, s97, s66
v_mfma_f32_16x16x32_bf16 v[144:147], a[196:199], v[32:35], v[144:147]
ds_read_b64_tr_b16 a[254:255], v18 offset:39424
s_lshl_b32 s97, s97, 3
v_mfma_f32_16x16x32_bf16 v[72:75], a[200:203], a[160:163], v[72:75]
ds_read_b128 a[208:211], v17 offset:0
v_mfma_f32_16x16x32_bf16 v[76:79], a[200:203], a[164:167], v[76:79]
ds_read_b128 a[212:215], v17 offset:1024
s_add_u32 s97, s97, s68
v_mfma_f32_16x16x32_bf16 v[80:83], a[200:203], a[168:171], v[80:83]
buffer_load_dwordx4 v7, s[8:11], s3 offen offset:2048 lds
v_mfma_f32_16x16x32_bf16 v[84:87], a[200:203], a[172:175], v[84:87]
s_lshl_b32 s97, s97, 11
v_mfma_f32_16x16x32_bf16 v[88:91], a[200:203], a[176:179], v[88:91]
s_add_u32 m0, s86, 0
ds_read_b128 a[216:219], v17 offset:8192
v_mfma_f32_16x16x32_bf16 v[92:95], a[200:203], a[180:183], v[92:95]
s_add_u32 s3, s79, 294912
s_add_u32 s56, s97, 1048576
v_mfma_f32_16x16x32_bf16 v[96:99], a[200:203], a[184:187], v[96:99]
buffer_load_dwordx4 v7, s[8:11], s3 offen offset:0 lds
v_mfma_f32_16x16x32_bf16 v[100:103], a[200:203], a[188:191], v[100:103]
ds_read_b128 a[220:223], v17 offset:9216
v_mfma_f32_16x16x32_bf16 v[104:107], a[200:203], a[192:195], v[104:107]
ds_read_b128 a[224:227], v17 offset:16384
s_lshl_b32 s88, s70, 10
v_mfma_f32_16x16x32_bf16 v[108:111], a[160:163], a[204:207], v[108:111]
ds_read_b128 a[228:231], v17 offset:17408
s_lshl_b32 s87, s71, 3
v_mfma_f32_16x16x32_bf16 v[112:115], a[164:167], a[204:207], v[112:115]
ds_read_b128 a[232:235], v17 offset:24576
v_mfma_f32_16x16x32_bf16 v[116:119], a[168:171], a[204:207], v[116:119]
buffer_load_dwordx4 v7, s[8:11], s3 offen offset:1024 lds
v_mfma_f32_16x16x32_bf16 v[120:123], a[172:175], a[204:207], v[120:123]
ds_read_b128 a[236:239], v17 offset:25600
s_add_u32 s88, s88, s87
v_mfma_f32_16x16x32_bf16 v[124:127], a[176:179], a[204:207], v[124:127]
ds_read_b128 a[240:243], v27 offset:0
v_mfma_f32_16x16x32_bf16 v[128:131], a[180:183], a[204:207], v[128:131]
s_add_u32 s88, s88, 65536
v_add_u32 v253, s88, v4
v_mfma_f32_16x16x32_bf16 v[132:135], a[184:187], a[204:207], v[132:135]
buffer_load_dwordx4 v7, s[8:11], s3 offen offset:2048 lds
v_mfma_f32_16x16x32_bf16 v[136:139], a[188:191], a[204:207], v[136:139]
s_lshl_b32 s87, s66, 11
v_mfma_f32_16x16x32_bf16 v[140:143], a[192:195], a[204:207], v[140:143]
s_add_u32 s87, s87, 65536
s_waitcnt lgkmcnt(0)
s_waitcnt vmcnt(6)
s_barrier
v_mfma_f32_16x16x32_bf16 v[40:43], a[244:247], a[208:211], v[40:43]
s_add_u32 m0, s84, 0
s_add_u32 s3, s76, 0
v_mfma_f32_16x16x32_bf16 v[44:47], a[244:247], a[212:215], v[44:47]
buffer_load_dwordx4 v5, s[4:7], s3 offen lds
v_add_u32_e64 v254, s87, v4
v_mfma_f32_16x16x32_bf16 v[48:51], a[244:247], a[216:219], v[48:51]
ds_read_b64_tr_b16 a[196:197], v21 offset:0
v_mov_b32 v172, 0xf149f2ca
v_mfma_f32_16x16x32_bf16 v[52:55], a[244:247], a[220:223], v[52:55]
ds_read_b64_tr_b16 a[198:199], v21 offset:512
ds_read_b64_tr_b16 a[200:201], v21 offset:1024
v_mfma_f32_16x16x32_bf16 v[56:59], a[244:247], a[224:227], v[56:59]
ds_read_b64_tr_b16 a[202:203], v21 offset:1536
v_lshlrev_b32_e64 v173, 2, v2
v_mfma_f32_16x16x32_bf16 v[60:63], a[244:247], a[228:231], v[60:63]
buffer_load_dwordx4 v5, s[4:7], s3 offen offset:1024 lds
v_mfma_f32_16x16x32_bf16 v[64:67], a[244:247], a[232:235], v[64:67]
s_add_u32 m0, s84, 8192
v_sub_u32_e64 v173, v1, v173
v_mfma_f32_16x16x32_bf16 v[68:71], a[244:247], a[236:239], v[68:71]
s_add_u32 s3, s76, 32768
ds_read_b64_tr_b16 a[204:205], v21 offset:2048
v_mfma_f32_16x16x32_bf16 v[144:147], a[244:247], v[32:35], v[144:147]
buffer_load_dwordx4 v5, s[4:7], s3 offen lds
v_mfma_f32_16x16x32_bf16 v[72:75], a[248:251], a[208:211], v[72:75]
ds_read_b64_tr_b16 a[206:207], v21 offset:2560
s_cmp_eq_u32 s82, 0
s_cselect_b32 s87, 0, 7
v_mfma_f32_16x16x32_bf16 v[76:79], a[248:251], a[212:215], v[76:79]
ds_read_b128 a[160:163], v14 offset:32768
ds_read_b128 a[164:167], v14 offset:33792
v_mfma_f32_16x16x32_bf16 v[80:83], a[248:251], a[216:219], v[80:83]
buffer_load_dwordx4 v5, s[4:7], s3 offen offset:1024 lds
v_mfma_f32_16x16x32_bf16 v[84:87], a[248:251], a[220:223], v[84:87]
ds_read_b128 a[168:171], v14 offset:40960
v_cmp_gt_u32 s[98:99], 2, v2
v_mfma_f32_16x16x32_bf16 v[88:91], a[248:251], a[224:227], v[88:91]
s_add_u32 m0, s84, 16384
v_subrev_u32_e64 v174, 0, v173
v_mfma_f32_16x16x32_bf16 v[92:95], a[248:251], a[228:231], v[92:95]
s_add_u32 s3, s76, 65536
ds_read_b128 a[172:175], v14 offset:41984
v_mfma_f32_16x16x32_bf16 v[96:99], a[248:251], a[232:235], v[96:99]
buffer_load_dwordx4 v5, s[4:7], s3 offen lds
v_mfma_f32_16x16x32_bf16 v[100:103], a[248:251], a[236:239], v[100:103]
ds_read_b128 a[176:179], v14 offset:49152
v_cmp_gt_u32 vcc, 8, v174
v_mfma_f32_16x16x32_bf16 v[104:107], a[248:251], a[240:243], v[104:107]
ds_read_b128 a[180:183], v14 offset:50176
ds_read_b128 a[184:187], v14 offset:57344
v_add_u32 v175, 15, v174
v_mfma_f32_16x16x32_bf16 v[108:111], a[208:211], a[252:255], v[108:111]
buffer_load_dwordx4 v5, s[4:7], s3 offen offset:1024 lds
v_mfma_f32_16x16x32_bf16 v[112:115], a[212:215], a[252:255], v[112:115]
s_add_u32 m0, s84, 24576
v_add_u32_e64 v174, 7, v174
v_mfma_f32_16x16x32_bf16 v[116:119], a[216:219], a[252:255], v[116:119]
s_add_u32 s3, s76, 98304
ds_read_b128 a[188:191], v14 offset:58368
v_mfma_f32_16x16x32_bf16 v[120:123], a[220:223], a[252:255], v[120:123]
buffer_load_dwordx4 v5, s[4:7], s3 offen lds
v_mfma_f32_16x16x32_bf16 v[124:127], a[224:227], a[252:255], v[124:127]
ds_read_b128 a[192:195], v24 offset:1024
v_cndmask_b32 v228, v172, 0, vcc
v_mfma_f32_16x16x32_bf16 v[128:131], a[228:231], a[252:255], v[128:131]
v_cmp_gt_u32 vcc, 7, v175
v_mfma_f32_16x16x32_bf16 v[132:135], a[232:235], a[252:255], v[132:135]
v_cmp_gt_u32 s[90:91], s87, v175
v_mfma_f32_16x16x32_bf16 v[136:139], a[236:239], a[252:255], v[136:139]
buffer_load_dwordx4 v5, s[4:7], s3 offen offset:1024 lds
v_cmp_gt_u32 s[92:93], s87, v174
v_mfma_f32_16x16x32_bf16 v[140:143], a[240:243], a[252:255], v[140:143]
v_cndmask_b32 v232, v172, 0, vcc
s_waitcnt lgkmcnt(0)
v_mfma_f32_16x16x32_bf16 v[40:43], a[196:199], a[160:163], v[40:43]
s_add_u32 m0, s84, 65536
s_sub_u32 s3, s76, 16384
s_max_i32 s3, s3, 0
v_mfma_f32_16x16x32_bf16 v[44:47], a[196:199], a[164:167], v[44:47]
s_mov_b32 exec_lo, s61
buffer_load_dwordx4 v6, s[4:7], s3 offen lds
s_mov_b32 exec_lo, -1
v_mfma_f32_16x16x32_bf16 v[48:51], a[196:199], a[168:171], v[48:51]
ds_read_b64_tr_b16 a[244:245], v21 offset:12288
v_cndmask_b32 v240, v172, 0, s[90:91]
v_mfma_f32_16x16x32_bf16 v[52:55], a[196:199], a[172:175], v[52:55]
s_add_u32 m0, s86, 12288
ds_read_b64_tr_b16 a[246:247], v21 offset:12800
v_mfma_f32_16x16x32_bf16 v[56:59], a[196:199], a[176:179], v[56:59]
s_add_u32 s3, s80, 0
s_and_b64 vcc, s[92:93], s[98:99]
s_nop 0
v_mfma_f32_16x16x32_bf16 v[60:63], a[196:199], a[180:183], v[60:63]
buffer_load_dwordx4 v7, s[8:11], s3 offen offset:0 lds
v_mfma_f32_16x16x32_bf16 v[64:67], a[196:199], a[184:187], v[64:67]
ds_read_b64_tr_b16 a[248:249], v21 offset:13312
v_mfma_f32_16x16x32_bf16 v[68:71], a[196:199], a[188:191], v[68:71]
ds_read_b64_tr_b16 a[250:251], v21 offset:13824
ds_read_b64_tr_b16 a[252:253], v21 offset:14336
v_mfma_f32_16x16x32_bf16 v[144:147], a[196:199], v[32:35], v[144:147]
buffer_load_dwordx4 v7, s[8:11], s3 offen offset:1024 lds
v_mfma_f32_16x16x32_bf16 v[72:75], a[200:203], a[160:163], v[72:75]
ds_read_b64_tr_b16 a[254:255], v21 offset:14848
v_cndmask_b32 v236, v172, 0, vcc
v_mfma_f32_16x16x32_bf16 v[76:79], a[200:203], a[164:167], v[76:79]
ds_read_b128 a[208:211], v15 offset:32768
v_subrev_u32_e64 v174, 1, v173
v_mfma_f32_16x16x32_bf16 v[80:83], a[200:203], a[168:171], v[80:83]
buffer_load_dwordx4 v7, s[8:11], s3 offen offset:2048 lds
v_mfma_f32_16x16x32_bf16 v[84:87], a[200:203], a[172:175], v[84:87]
ds_read_b128 a[212:215], v15 offset:33792
v_cmp_gt_u32 vcc, 8, v174
v_mfma_f32_16x16x32_bf16 v[88:91], a[200:203], a[176:179], v[88:91]
s_add_u32 m0, s86, 24576
ds_read_b128 a[216:219], v15 offset:40960
v_mfma_f32_16x16x32_bf16 v[92:95], a[200:203], a[180:183], v[92:95]
s_add_u32 s3, s80, 98304
v_mfma_f32_16x16x32_bf16 v[96:99], a[200:203], a[184:187], v[96:99]
buffer_load_dwordx4 v7, s[8:11], s3 offen offset:0 lds
v_mfma_f32_16x16x32_bf16 v[100:103], a[200:203], a[188:191], v[100:103]
ds_read_b128 a[220:223], v15 offset:41984
v_add_u32 v175, 15, v174
v_mfma_f32_16x16x32_bf16 v[104:107], a[200:203], a[192:195], v[104:107]
ds_read_b128 a[224:227], v15 offset:49152
ds_read_b128 a[228:231], v15 offset:50176
v_mfma_f32_16x16x32_bf16 v[108:111], a[160:163], a[204:207], v[108:111]
buffer_load_dwordx4 v7, s[8:11], s3 offen offset:1024 lds
v_mfma_f32_16x16x32_bf16 v[112:115], a[164:167], a[204:207], v[112:115]
ds_read_b128 a[232:235], v15 offset:57344
v_add_u32_e64 v174, 7, v174
v_mfma_f32_16x16x32_bf16 v[116:119], a[168:171], a[204:207], v[116:119]
ds_read_b128 a[236:239], v15 offset:58368
v_cndmask_b32 v229, v172, 0, vcc
v_mfma_f32_16x16x32_bf16 v[120:123], a[172:175], a[204:207], v[120:123]
buffer_load_dwordx4 v7, s[8:11], s3 offen offset:2048 lds
v_mfma_f32_16x16x32_bf16 v[124:127], a[176:179], a[204:207], v[124:127]
ds_read_b128 a[240:243], v25 offset:1024
v_mfma_f32_16x16x32_bf16 v[128:131], a[180:183], a[204:207], v[128:131]
v_cmp_gt_u32 vcc, 7, v175
v_cmp_gt_u32 s[90:91], s87, v175
v_mfma_f32_16x16x32_bf16 v[132:135], a[184:187], a[204:207], v[132:135]
s_add_u32 s3, s19, 0
v_cmp_gt_u32 s[92:93], s87, v174
v_mfma_f32_16x16x32_bf16 v[136:139], a[188:191], a[204:207], v[136:139]
buffer_load_dword v248, v244, s[20:23], s3 offen
v_mfma_f32_16x16x32_bf16 v[140:143], a[192:195], a[204:207], v[140:143]
v_cndmask_b32 v233, v172, 0, vcc
s_waitcnt lgkmcnt(0)
s_waitcnt vmcnt(16)
s_barrier
v_mfma_f32_16x16x32_bf16 v[40:43], a[244:247], a[208:211], v[40:43]
s_add_u32 m0, s86, 36864
v_cndmask_b32 v241, v172, 0, s[90:91]
v_mfma_f32_16x16x32_bf16 v[44:47], a[244:247], a[212:215], v[44:47]
s_add_u32 s3, s80, 196608
ds_read_b64_tr_b16 a[196:197], v21 offset:24576
v_mfma_f32_16x16x32_bf16 v[48:51], a[244:247], a[216:219], v[48:51]
buffer_load_dwordx4 v7, s[8:11], s3 offen offset:0 lds
v_mfma_f32_16x16x32_bf16 v[52:55], a[244:247], a[220:223], v[52:55]
ds_read_b64_tr_b16 a[198:199], v21 offset:25088
v_mfma_f32_16x16x32_bf16 v[56:59], a[244:247], a[224:227], v[56:59]
ds_read_b64_tr_b16 a[200:201], v21 offset:25600
s_and_b64 vcc, s[92:93], s[98:99]
v_mfma_f32_16x16x32_bf16 v[60:63], a[244:247], a[228:231], v[60:63]
ds_read_b64_tr_b16 a[202:203], v21 offset:26112
v_cndmask_b32 v237, v172, 0, vcc
v_mfma_f32_16x16x32_bf16 v[64:67], a[244:247], a[232:235], v[64:67]
buffer_load_dwordx4 v7, s[8:11], s3 offen offset:1024 lds
v_mfma_f32_16x16x32_bf16 v[68:71], a[244:247], a[236:239], v[68:71]
ds_read_b64_tr_b16 a[204:205], v21 offset:26624
v_mfma_f32_16x16x32_bf16 v[144:147], a[244:247], v[32:35], v[144:147]
ds_read_b64_tr_b16 a[206:207], v21 offset:27136
v_subrev_u32_e64 v174, 2, v173
v_mfma_f32_16x16x32_bf16 v[72:75], a[248:251], a[208:211], v[72:75]
ds_read_b128 a[160:163], v16 offset:32768
v_cmp_gt_u32 vcc, 8, v174
v_mfma_f32_16x16x32_bf16 v[76:79], a[248:251], a[212:215], v[76:79]
ds_read_b128 a[164:167], v16 offset:33792
v_mfma_f32_16x16x32_bf16 v[80:83], a[248:251], a[216:219], v[80:83]
buffer_load_dwordx4 v7, s[8:11], s3 offen offset:2048 lds
v_mfma_f32_16x16x32_bf16 v[84:87], a[248:251], a[220:223], v[84:87]
v_add_u32 v175, 15, v174
v_add_u32_e64 v174, 7, v174
v_mfma_f32_16x16x32_bf16 v[88:91], a[248:251], a[224:227], v[88:91]
s_add_u32 m0, s86, 49152
ds_read_b128 a[168:171], v16 offset:40960
v_mfma_f32_16x16x32_bf16 v[92:95], a[248:251], a[228:231], v[92:95]
s_add_u32 s3, s80, 294912
v_mfma_f32_16x16x32_bf16 v[96:99], a[248:251], a[232:235], v[96:99]
buffer_load_dwordx4 v7, s[8:11], s3 offen offset:0 lds
v_mfma_f32_16x16x32_bf16 v[100:103], a[248:251], a[236:239], v[100:103]
ds_read_b128 a[172:175], v16 offset:41984
v_cndmask_b32 v230, v172, 0, vcc
v_mfma_f32_16x16x32_bf16 v[104:107], a[248:251], a[240:243], v[104:107]
ds_read_b128 a[176:179], v16 offset:49152
v_mfma_f32_16x16x32_bf16 v[108:111], a[208:211], a[252:255], v[108:111]
ds_read_b128 a[180:183], v16 offset:50176
v_cmp_gt_u32 vcc, 7, v175
s_nop 0
v_mfma_f32_16x16x32_bf16 v[112:115], a[212:215], a[252:255], v[112:115]
ds_read_b128 a[184:187], v16 offset:57344
v_cmp_gt_u32 s[90:91], s87, v175
v_mfma_f32_16x16x32_bf16 v[116:119], a[216:219], a[252:255], v[116:119]
buffer_load_dwordx4 v7, s[8:11], s3 offen offset:1024 lds
v_mfma_f32_16x16x32_bf16 v[120:123], a[220:223], a[252:255], v[120:123]
ds_read_b128 a[188:191], v16 offset:58368
v_mfma_f32_16x16x32_bf16 v[124:127], a[224:227], a[252:255], v[124:127]
ds_read_b128 a[192:195], v26 offset:1024
v_cmp_gt_u32 s[92:93], s87, v174
v_mfma_f32_16x16x32_bf16 v[128:131], a[228:231], a[252:255], v[128:131]
v_cndmask_b32 v234, v172, 0, vcc
v_mfma_f32_16x16x32_bf16 v[132:135], a[232:235], a[252:255], v[132:135]
buffer_load_dwordx4 v7, s[8:11], s3 offen offset:2048 lds
v_mfma_f32_16x16x32_bf16 v[136:139], a[236:239], a[252:255], v[136:139]
v_cndmask_b32 v242, v172, 0, s[90:91]
s_and_b64 vcc, s[92:93], s[98:99]
v_mfma_f32_16x16x32_bf16 v[140:143], a[240:243], a[252:255], v[140:143]
v_cndmask_b32 v238, v172, 0, vcc
s_waitcnt lgkmcnt(0)
v_mfma_f32_16x16x32_bf16 v[40:43], a[196:199], a[160:163], v[40:43]
ds_read_b64_tr_b16 a[244:245], v18 offset:0
v_mfma_f32_16x16x32_bf16 v[44:47], a[196:199], a[164:167], v[44:47]
v_subrev_u32_e64 v174, 3, v173
v_mfma_f32_16x16x32_bf16 v[48:51], a[196:199], a[168:171], v[48:51]
ds_read_b64_tr_b16 a[246:247], v18 offset:512
v_mfma_f32_16x16x32_bf16 v[52:55], a[196:199], a[172:175], v[52:55]
ds_read_b64_tr_b16 a[248:249], v18 offset:1024
v_cmp_gt_u32 vcc, 8, v174
v_mfma_f32_16x16x32_bf16 v[56:59], a[196:199], a[176:179], v[56:59]
v_mfma_f32_16x16x32_bf16 v[60:63], a[196:199], a[180:183], v[60:63]
ds_read_b64_tr_b16 a[250:251], v18 offset:1536
v_add_u32 v175, 15, v174
v_mfma_f32_16x16x32_bf16 v[64:67], a[196:199], a[184:187], v[64:67]
ds_read_b64_tr_b16 a[252:253], v18 offset:2048
v_mfma_f32_16x16x32_bf16 v[68:71], a[196:199], a[188:191], v[68:71]
ds_read_b64_tr_b16 a[254:255], v18 offset:2560
v_mfma_f32_16x16x32_bf16 v[144:147], a[196:199], v[32:35], v[144:147]
v_add_u32_e64 v174, 7, v174
v_mfma_f32_16x16x32_bf16 v[72:75], a[200:203], a[160:163], v[72:75]
ds_read_b128 a[208:211], v17 offset:32768
v_mfma_f32_16x16x32_bf16 v[76:79], a[200:203], a[164:167], v[76:79]
ds_read_b128 a[212:215], v17 offset:33792
v_cndmask_b32 v231, v172, 0, vcc
v_mfma_f32_16x16x32_bf16 v[80:83], a[200:203], a[168:171], v[80:83]
v_mfma_f32_16x16x32_bf16 v[84:87], a[200:203], a[172:175], v[84:87]
s_add_u32 s3, s19, 8192
ds_read_b128 a[216:219], v17 offset:40960
v_mfma_f32_16x16x32_bf16 v[88:91], a[200:203], a[176:179], v[88:91]
buffer_load_dword v248, v244, s[20:23], s3 offen
v_mfma_f32_16x16x32_bf16 v[92:95], a[200:203], a[180:183], v[92:95]
v_cmp_gt_u32 vcc, 7, v175
s_nop 0
v_mfma_f32_16x16x32_bf16 v[96:99], a[200:203], a[184:187], v[96:99]
ds_read_b128 a[220:223], v17 offset:41984
v_mfma_f32_16x16x32_bf16 v[100:103], a[200:203], a[188:191], v[100:103]
ds_read_b128 a[224:227], v17 offset:49152
v_cmp_gt_u32 s[90:91], s87, v175
v_mfma_f32_16x16x32_bf16 v[104:107], a[200:203], a[192:195], v[104:107]
ds_read_b128 a[228:231], v17 offset:50176
v_mfma_f32_16x16x32_bf16 v[108:111], a[160:163], a[204:207], v[108:111]
v_cmp_gt_u32 s[92:93], s87, v174
v_mfma_f32_16x16x32_bf16 v[112:115], a[164:167], a[204:207], v[112:115]
ds_read_b128 a[232:235], v17 offset:57344
v_mfma_f32_16x16x32_bf16 v[116:119], a[168:171], a[204:207], v[116:119]
ds_read_b128 a[236:239], v17 offset:58368
v_mfma_f32_16x16x32_bf16 v[120:123], a[172:175], a[204:207], v[120:123]
v_cndmask_b32 v235, v172, 0, vcc
v_mfma_f32_16x16x32_bf16 v[124:127], a[176:179], a[204:207], v[124:127]
ds_read_b128 a[240:243], v27 offset:1024
v_mfma_f32_16x16x32_bf16 v[128:131], a[180:183], a[204:207], v[128:131]
v_cndmask_b32 v243, v172, 0, s[90:91]
v_mfma_f32_16x16x32_bf16 v[132:135], a[184:187], a[204:207], v[132:135]
s_and_b64 vcc, s[92:93], s[98:99]
v_mfma_f32_16x16x32_bf16 v[136:139], a[188:191], a[204:207], v[136:139]
v_mfma_f32_16x16x32_bf16 v[140:143], a[192:195], a[204:207], v[140:143]
v_cndmask_b32 v239, v172, 0, vcc
s_waitcnt lgkmcnt(0)
s_waitcnt vmcnt(8)
s_barrier
v_mfma_f32_16x16x32_bf16 v[40:43], a[244:247], a[208:211], v[40:43]
ds_read_b64_tr_b16 a[196:197], v18 offset:12288
v_mfma_f32_16x16x32_bf16 v[44:47], a[244:247], a[212:215], v[44:47]
buffer_load_dwordx4 v[180:183], v249, s[36:39], 0 offen sc1
v_mfma_f32_16x16x32_bf16 v[48:51], a[244:247], a[216:219], v[48:51]
ds_read_b64_tr_b16 a[198:199], v18 offset:12800
v_mfma_f32_16x16x32_bf16 v[52:55], a[244:247], a[220:223], v[52:55]
s_add_u32 m0, s84, 32768
ds_read_b64_tr_b16 a[200:201], v18 offset:13312
v_mfma_f32_16x16x32_bf16 v[56:59], a[244:247], a[224:227], v[56:59]
s_add_u32 s3, s77, 0
s_nop 0
v_mfma_f32_16x16x32_bf16 v[60:63], a[244:247], a[228:231], v[60:63]
buffer_load_dwordx4 v5, s[4:7], s3 offen lds
v_mfma_f32_16x16x32_bf16 v[64:67], a[244:247], a[232:235], v[64:67]
ds_read_b64_tr_b16 a[202:203], v18 offset:13824
v_mfma_f32_16x16x32_bf16 v[68:71], a[244:247], a[236:239], v[68:71]
ds_read_b64_tr_b16 a[204:205], v18 offset:14336
v_mfma_f32_16x16x32_bf16 v[144:147], a[244:247], v[32:35], v[144:147]
ds_read_b64_tr_b16 a[206:207], v18 offset:14848
v_mfma_f32_16x16x32_bf16 v[72:75], a[248:251], a[208:211], v[72:75]
buffer_load_dwordx4 v5, s[4:7], s3 offen offset:1024 lds
v_mfma_f32_16x16x32_bf16 v[76:79], a[248:251], a[212:215], v[76:79]
ds_read_b128 a[160:163], v14 offset:0
ds_read_b128 a[164:167], v14 offset:1024
v_mfma_f32_16x16x32_bf16 v[80:83], a[248:251], a[216:219], v[80:83]
s_add_u32 m0, s84, 40960
v_mfma_f32_16x16x32_bf16 v[84:87], a[248:251], a[220:223], v[84:87]
s_add_u32 s3, s77, 32768
ds_read_b128 a[168:171], v14 offset:8192
v_mfma_f32_16x16x32_bf16 v[88:91], a[248:251], a[224:227], v[88:91]
buffer_load_dwordx4 v5, s[4:7], s3 offen lds
v_mfma_f32_16x16x32_bf16 v[92:95], a[248:251], a[228:231], v[92:95]
ds_read_b128 a[172:175], v14 offset:9216
v_mfma_f32_16x16x32_bf16 v[96:99], a[248:251], a[232:235], v[96:99]
ds_read_b128 a[176:179], v14 offset:16384
v_mfma_f32_16x16x32_bf16 v[100:103], a[248:251], a[236:239], v[100:103]
ds_read_b128 a[180:183], v14 offset:17408
v_mfma_f32_16x16x32_bf16 v[104:107], a[248:251], a[240:243], v[104:107]
buffer_load_dwordx4 v5, s[4:7], s3 offen offset:1024 lds
v_mfma_f32_16x16x32_bf16 v[108:111], a[208:211], a[252:255], v[108:111]
ds_read_b128 a[184:187], v14 offset:24576
v_mfma_f32_16x16x32_bf16 v[112:115], a[212:215], a[252:255], v[112:115]
s_add_u32 m0, s84, 49152
v_mfma_f32_16x16x32_bf16 v[116:119], a[216:219], a[252:255], v[116:119]
s_add_u32 s3, s77, 65536
ds_read_b128 a[188:191], v14 offset:25600
v_mfma_f32_16x16x32_bf16 v[120:123], a[220:223], a[252:255], v[120:123]
buffer_load_dwordx4 v5, s[4:7], s3 offen lds
v_mfma_f32_16x16x32_bf16 v[124:127], a[224:227], a[252:255], v[124:127]
ds_read_b128 a[192:195], v24 offset:0
v_mfma_f32_16x16x32_bf16 v[128:131], a[228:231], a[252:255], v[128:131]
v_mfma_f32_16x16x32_bf16 v[132:135], a[232:235], a[252:255], v[132:135]
v_mfma_f32_16x16x32_bf16 v[136:139], a[236:239], a[252:255], v[136:139]
buffer_load_dwordx4 v5, s[4:7], s3 offen offset:1024 lds
v_mfma_f32_16x16x32_bf16 v[140:143], a[240:243], a[252:255], v[140:143]
s_nop 0
s_waitcnt lgkmcnt(0)
v_mfma_f32_16x16x32_bf16 v[40:43], a[196:199], a[160:163], v[40:43]
s_add_u32 m0, s84, 57344
ds_read_b64_tr_b16 a[244:245], v18 offset:24576
v_mfma_f32_16x16x32_bf16 v[44:47], a[196:199], a[164:167], v[44:47]
s_add_u32 s3, s77, 98304
v_mfma_f32_16x16x32_bf16 v[48:51], a[196:199], a[168:171], v[48:51]
buffer_load_dwordx4 v5, s[4:7], s3 offen lds
v_mfma_f32_16x16x32_bf16 v[52:55], a[196:199], a[172:175], v[52:55]
ds_read_b64_tr_b16 a[246:247], v18 offset:25088
v_mfma_f32_16x16x32_bf16 v[56:59], a[196:199], a[176:179], v[56:59]
ds_read_b64_tr_b16 a[248:249], v18 offset:25600
v_mfma_f32_16x16x32_bf16 v[60:63], a[196:199], a[180:183], v[60:63]
ds_read_b64_tr_b16 a[250:251], v18 offset:26112
v_mfma_f32_16x16x32_bf16 v[64:67], a[196:199], a[184:187], v[64:67]
buffer_load_dwordx4 v5, s[4:7], s3 offen offset:1024 lds
v_mfma_f32_16x16x32_bf16 v[68:71], a[196:199], a[188:191], v[68:71]
ds_read_b64_tr_b16 a[252:253], v18 offset:26624
v_mfma_f32_16x16x32_bf16 v[144:147], a[196:199], v[32:35], v[144:147]
s_add_u32 m0, s84, 66560
ds_read_b64_tr_b16 a[254:255], v18 offset:27136
v_mfma_f32_16x16x32_bf16 v[72:75], a[200:203], a[160:163], v[72:75]
s_sub_u32 s3, s77, 16384
v_mfma_f32_16x16x32_bf16 v[76:79], a[200:203], a[164:167], v[76:79]
s_max_i32 s3, s3, 0
ds_read_b128 a[208:211], v15 offset:0
v_mfma_f32_16x16x32_bf16 v[80:83], a[200:203], a[168:171], v[80:83]
s_mov_b32 exec_lo, s61
buffer_load_dwordx4 v6, s[4:7], s3 offen lds
s_mov_b32 exec_lo, -1
v_mfma_f32_16x16x32_bf16 v[84:87], a[200:203], a[172:175], v[84:87]
ds_read_b128 a[212:215], v15 offset:1024
v_mfma_f32_16x16x32_bf16 v[88:91], a[200:203], a[176:179], v[88:91]
s_add_u32 m0, s86, 61440
v_mfma_f32_16x16x32_bf16 v[92:95], a[200:203], a[180:183], v[92:95]
s_add_u32 s3, s81, 0
ds_read_b128 a[216:219], v15 offset:8192
v_mfma_f32_16x16x32_bf16 v[96:99], a[200:203], a[184:187], v[96:99]
buffer_load_dwordx4 v7, s[8:11], s3 offen offset:0 lds
v_mfma_f32_16x16x32_bf16 v[100:103], a[200:203], a[188:191], v[100:103]
ds_read_b128 a[220:223], v15 offset:9216
v_mfma_f32_16x16x32_bf16 v[104:107], a[200:203], a[192:195], v[104:107]
ds_read_b128 a[224:227], v15 offset:16384
v_mfma_f32_16x16x32_bf16 v[108:111], a[160:163], a[204:207], v[108:111]
ds_read_b128 a[228:231], v15 offset:17408
v_mfma_f32_16x16x32_bf16 v[112:115], a[164:167], a[204:207], v[112:115]
ds_read_b128 a[232:235], v15 offset:24576
v_mfma_f32_16x16x32_bf16 v[116:119], a[168:171], a[204:207], v[116:119]
buffer_load_dwordx4 v7, s[8:11], s3 offen offset:1024 lds
v_mfma_f32_16x16x32_bf16 v[120:123], a[172:175], a[204:207], v[120:123]
ds_read_b128 a[236:239], v15 offset:25600
v_mfma_f32_16x16x32_bf16 v[124:127], a[176:179], a[204:207], v[124:127]
ds_read_b128 a[240:243], v25 offset:0
v_mfma_f32_16x16x32_bf16 v[128:131], a[180:183], a[204:207], v[128:131]
v_mfma_f32_16x16x32_bf16 v[132:135], a[184:187], a[204:207], v[132:135]
buffer_load_dwordx4 v7, s[8:11], s3 offen offset:2048 lds
v_mfma_f32_16x16x32_bf16 v[136:139], a[188:191], a[204:207], v[136:139]
v_mfma_f32_16x16x32_bf16 v[140:143], a[192:195], a[204:207], v[140:143]
s_waitcnt lgkmcnt(0)
s_waitcnt vmcnt(14)
s_nop 0
s_barrier
v_mfma_f32_16x16x32_bf16 v[40:43], a[244:247], a[208:211], v[40:43]
s_add_u32 m0, s86, 73728
v_mfma_f32_16x16x32_bf16 v[44:47], a[244:247], a[212:215], v[44:47]
s_add_u32 s3, s81, 98304
ds_read_b64_tr_b16 a[196:197], v18 offset:36864
v_mfma_f32_16x16x32_bf16 v[48:51], a[244:247], a[216:219], v[48:51]
buffer_load_dwordx4 v7, s[8:11], s3 offen offset:0 lds
v_mfma_f32_16x16x32_bf16 v[52:55], a[244:247], a[220:223], v[52:55]
ds_read_b64_tr_b16 a[198:199], v18 offset:37376
v_mfma_f32_16x16x32_bf16 v[56:59], a[244:247], a[224:227], v[56:59]
ds_read_b64_tr_b16 a[200:201], v18 offset:37888
v_mfma_f32_16x16x32_bf16 v[60:63], a[244:247], a[228:231], v[60:63]
ds_read_b64_tr_b16 a[202:203], v18 offset:38400
v_mfma_f32_16x16x32_bf16 v[64:67], a[244:247], a[232:235], v[64:67]
buffer_load_dwordx4 v7, s[8:11], s3 offen offset:1024 lds
v_mfma_f32_16x16x32_bf16 v[68:71], a[244:247], a[236:239], v[68:71]
ds_read_b64_tr_b16 a[204:205], v18 offset:38912
v_mfma_f32_16x16x32_bf16 v[144:147], a[244:247], v[32:35], v[144:147]
ds_read_b64_tr_b16 a[206:207], v18 offset:39424
v_mfma_f32_16x16x32_bf16 v[72:75], a[248:251], a[208:211], v[72:75]
ds_read_b128 a[160:163], v16 offset:0
v_mfma_f32_16x16x32_bf16 v[76:79], a[248:251], a[212:215], v[76:79]
ds_read_b128 a[164:167], v16 offset:1024
v_mfma_f32_16x16x32_bf16 v[80:83], a[248:251], a[216:219], v[80:83]
buffer_load_dwordx4 v7, s[8:11], s3 offen offset:2048 lds
v_mfma_f32_16x16x32_bf16 v[84:87], a[248:251], a[220:223], v[84:87]
v_mfma_f32_16x16x32_bf16 v[88:91], a[248:251], a[224:227], v[88:91]
s_add_u32 m0, s86, 0
s_nop 0
ds_read_b128 a[168:171], v16 offset:8192
v_mfma_f32_16x16x32_bf16 v[92:95], a[248:251], a[228:231], v[92:95]
s_add_u32 s3, s81, 196608
v_mfma_f32_16x16x32_bf16 v[96:99], a[248:251], a[232:235], v[96:99]
buffer_load_dwordx4 v7, s[8:11], s3 offen offset:0 lds
v_mfma_f32_16x16x32_bf16 v[100:103], a[248:251], a[236:239], v[100:103]
ds_read_b128 a[172:175], v16 offset:9216
v_mfma_f32_16x16x32_bf16 v[104:107], a[248:251], a[240:243], v[104:107]
ds_read_b128 a[176:179], v16 offset:16384
v_mfma_f32_16x16x32_bf16 v[108:111], a[208:211], a[252:255], v[108:111]
ds_read_b128 a[180:183], v16 offset:17408
v_mfma_f32_16x16x32_bf16 v[112:115], a[212:215], a[252:255], v[112:115]
ds_read_b128 a[184:187], v16 offset:24576
v_mfma_f32_16x16x32_bf16 v[116:119], a[216:219], a[252:255], v[116:119]
buffer_load_dwordx4 v7, s[8:11], s3 offen offset:1024 lds
v_mfma_f32_16x16x32_bf16 v[120:123], a[220:223], a[252:255], v[120:123]
ds_read_b128 a[188:191], v16 offset:25600
v_mfma_f32_16x16x32_bf16 v[124:127], a[224:227], a[252:255], v[124:127]
ds_read_b128 a[192:195], v26 offset:0
v_mfma_f32_16x16x32_bf16 v[128:131], a[228:231], a[252:255], v[128:131]
v_mfma_f32_16x16x32_bf16 v[132:135], a[232:235], a[252:255], v[132:135]
buffer_load_dwordx4 v7, s[8:11], s3 offen offset:2048 lds
v_mfma_f32_16x16x32_bf16 v[136:139], a[236:239], a[252:255], v[136:139]
v_mfma_f32_16x16x32_bf16 v[140:143], a[240:243], a[252:255], v[140:143]
s_waitcnt lgkmcnt(0)
s_waitcnt vmcnt(18)
v_xor_b32 v184, s69, v181
v_bitop3_b32 v184, v184, v183, s69 bitop3:0xf6
v_cmp_ne_u32 vcc, 0, v184
s_nop 0
s_cbranch_vccnz L_lnA_slow
L_lnA_ok:
v_mfma_f32_16x16x32_bf16 v[40:43], a[196:199], a[160:163], v[40:43]
s_add_u32 m0, s86, 12288
v_mfma_f32_16x16x32_bf16 v[44:47], a[196:199], a[164:167], v[44:47]
s_add_u32 s3, s81, 294912
ds_read_b64_tr_b16 a[244:245], v21 offset:0
v_mfma_f32_16x16x32_bf16 v[48:51], a[196:199], a[168:171], v[48:51]
buffer_load_dwordx4 v7, s[8:11], s3 offen offset:0 lds
v_mfma_f32_16x16x32_bf16 v[52:55], a[196:199], a[172:175], v[52:55]
ds_read_b64_tr_b16 a[246:247], v21 offset:512
v_mfma_f32_16x16x32_bf16 v[56:59], a[196:199], a[176:179], v[56:59]
ds_read_b64_tr_b16 a[248:249], v21 offset:1024
v_mfma_f32_16x16x32_bf16 v[60:63], a[196:199], a[180:183], v[60:63]
ds_read_b64_tr_b16 a[250:251], v21 offset:1536
v_mfma_f32_16x16x32_bf16 v[64:67], a[196:199], a[184:187], v[64:67]
v_mfma_f32_16x16x32_bf16 v[68:71], a[196:199], a[188:191], v[68:71]
ds_read_b64_tr_b16 a[252:253], v21 offset:2048
v_mfma_f32_16x16x32_bf16 v[144:147], a[196:199], v[32:35], v[144:147]
buffer_load_dwordx4 v7, s[8:11], s3 offen offset:1024 lds
v_mfma_f32_16x16x32_bf16 v[72:75], a[200:203], a[160:163], v[72:75]
ds_read_b64_tr_b16 a[254:255], v21 offset:2560
v_mfma_f32_16x16x32_bf16 v[76:79], a[200:203], a[164:167], v[76:79]
ds_read_b128 a[208:211], v17 offset:0
v_mfma_f32_16x16x32_bf16 v[80:83], a[200:203], a[168:171], v[80:83]
ds_read_b128 a[212:215], v17 offset:1024
v_mfma_f32_16x16x32_bf16 v[84:87], a[200:203], a[172:175], v[84:87]
ds_read_b128 a[216:219], v17 offset:8192
v_mfma_f32_16x16x32_bf16 v[88:91], a[200:203], a[176:179], v[88:91]
buffer_load_dwordx4 v7, s[8:11], s3 offen offset:2048 lds
v_mfma_f32_16x16x32_bf16 v[92:95], a[200:203], a[180:183], v[92:95]
ds_read_b128 a[220:223], v17 offset:9216
v_mfma_f32_16x16x32_bf16 v[96:99], a[200:203], a[184:187], v[96:99]
ds_read_b128 a[224:227], v17 offset:16384
v_mfma_f32_16x16x32_bf16 v[100:103], a[200:203], a[188:191], v[100:103]
ds_read_b128 a[228:231], v17 offset:17408
v_mfma_f32_16x16x32_bf16 v[104:107], a[200:203], a[192:195], v[104:107]
v_mfma_f32_16x16x32_bf16 v[108:111], a[160:163], a[204:207], v[108:111]
buffer_load_dword v248, v245, s[12:15], 0 offen
v_mfma_f32_16x16x32_bf16 v[112:115], a[164:167], a[204:207], v[112:115]
ds_read_b128 a[232:235], v17 offset:24576
v_mfma_f32_16x16x32_bf16 v[116:119], a[168:171], a[204:207], v[116:119]
ds_read_b128 a[236:239], v17 offset:25600
v_mfma_f32_16x16x32_bf16 v[120:123], a[172:175], a[204:207], v[120:123]
ds_read_b128 a[240:243], v27 offset:0
v_mfma_f32_16x16x32_bf16 v[124:127], a[176:179], a[204:207], v[124:127]
ds_write2_b32 v250, v180, v182 offset0:0 offset1:16
v_mfma_f32_16x16x32_bf16 v[128:131], a[180:183], a[204:207], v[128:131]
v_mfma_f32_16x16x32_bf16 v[132:135], a[184:187], a[204:207], v[132:135]
buffer_load_dword v248, v245, s[28:31], 0 offen
v_mfma_f32_16x16x32_bf16 v[136:139], a[188:191], a[204:207], v[136:139]
v_mfma_f32_16x16x32_bf16 v[140:143], a[192:195], a[204:207], v[140:143]
s_waitcnt lgkmcnt(0)
s_waitcnt vmcnt(8)
s_barrier
v_mfma_f32_16x16x32_bf16 v[40:43], a[244:247], a[208:211], v[40:43]
ds_read_b64_tr_b16 a[196:197], v21 offset:12288
v_mfma_f32_16x16x32_bf16 v[44:47], a[244:247], a[212:215], v[44:47]
s_add_u32 m0, s65, 98304
v_mfma_f32_16x16x32_bf16 v[48:51], a[244:247], a[216:219], v[48:51]
s_xor_b32 s3, s24, 0
ds_read_b64_tr_b16 a[198:199], v21 offset:12800
v_mfma_f32_16x16x32_bf16 v[52:55], a[244:247], a[220:223], v[52:55]
buffer_load_dwordx4 v216, s[20:23], s3 offen offset:0 lds
v_mfma_f32_16x16x32_bf16 v[56:59], a[244:247], a[224:227], v[56:59]
v_mfma_f32_16x16x32_bf16 v[60:63], a[244:247], a[228:231], v[60:63]
ds_read_b64_tr_b16 a[200:201], v21 offset:13312
v_mfma_f32_16x16x32_bf16 v[64:67], a[244:247], a[232:235], v[64:67]
ds_read_b64_tr_b16 a[202:203], v21 offset:13824
v_mfma_f32_16x16x32_bf16 v[68:71], a[244:247], a[236:239], v[68:71]
ds_read_b64_tr_b16 a[204:205], v21 offset:14336
v_mfma_f32_16x16x32_bf16 v[144:147], a[244:247], v[32:35], v[144:147]
ds_read_b64_tr_b16 a[206:207], v21 offset:14848
v_mfma_f32_16x16x32_bf16 v[72:75], a[248:251], a[208:211], v[72:75]
v_mfma_f32_16x16x32_bf16 v[76:79], a[248:251], a[212:215], v[76:79]
buffer_load_dwordx4 v217, s[20:23], s3 offen offset:1024 lds
v_mfma_f32_16x16x32_bf16 v[80:83], a[248:251], a[216:219], v[80:83]
ds_read_b128 a[160:163], v14 offset:32768
v_mfma_f32_16x16x32_bf16 v[84:87], a[248:251], a[220:223], v[84:87]
ds_read_b128 a[164:167], v14 offset:33792
v_mfma_f32_16x16x32_bf16 v[88:91], a[248:251], a[224:227], v[88:91]
ds_read_b128 a[168:171], v14 offset:40960
v_mfma_f32_16x16x32_bf16 v[92:95], a[248:251], a[228:231], v[92:95]
v_mfma_f32_16x16x32_bf16 v[96:99], a[248:251], a[232:235], v[96:99]
ds_read_b128 a[172:175], v14 offset:41984
v_mfma_f32_16x16x32_bf16 v[100:103], a[248:251], a[236:239], v[100:103]
buffer_load_dwordx4 v218, s[20:23], s3 offen offset:2048 lds
v_mfma_f32_16x16x32_bf16 v[104:107], a[248:251], a[240:243], v[104:107]
ds_read_b128 a[176:179], v14 offset:49152
v_mfma_f32_16x16x32_bf16 v[108:111], a[208:211], a[252:255], v[108:111]
ds_read_b128 a[180:183], v14 offset:50176
v_mfma_f32_16x16x32_bf16 v[112:115], a[212:215], a[252:255], v[112:115]
ds_read_b128 a[184:187], v14 offset:57344
v_mfma_f32_16x16x32_bf16 v[116:119], a[216:219], a[252:255], v[116:119]
v_mfma_f32_16x16x32_bf16 v[120:123], a[220:223], a[252:255], v[120:123]
ds_read_b128 a[188:191], v14 offset:58368
v_mfma_f32_16x16x32_bf16 v[124:127], a[224:227], a[252:255], v[124:127]
ds_read_b128 a[192:195], v24 offset:1024
v_mfma_f32_16x16x32_bf16 v[128:131], a[228:231], a[252:255], v[128:131]
buffer_load_dwordx4 v219, s[20:23], s3 offen offset:3072 lds
v_mfma_f32_16x16x32_bf16 v[132:135], a[232:235], a[252:255], v[132:135]
v_mfma_f32_16x16x32_bf16 v[136:139], a[236:239], a[252:255], v[136:139]
v_mfma_f32_16x16x32_bf16 v[140:143], a[240:243], a[252:255], v[140:143]
s_nop 0
s_waitcnt lgkmcnt(0)
v_mfma_f32_16x16x32_bf16 v[40:43], a[196:199], a[160:163], v[40:43]
ds_read_b64_tr_b16 a[244:245], v21 offset:24576
v_mfma_f32_16x16x32_bf16 v[44:47], a[196:199], a[164:167], v[44:47]
ds_read_b64_tr_b16 a[246:247], v21 offset:25088
v_mfma_f32_16x16x32_bf16 v[48:51], a[196:199], a[168:171], v[48:51]
buffer_store_dwordx4 v[188:191], v4, s[36:39], s58 offen offset:1024 sc1
v_mfma_f32_16x16x32_bf16 v[52:55], a[196:199], a[172:175], v[52:55]
ds_read_b64_tr_b16 a[248:249], v21 offset:25600
v_mfma_f32_16x16x32_bf16 v[56:59], a[196:199], a[176:179], v[56:59]
ds_read_b64_tr_b16 a[250:251], v21 offset:26112
v_mfma_f32_16x16x32_bf16 v[60:63], a[196:199], a[180:183], v[60:63]
v_mfma_f32_16x16x32_bf16 v[64:67], a[196:199], a[184:187], v[64:67]
buffer_store_dwordx4 v[188:191], v4, s[36:39], s58 offen offset:2048 sc1
v_mfma_f32_16x16x32_bf16 v[68:71], a[196:199], a[188:191], v[68:71]
ds_read_b64_tr_b16 a[252:253], v21 offset:26624
v_mfma_f32_16x16x32_bf16 v[144:147], a[196:199], v[32:35], v[144:147]
ds_read_b64_tr_b16 a[254:255], v21 offset:27136
v_mfma_f32_16x16x32_bf16 v[72:75], a[200:203], a[160:163], v[72:75]
s_add_u32 m0, s65, 114688
ds_read_b128 a[208:211], v15 offset:32768
v_mfma_f32_16x16x32_bf16 v[76:79], a[200:203], a[164:167], v[76:79]
s_xor_b32 s3, s24, 4096
v_mfma_f32_16x16x32_bf16 v[80:83], a[200:203], a[168:171], v[80:83]
buffer_load_dwordx4 v216, s[20:23], s3 offen offset:0 lds
v_mfma_f32_16x16x32_bf16 v[84:87], a[200:203], a[172:175], v[84:87]
ds_read_b128 a[212:215], v15 offset:33792
v_mfma_f32_16x16x32_bf16 v[88:91], a[200:203], a[176:179], v[88:91]
ds_read_b128 a[216:219], v15 offset:40960
v_mfma_f32_16x16x32_bf16 v[92:95], a[200:203], a[180:183], v[92:95]
ds_read_b128 a[220:223], v15 offset:41984
v_mfma_f32_16x16x32_bf16 v[96:99], a[200:203], a[184:187], v[96:99]
buffer_load_dwordx4 v217, s[20:23], s3 offen offset:1024 lds
v_mfma_f32_16x16x32_bf16 v[100:103], a[200:203], a[188:191], v[100:103]
ds_read_b128 a[224:227], v15 offset:49152
v_mfma_f32_16x16x32_bf16 v[104:107], a[200:203], a[192:195], v[104:107]
v_mfma_f32_16x16x32_bf16 v[108:111], a[160:163], a[204:207], v[108:111]
ds_read_b128 a[228:231], v15 offset:50176
v_mfma_f32_16x16x32_bf16 v[112:115], a[164:167], a[204:207], v[112:115]
ds_read_b128 a[232:235], v15 offset:57344
v_mfma_f32_16x16x32_bf16 v[116:119], a[168:171], a[204:207], v[116:119]
buffer_load_dwordx4 v218, s[20:23], s3 offen offset:2048 lds
v_mfma_f32_16x16x32_bf16 v[120:123], a[172:175], a[204:207], v[120:123]
ds_read_b128 a[236:239], v15 offset:58368
v_mfma_f32_16x16x32_bf16 v[124:127], a[176:179], a[204:207], v[124:127]
ds_read_b128 a[240:243], v25 offset:1024
v_mfma_f32_16x16x32_bf16 v[128:131], a[180:183], a[204:207], v[128:131]
v_mfma_f32_16x16x32_bf16 v[132:135], a[184:187], a[204:207], v[132:135]
buffer_load_dwordx4 v219, s[20:23], s3 offen offset:3072 lds
v_mfma_f32_16x16x32_bf16 v[136:139], a[188:191], a[204:207], v[136:139]
v_mfma_f32_16x16x32_bf16 v[140:143], a[192:195], a[204:207], v[140:143]
s_waitcnt lgkmcnt(0)
s_waitcnt vmcnt(6)
s_nop 0
s_barrier
v_mfma_f32_16x16x32_bf16 v[40:43], a[244:247], a[208:211], v[40:43]
ds_read_b64_tr_b16 a[196:197], v18 offset:0
v_mfma_f32_16x16x32_bf16 v[44:47], a[244:247], a[212:215], v[44:47]
s_add_u32 m0, s65, 131072
ds_read_b64_tr_b16 a[198:199], v18 offset:512
v_mfma_f32_16x16x32_bf16 v[48:51], a[244:247], a[216:219], v[48:51]
s_xor_b32 s3, s24, 131072
v_mfma_f32_16x16x32_bf16 v[52:55], a[244:247], a[220:223], v[52:55]
buffer_load_dwordx4 v216, s[20:23], s3 offen offset:0 lds
v_mfma_f32_16x16x32_bf16 v[56:59], a[244:247], a[224:227], v[56:59]
ds_read_b64_tr_b16 a[200:201], v18 offset:1024
v_mfma_f32_16x16x32_bf16 v[60:63], a[244:247], a[228:231], v[60:63]
ds_read_b64_tr_b16 a[202:203], v18 offset:1536
v_mfma_f32_16x16x32_bf16 v[64:67], a[244:247], a[232:235], v[64:67]
ds_read_b64_tr_b16 a[204:205], v18 offset:2048
v_mfma_f32_16x16x32_bf16 v[68:71], a[244:247], a[236:239], v[68:71]
ds_read_b64_tr_b16 a[206:207], v18 offset:2560
v_mfma_f32_16x16x32_bf16 v[144:147], a[244:247], v[32:35], v[144:147]
ds_read_b128 a[160:163], v16 offset:32768
v_mfma_f32_16x16x32_bf16 v[72:75], a[248:251], a[208:211], v[72:75]
ds_read_b128 a[164:167], v16 offset:33792
v_mfma_f32_16x16x32_bf16 v[76:79], a[248:251], a[212:215], v[76:79]
buffer_load_dwordx4 v217, s[20:23], s3 offen offset:1024 lds
v_mfma_f32_16x16x32_bf16 v[80:83], a[248:251], a[216:219], v[80:83]
ds_read_b128 a[168:171], v16 offset:40960
v_mfma_f32_16x16x32_bf16 v[84:87], a[248:251], a[220:223], v[84:87]
ds_read_b128 a[172:175], v16 offset:41984
v_mfma_f32_16x16x32_bf16 v[88:91], a[248:251], a[224:227], v[88:91]
ds_read_b128 a[176:179], v16 offset:49152
v_mfma_f32_16x16x32_bf16 v[92:95], a[248:251], a[228:231], v[92:95]
ds_read_b128 a[180:183], v16 offset:50176
v_mfma_f32_16x16x32_bf16 v[96:99], a[248:251], a[232:235], v[96:99]
ds_read_b128 a[184:187], v16 offset:57344
v_mfma_f32_16x16x32_bf16 v[100:103], a[248:251], a[236:239], v[100:103]
buffer_load_dwordx4 v218, s[20:23], s3 offen offset:2048 lds
v_mfma_f32_16x16x32_bf16 v[104:107], a[248:251], a[240:243], v[104:107]
ds_read_b128 a[188:191], v16 offset:58368
v_mfma_f32_16x16x32_bf16 v[108:111], a[208:211], a[252:255], v[108:111]
ds_read_b128 a[192:195], v26 offset:1024
v_mfma_f32_16x16x32_bf16 v[112:115], a[212:215], a[252:255], v[112:115]
ds_read_b128 a[0:3], v224 offset:16384
v_mfma_f32_16x16x32_bf16 v[116:119], a[216:219], a[252:255], v[116:119]
ds_read_b128 a[4:7], v225 offset:16384
v_mfma_f32_16x16x32_bf16 v[120:123], a[220:223], a[252:255], v[120:123]
ds_read_b128 a[8:11], v226 offset:16384
v_mfma_f32_16x16x32_bf16 v[124:127], a[224:227], a[252:255], v[124:127]
ds_read_b128 a[12:15], v227 offset:16384
v_mfma_f32_16x16x32_bf16 v[128:131], a[228:231], a[252:255], v[128:131]
buffer_load_dwordx4 v219, s[20:23], s3 offen offset:3072 lds
v_mfma_f32_16x16x32_bf16 v[132:135], a[232:235], a[252:255], v[132:135]
v_mfma_f32_16x16x32_bf16 v[136:139], a[236:239], a[252:255], v[136:139]
v_mfma_f32_16x16x32_bf16 v[140:143], a[240:243], a[252:255], v[140:143]
s_waitcnt lgkmcnt(0)
s_waitcnt vmcnt(4)
v_mfma_f32_16x16x32_bf16 v[40:43], a[196:199], a[160:163], v[40:43]
ds_read_b64_tr_b16 a[244:245], v18 offset:12288
v_mfma_f32_16x16x32_bf16 v[44:47], a[196:199], a[164:167], v[44:47]
s_add_u32 m0, s65, 98304
ds_read_b64_tr_b16 a[246:247], v18 offset:12800
v_mfma_f32_16x16x32_bf16 v[48:51], a[196:199], a[168:171], v[48:51]
s_xor_b32 s3, s24, 135168
v_mfma_f32_16x16x32_bf16 v[52:55], a[196:199], a[172:175], v[52:55]
buffer_load_dwordx4 v216, s[20:23], s3 offen offset:0 lds
v_mfma_f32_16x16x32_bf16 v[56:59], a[196:199], a[176:179], v[56:59]
ds_read_b64_tr_b16 a[248:249], v18 offset:13312
v_mfma_f32_16x16x32_bf16 v[60:63], a[196:199], a[180:183], v[60:63]
ds_read_b64_tr_b16 a[250:251], v18 offset:13824
v_mfma_f32_16x16x32_bf16 v[64:67], a[196:199], a[184:187], v[64:67]
ds_read_b64_tr_b16 a[252:253], v18 offset:14336
v_mfma_f32_16x16x32_bf16 v[68:71], a[196:199], a[188:191], v[68:71]
ds_read_b64_tr_b16 a[254:255], v18 offset:14848
v_mfma_f32_16x16x32_bf16 v[144:147], a[196:199], v[32:35], v[144:147]
ds_read_b128 a[208:211], v17 offset:32768
v_mfma_f32_16x16x32_bf16 v[72:75], a[200:203], a[160:163], v[72:75]
ds_read_b128 a[212:215], v17 offset:33792
v_mfma_f32_16x16x32_bf16 v[76:79], a[200:203], a[164:167], v[76:79]
buffer_load_dwordx4 v217, s[20:23], s3 offen offset:1024 lds
v_mfma_f32_16x16x32_bf16 v[80:83], a[200:203], a[168:171], v[80:83]
ds_read_b128 a[216:219], v17 offset:40960
v_mfma_f32_16x16x32_bf16 v[84:87], a[200:203], a[172:175], v[84:87]
ds_read_b128 a[220:223], v17 offset:41984
v_mfma_f32_16x16x32_bf16 v[88:91], a[200:203], a[176:179], v[88:91]
ds_read_b128 a[224:227], v17 offset:49152
v_mfma_f32_16x16x32_bf16 v[92:95], a[200:203], a[180:183], v[92:95]
ds_read_b128 a[228:231], v17 offset:50176
v_mfma_f32_16x16x32_bf16 v[96:99], a[200:203], a[184:187], v[96:99]
ds_read_b128 a[232:235], v17 offset:57344
v_mfma_f32_16x16x32_bf16 v[100:103], a[200:203], a[188:191], v[100:103]
buffer_load_dwordx4 v218, s[20:23], s3 offen offset:2048 lds
v_mfma_f32_16x16x32_bf16 v[104:107], a[200:203], a[192:195], v[104:107]
ds_read_b128 a[236:239], v17 offset:58368
v_mfma_f32_16x16x32_bf16 v[108:111], a[160:163], a[204:207], v[108:111]
ds_read_b128 a[240:243], v27 offset:1024
v_mfma_f32_16x16x32_bf16 v[112:115], a[164:167], a[204:207], v[112:115]
ds_read_b128 a[16:19], v224 offset:32768
v_mfma_f32_16x16x32_bf16 v[116:119], a[168:171], a[204:207], v[116:119]
ds_read_b128 a[20:23], v225 offset:32768
v_mfma_f32_16x16x32_bf16 v[120:123], a[172:175], a[204:207], v[120:123]
ds_read_b128 a[24:27], v226 offset:32768
v_mfma_f32_16x16x32_bf16 v[124:127], a[176:179], a[204:207], v[124:127]
ds_read_b128 a[28:31], v227 offset:32768
v_mfma_f32_16x16x32_bf16 v[128:131], a[180:183], a[204:207], v[128:131]
buffer_load_dwordx4 v219, s[20:23], s3 offen offset:3072 lds
v_mfma_f32_16x16x32_bf16 v[132:135], a[184:187], a[204:207], v[132:135]
v_mfma_f32_16x16x32_bf16 v[136:139], a[188:191], a[204:207], v[136:139]
v_mfma_f32_16x16x32_bf16 v[140:143], a[192:195], a[204:207], v[140:143]
s_waitcnt lgkmcnt(0)
s_waitcnt vmcnt(4)
s_nop 0
s_barrier
v_mfma_f32_16x16x32_bf16 v[40:43], a[244:247], a[208:211], v[40:43]
s_add_u32 m0, s65, 81920
s_xor_b32 s3, s24, 256
v_mfma_f32_16x16x32_bf16 v[44:47], a[244:247], a[212:215], v[44:47]
buffer_load_dwordx4 v216, s[20:23], s3 offen offset:0 lds
v_mfma_f32_16x16x32_bf16 v[48:51], a[244:247], a[216:219], v[48:51]
ds_read2_b32 v[148:149], v251 offset0:0 offset1:16
ds_read2_b32 v[150:151], v251 offset0:32 offset1:48
v_mfma_f32_16x16x32_bf16 v[52:55], a[244:247], a[220:223], v[52:55]
ds_read2_b32 v[152:153], v251 offset0:64 offset1:80
v_mfma_f32_16x16x32_bf16 v[56:59], a[244:247], a[224:227], v[56:59]
ds_read2_b32 v[154:155], v251 offset0:96 offset1:112
ds_read2_b32 v[156:157], v251 offset0:128 offset1:144
v_mfma_f32_16x16x32_bf16 v[60:63], a[244:247], a[228:231], v[60:63]
buffer_load_dwordx4 v217, s[20:23], s3 offen offset:1024 lds
v_mfma_f32_16x16x32_bf16 v[64:67], a[244:247], a[232:235], v[64:67]
ds_read2_b32 v[158:159], v251 offset0:160 offset1:176
ds_read2_b32 v[160:161], v251 offset0:192 offset1:208
v_mfma_f32_16x16x32_bf16 v[68:71], a[244:247], a[236:239], v[68:71]
ds_read2_b32 v[162:163], v251 offset0:224 offset1:240
ds_read_b32 v164, v251 offset:1024
v_mfma_f32_16x16x32_bf16 v[144:147], a[244:247], v[32:35], v[144:147]
buffer_load_dwordx4 v218, s[20:23], s3 offen offset:2048 lds
v_mfma_f32_16x16x32_bf16 v[72:75], a[248:251], a[208:211], v[72:75]
ds_read_b32 v165, v251 offset:1088
v_mfma_f32_16x16x32_bf16 v[76:79], a[248:251], a[212:215], v[76:79]
ds_read_b128 v[172:175], v252 offset:0
ds_read_b128 v[176:179], v252 offset:64
v_mfma_f32_16x16x32_bf16 v[80:83], a[248:251], a[216:219], v[80:83]
buffer_load_dwordx4 v219, s[20:23], s3 offen offset:3072 lds
v_mfma_f32_16x16x32_bf16 v[84:87], a[248:251], a[220:223], v[84:87]
ds_read_b128 v[180:183], v252 offset:128
ds_read_b128 v[184:187], v252 offset:192
v_mfma_f32_16x16x32_bf16 v[88:91], a[248:251], a[224:227], v[88:91]
s_add_u32 m0, s65, 114688
ds_read_b128 v[188:191], v252 offset:256
v_mfma_f32_16x16x32_bf16 v[92:95], a[248:251], a[228:231], v[92:95]
s_xor_b32 s3, s24, 4352
v_mfma_f32_16x16x32_bf16 v[96:99], a[248:251], a[232:235], v[96:99]
buffer_load_dwordx4 v216, s[20:23], s3 offen offset:0 lds
v_mfma_f32_16x16x32_bf16 v[100:103], a[248:251], a[236:239], v[100:103]
ds_read_b128 v[192:195], v252 offset:320
ds_read_b128 v[196:199], v252 offset:384
v_mfma_f32_16x16x32_bf16 v[104:107], a[248:251], a[240:243], v[104:107]
ds_read_b128 v[200:203], v252 offset:448
ds_read_b128 v[204:207], v252 offset:512
v_mfma_f32_16x16x32_bf16 v[108:111], a[208:211], a[252:255], v[108:111]
buffer_load_dwordx4 v217, s[20:23], s3 offen offset:1024 lds
v_mfma_f32_16x16x32_bf16 v[112:115], a[212:215], a[252:255], v[112:115]
ds_read_b128 v[208:211], v252 offset:576
ds_read_b128 a[32:35], v224 offset:49152
v_mfma_f32_16x16x32_bf16 v[116:119], a[216:219], a[252:255], v[116:119]
ds_read_b128 a[36:39], v225 offset:49152
v_mfma_f32_16x16x32_bf16 v[120:123], a[220:223], a[252:255], v[120:123]
buffer_load_dwordx4 v218, s[20:23], s3 offen offset:2048 lds
v_mfma_f32_16x16x32_bf16 v[124:127], a[224:227], a[252:255], v[124:127]
ds_read_b128 a[40:43], v226 offset:49152
ds_read_b128 a[44:47], v227 offset:49152
v_mfma_f32_16x16x32_bf16 v[128:131], a[228:231], a[252:255], v[128:131]
v_mfma_f32_16x16x32_bf16 v[132:135], a[232:235], a[252:255], v[132:135]
v_mfma_f32_16x16x32_bf16 v[136:139], a[236:239], a[252:255], v[136:139]
buffer_load_dwordx4 v219, s[20:23], s3 offen offset:3072 lds
v_mfma_f32_16x16x32_bf16 v[140:143], a[240:243], a[252:255], v[140:143]
v_mov_b32_dpp v166, v104 row_newbcast:0 row_mask:0xf bank_mask:0xf
v_mov_b32_dpp v167, v105 row_newbcast:0 row_mask:0xf bank_mask:0xf
v_mov_b32_dpp v168, v106 row_newbcast:0 row_mask:0xf bank_mask:0xf
v_mov_b32_dpp v169, v107 row_newbcast:0 row_mask:0xf bank_mask:0xf
s_nop 3
v_mov_b32 v170, v140
v_mov_b32 v171, v140
s_nop 1
v_permlane16_swap_b32 v170, v171
v_mov_b32 v171, v170
s_nop 1
v_permlane32_swap_b32 v170, v171
s_waitcnt lgkmcnt(14)
v_pk_fma_f32 v[40:41], v[148:149], v[144:145], v[40:41] op_sel_hi:[0,1,1] neg_lo:[1,0,0] neg_hi:[1,0,0]
v_pk_fma_f32 v[42:43], v[148:149], v[146:147], v[42:43] op_sel_hi:[0,1,1] neg_lo:[1,0,0] neg_hi:[1,0,0]
v_pk_mul_f32 v[40:41], v[40:41], v[148:149] op_sel:[0,1] op_sel_hi:[1,1]
v_pk_mul_f32 v[42:43], v[42:43], v[148:149] op_sel:[0,1] op_sel_hi:[1,1]
v_pk_fma_f32 v[44:45], v[150:151], v[144:145], v[44:45] op_sel_hi:[0,1,1] neg_lo:[1,0,0] neg_hi:[1,0,0]
s_waitcnt vmcnt(8)
ds_read_b128 a[48:51], v224 offset:16384
v_pk_fma_f32 v[46:47], v[150:151], v[146:147], v[46:47] op_sel_hi:[0,1,1] neg_lo:[1,0,0] neg_hi:[1,0,0]
v_pk_mul_f32 v[44:45], v[44:45], v[150:151] op_sel:[0,1] op_sel_hi:[1,1]
v_pk_mul_f32 v[46:47], v[46:47], v[150:151] op_sel:[0,1] op_sel_hi:[1,1]
ds_read_b128 a[52:55], v225 offset:16384
v_pk_fma_f32 v[48:49], v[152:153], v[144:145], v[48:49] op_sel_hi:[0,1,1] neg_lo:[1,0,0] neg_hi:[1,0,0]
v_pk_fma_f32 v[50:51], v[152:153], v[146:147], v[50:51] op_sel_hi:[0,1,1] neg_lo:[1,0,0] neg_hi:[1,0,0]
v_pk_mul_f32 v[48:49], v[48:49], v[152:153] op_sel:[0,1] op_sel_hi:[1,1]
ds_read_b128 a[56:59], v226 offset:16384
v_pk_mul_f32 v[50:51], v[50:51], v[152:153] op_sel:[0,1] op_sel_hi:[1,1]
v_pk_fma_f32 v[52:53], v[154:155], v[144:145], v[52:53] op_sel_hi:[0,1,1] neg_lo:[1,0,0] neg_hi:[1,0,0]
ds_read_b128 a[60:63], v227 offset:16384
s_nop 0
s_waitcnt lgkmcnt(4)
s_add_u32 m0, s65, 131072
s_xor_b32 s3, s24, 131328
buffer_load_dwordx4 v216, s[20:23], s3 offen offset:0 lds
v_pk_fma_f32 v[54:55], v[154:155], v[146:147], v[54:55] op_sel_hi:[0,1,1] neg_lo:[1,0,0] neg_hi:[1,0,0]
v_pk_mul_f32 v[52:53], v[52:53], v[154:155] op_sel:[0,1] op_sel_hi:[1,1]
v_pk_mul_f32 v[54:55], v[54:55], v[154:155] op_sel:[0,1] op_sel_hi:[1,1]
v_pk_fma_f32 v[56:57], v[156:157], v[144:145], v[56:57] op_sel_hi:[0,1,1] neg_lo:[1,0,0] neg_hi:[1,0,0]
v_pk_fma_f32 v[58:59], v[156:157], v[146:147], v[58:59] op_sel_hi:[0,1,1] neg_lo:[1,0,0] neg_hi:[1,0,0]
v_pk_mul_f32 v[56:57], v[56:57], v[156:157] op_sel:[0,1] op_sel_hi:[1,1]
v_pk_mul_f32 v[58:59], v[58:59], v[156:157] op_sel:[0,1] op_sel_hi:[1,1]
buffer_load_dwordx4 v217, s[20:23], s3 offen offset:1024 lds
v_pk_fma_f32 v[60:61], v[158:159], v[144:145], v[60:61] op_sel_hi:[0,1,1] neg_lo:[1,0,0] neg_hi:[1,0,0]
v_pk_fma_f32 v[62:63], v[158:159], v[146:147], v[62:63] op_sel_hi:[0,1,1] neg_lo:[1,0,0] neg_hi:[1,0,0]
v_pk_mul_f32 v[60:61], v[60:61], v[158:159] op_sel:[0,1] op_sel_hi:[1,1]
v_pk_mul_f32 v[62:63], v[62:63], v[158:159] op_sel:[0,1] op_sel_hi:[1,1]
v_pk_fma_f32 v[64:65], v[160:161], v[144:145], v[64:65] op_sel_hi:[0,1,1] neg_lo:[1,0,0] neg_hi:[1,0,0]
v_pk_fma_f32 v[66:67], v[160:161], v[146:147], v[66:67] op_sel_hi:[0,1,1] neg_lo:[1,0,0] neg_hi:[1,0,0]
v_pk_mul_f32 v[64:65], v[64:65], v[160:161] op_sel:[0,1] op_sel_hi:[1,1]
v_pk_mul_f32 v[66:67], v[66:67], v[160:161] op_sel:[0,1] op_sel_hi:[1,1]
buffer_load_dwordx4 v218, s[20:23], s3 offen offset:2048 lds
v_pk_fma_f32 v[68:69], v[162:163], v[144:145], v[68:69] op_sel_hi:[0,1,1] neg_lo:[1,0,0] neg_hi:[1,0,0]
v_pk_fma_f32 v[70:71], v[162:163], v[146:147], v[70:71] op_sel_hi:[0,1,1] neg_lo:[1,0,0] neg_hi:[1,0,0]
v_pk_mul_f32 v[68:69], v[68:69], v[162:163] op_sel:[0,1] op_sel_hi:[1,1]
v_pk_mul_f32 v[70:71], v[70:71], v[162:163] op_sel:[0,1] op_sel_hi:[1,1]
v_pk_fma_f32 v[108:109], v[172:173], v[170:171], v[108:109] op_sel_hi:[1,0,1] neg_lo:[1,0,0] neg_hi:[1,0,0]
v_pk_fma_f32 v[110:111], v[174:175], v[170:171], v[110:111] op_sel_hi:[1,0,1] neg_lo:[1,0,0] neg_hi:[1,0,0]
v_pk_mul_f32 v[108:109], v[108:109], v[176:177]
buffer_load_dwordx4 v219, s[20:23], s3 offen offset:3072 lds
v_pk_mul_f32 v[110:111], v[110:111], v[178:179]
v_pk_fma_f32 v[112:113], v[180:181], v[170:171], v[112:113] op_sel_hi:[1,0,1] neg_lo:[1,0,0] neg_hi:[1,0,0]
v_pk_fma_f32 v[114:115], v[182:183], v[170:171], v[114:115] op_sel_hi:[1,0,1] neg_lo:[1,0,0] neg_hi:[1,0,0]
v_pk_mul_f32 v[112:113], v[112:113], v[184:185]
v_pk_mul_f32 v[114:115], v[114:115], v[186:187]
v_pk_fma_f32 v[116:117], v[188:189], v[170:171], v[116:117] op_sel_hi:[1,0,1] neg_lo:[1,0,0] neg_hi:[1,0,0]
v_pk_fma_f32 v[118:119], v[190:191], v[170:171], v[118:119] op_sel_hi:[1,0,1] neg_lo:[1,0,0] neg_hi:[1,0,0]
s_waitcnt vmcnt(8)
ds_read_b128 a[64:67], v224 offset:0
v_pk_mul_f32 v[116:117], v[116:117], v[192:193]
v_pk_mul_f32 v[118:119], v[118:119], v[194:195]
v_pk_fma_f32 v[120:121], v[196:197], v[170:171], v[120:121] op_sel_hi:[1,0,1] neg_lo:[1,0,0] neg_hi:[1,0,0]
ds_read_b128 a[68:71], v225 offset:0
v_pk_fma_f32 v[122:123], v[198:199], v[170:171], v[122:123] op_sel_hi:[1,0,1] neg_lo:[1,0,0] neg_hi:[1,0,0]
v_pk_mul_f32 v[120:121], v[120:121], v[200:201]
v_pk_mul_f32 v[122:123], v[122:123], v[202:203]
ds_read_b128 a[72:75], v226 offset:0
v_pk_fma_f32 v[124:125], v[204:205], v[170:171], v[124:125] op_sel_hi:[1,0,1] neg_lo:[1,0,0] neg_hi:[1,0,0]
v_pk_fma_f32 v[126:127], v[206:207], v[170:171], v[126:127] op_sel_hi:[1,0,1] neg_lo:[1,0,0] neg_hi:[1,0,0]
ds_read_b128 a[76:79], v227 offset:0
s_waitcnt lgkmcnt(4)
s_add_u32 m0, s65, 98304
s_xor_b32 s3, s24, 135424
buffer_load_dwordx4 v216, s[20:23], s3 offen offset:0 lds
v_pk_mul_f32 v[124:125], v[124:125], v[208:209]
v_pk_mul_f32 v[126:127], v[126:127], v[210:211]
ds_read_b128 v[172:175], v252 offset:640
ds_read_b128 v[176:179], v252 offset:704
ds_read_b128 v[180:183], v252 offset:768
ds_read_b128 v[184:187], v252 offset:832
ds_read_b128 v[188:191], v252 offset:896
buffer_load_dwordx4 v217, s[20:23], s3 offen offset:1024 lds
ds_read_b128 v[192:195], v252 offset:960
ds_read_b128 v[196:199], v252 offset:1024
ds_read_b128 v[200:203], v252 offset:1088
v_pk_fma_f32 v[72:73], v[148:149], v[166:167], v[72:73] op_sel_hi:[0,1,1] neg_lo:[1,0,0] neg_hi:[1,0,0]
v_pk_fma_f32 v[74:75], v[148:149], v[168:169], v[74:75] op_sel_hi:[0,1,1] neg_lo:[1,0,0] neg_hi:[1,0,0]
v_pk_mul_f32 v[72:73], v[72:73], v[148:149] op_sel:[0,1] op_sel_hi:[1,1]
v_pk_mul_f32 v[74:75], v[74:75], v[148:149] op_sel:[0,1] op_sel_hi:[1,1]
buffer_load_dwordx4 v218, s[20:23], s3 offen offset:2048 lds
v_pk_fma_f32 v[76:77], v[150:151], v[166:167], v[76:77] op_sel_hi:[0,1,1] neg_lo:[1,0,0] neg_hi:[1,0,0]
v_pk_fma_f32 v[78:79], v[150:151], v[168:169], v[78:79] op_sel_hi:[0,1,1] neg_lo:[1,0,0] neg_hi:[1,0,0]
v_pk_mul_f32 v[76:77], v[76:77], v[150:151] op_sel:[0,1] op_sel_hi:[1,1]
v_pk_mul_f32 v[78:79], v[78:79], v[150:151] op_sel:[0,1] op_sel_hi:[1,1]
v_pk_fma_f32 v[80:81], v[152:153], v[166:167], v[80:81] op_sel_hi:[0,1,1] neg_lo:[1,0,0] neg_hi:[1,0,0]
v_pk_fma_f32 v[82:83], v[152:153], v[168:169], v[82:83] op_sel_hi:[0,1,1] neg_lo:[1,0,0] neg_hi:[1,0,0]
v_pk_mul_f32 v[80:81], v[80:81], v[152:153] op_sel:[0,1] op_sel_hi:[1,1]
buffer_load_dwordx4 v219, s[20:23], s3 offen offset:3072 lds
v_pk_mul_f32 v[82:83], v[82:83], v[152:153] op_sel:[0,1] op_sel_hi:[1,1]
v_pk_fma_f32 v[84:85], v[154:155], v[166:167], v[84:85] op_sel_hi:[0,1,1] neg_lo:[1,0,0] neg_hi:[1,0,0]
v_pk_fma_f32 v[86:87], v[154:155], v[168:169], v[86:87] op_sel_hi:[0,1,1] neg_lo:[1,0,0] neg_hi:[1,0,0]
v_pk_mul_f32 v[84:85], v[84:85], v[154:155] op_sel:[0,1] op_sel_hi:[1,1]
v_pk_mul_f32 v[86:87], v[86:87], v[154:155] op_sel:[0,1] op_sel_hi:[1,1]
v_pk_fma_f32 v[88:89], v[156:157], v[166:167], v[88:89] op_sel_hi:[0,1,1] neg_lo:[1,0,0] neg_hi:[1,0,0]
v_pk_fma_f32 v[90:91], v[156:157], v[168:169], v[90:91] op_sel_hi:[0,1,1] neg_lo:[1,0,0] neg_hi:[1,0,0]
v_pk_mul_f32 v[88:89], v[88:89], v[156:157] op_sel:[0,1] op_sel_hi:[1,1]
s_waitcnt vmcnt(8)
ds_read_b128 a[80:83], v224 offset:32768
v_pk_mul_f32 v[90:91], v[90:91], v[156:157] op_sel:[0,1] op_sel_hi:[1,1]
v_pk_fma_f32 v[92:93], v[158:159], v[166:167], v[92:93] op_sel_hi:[0,1,1] neg_lo:[1,0,0] neg_hi:[1,0,0]
v_pk_fma_f32 v[94:95], v[158:159], v[168:169], v[94:95] op_sel_hi:[0,1,1] neg_lo:[1,0,0] neg_hi:[1,0,0]
ds_read_b128 a[84:87], v225 offset:32768
v_pk_mul_f32 v[92:93], v[92:93], v[158:159] op_sel:[0,1] op_sel_hi:[1,1]
v_pk_mul_f32 v[94:95], v[94:95], v[158:159] op_sel:[0,1] op_sel_hi:[1,1]
v_pk_fma_f32 v[96:97], v[160:161], v[166:167], v[96:97] op_sel_hi:[0,1,1] neg_lo:[1,0,0] neg_hi:[1,0,0]
ds_read_b128 a[88:91], v226 offset:32768
v_pk_fma_f32 v[98:99], v[160:161], v[168:169], v[98:99] op_sel_hi:[0,1,1] neg_lo:[1,0,0] neg_hi:[1,0,0]
v_pk_mul_f32 v[96:97], v[96:97], v[160:161] op_sel:[0,1] op_sel_hi:[1,1]
ds_read_b128 a[92:95], v227 offset:32768
s_waitcnt lgkmcnt(12)
s_add_u32 m0, s65, 81920
s_xor_b32 s3, s24, 512
buffer_load_dwordx4 v216, s[20:23], s3 offen offset:0 lds
v_pk_mul_f32 v[98:99], v[98:99], v[160:161] op_sel:[0,1] op_sel_hi:[1,1]
v_pk_fma_f32 v[100:101], v[162:163], v[166:167], v[100:101] op_sel_hi:[0,1,1] neg_lo:[1,0,0] neg_hi:[1,0,0]
v_pk_fma_f32 v[102:103], v[162:163], v[168:169], v[102:103] op_sel_hi:[0,1,1] neg_lo:[1,0,0] neg_hi:[1,0,0]
v_pk_mul_f32 v[100:101], v[100:101], v[162:163] op_sel:[0,1] op_sel_hi:[1,1]
v_pk_mul_f32 v[102:103], v[102:103], v[162:163] op_sel:[0,1] op_sel_hi:[1,1]
v_pk_fma_f32 v[104:105], v[164:165], v[166:167], v[104:105] op_sel_hi:[0,1,1] neg_lo:[1,0,0] neg_hi:[1,0,0]
v_pk_fma_f32 v[106:107], v[164:165], v[168:169], v[106:107] op_sel_hi:[0,1,1] neg_lo:[1,0,0] neg_hi:[1,0,0]
buffer_load_dwordx4 v217, s[20:23], s3 offen offset:1024 lds
v_pk_mul_f32 v[104:105], v[104:105], v[164:165] op_sel:[0,1] op_sel_hi:[1,1]
v_pk_mul_f32 v[106:107], v[106:107], v[164:165] op_sel:[0,1] op_sel_hi:[1,1]
s_nop 0
s_waitcnt lgkmcnt(4)
v_pk_fma_f32 v[128:129], v[172:173], v[170:171], v[128:129] op_sel_hi:[1,0,1] neg_lo:[1,0,0] neg_hi:[1,0,0]
v_pk_fma_f32 v[130:131], v[174:175], v[170:171], v[130:131] op_sel_hi:[1,0,1] neg_lo:[1,0,0] neg_hi:[1,0,0]
v_pk_mul_f32 v[128:129], v[128:129], v[176:177]
v_pk_mul_f32 v[130:131], v[130:131], v[178:179]
v_pk_fma_f32 v[132:133], v[180:181], v[170:171], v[132:133] op_sel_hi:[1,0,1] neg_lo:[1,0,0] neg_hi:[1,0,0]
buffer_load_dwordx4 v218, s[20:23], s3 offen offset:2048 lds
v_pk_fma_f32 v[134:135], v[182:183], v[170:171], v[134:135] op_sel_hi:[1,0,1] neg_lo:[1,0,0] neg_hi:[1,0,0]
v_pk_mul_f32 v[132:133], v[132:133], v[184:185]
v_pk_mul_f32 v[134:135], v[134:135], v[186:187]
v_pk_fma_f32 v[136:137], v[188:189], v[170:171], v[136:137] op_sel_hi:[1,0,1] neg_lo:[1,0,0] neg_hi:[1,0,0]
v_pk_fma_f32 v[138:139], v[190:191], v[170:171], v[138:139] op_sel_hi:[1,0,1] neg_lo:[1,0,0] neg_hi:[1,0,0]
v_pk_mul_f32 v[136:137], v[136:137], v[192:193]
v_pk_mul_f32 v[138:139], v[138:139], v[194:195]
buffer_load_dwordx4 v219, s[20:23], s3 offen offset:3072 lds
v_pk_fma_f32 v[140:141], v[196:197], v[170:171], v[140:141] op_sel_hi:[1,0,1] neg_lo:[1,0,0] neg_hi:[1,0,0]
v_pk_fma_f32 v[142:143], v[198:199], v[170:171], v[142:143] op_sel_hi:[1,0,1] neg_lo:[1,0,0] neg_hi:[1,0,0]
v_pk_mul_f32 v[140:141], v[140:141], v[200:201]
v_pk_mul_f32 v[142:143], v[142:143], v[202:203]
v_cvt_pk_bf16_f32 v148, v140, v141
v_cvt_pk_bf16_f32 v149, v142, v143
v_cvt_pk_bf16_f32 v150, v108, v109
v_cvt_pk_bf16_f32 v151, v110, v111
s_waitcnt vmcnt(8)
ds_read_b128 a[96:99], v224 offset:49152
v_cvt_pk_bf16_f32 v152, v116, v117
v_cvt_pk_bf16_f32 v153, v118, v119
v_cvt_pk_bf16_f32 v154, v124, v125
ds_read_b128 a[100:103], v225 offset:49152
v_cvt_pk_bf16_f32 v155, v126, v127
v_cvt_pk_bf16_f32 v156, v132, v133
v_cvt_pk_bf16_f32 v157, v134, v135
ds_read_b128 a[104:107], v226 offset:49152
v_cvt_pk_bf16_f32 v158, v140, v141
ds_read_b128 a[108:111], v227 offset:49152
s_waitcnt lgkmcnt(4)
s_add_u32 m0, s65, 114688
s_xor_b32 s3, s24, 4608
buffer_load_dwordx4 v216, s[20:23], s3 offen offset:0 lds
v_cvt_pk_bf16_f32 v159, v142, v143
v_cvt_pk_bf16_f32 v160, v112, v113
v_cvt_pk_bf16_f32 v161, v114, v115
v_cvt_pk_bf16_f32 v162, v120, v121
v_cvt_pk_bf16_f32 v163, v122, v123
v_cvt_pk_bf16_f32 v164, v128, v129
v_cvt_pk_bf16_f32 v165, v130, v131
v_cvt_pk_bf16_f32 v166, v136, v137
buffer_load_dwordx4 v217, s[20:23], s3 offen offset:1024 lds
v_cvt_pk_bf16_f32 v167, v138, v139
v_cvt_pk_bf16_f32 v104, v104, v105
v_cvt_pk_bf16_f32 v105, v106, v107
v_cvt_pk_bf16_f32 v72, v72, v73
v_cvt_pk_bf16_f32 v73, v74, v75
v_cvt_pk_bf16_f32 v40, v40, v41
v_cvt_pk_bf16_f32 v41, v42, v43
v_cvt_pk_bf16_f32 v76, v76, v77
buffer_load_dwordx4 v218, s[20:23], s3 offen offset:2048 lds
v_cvt_pk_bf16_f32 v77, v78, v79
v_cvt_pk_bf16_f32 v44, v44, v45
v_cvt_pk_bf16_f32 v45, v46, v47
v_mfma_f32_16x16x16_bf16 v[108:111], v[104:105], v[40:41], v[236:239]
v_cvt_pk_bf16_f32 v48, v48, v49
v_cvt_pk_bf16_f32 v49, v50, v51
v_mfma_f32_16x16x16_bf16 v[112:115], v[72:73], v[40:41], v[228:231]
buffer_load_dwordx4 v219, s[20:23], s3 offen offset:3072 lds
v_cvt_pk_bf16_f32 v80, v80, v81
v_cvt_pk_bf16_f32 v81, v82, v83
v_mfma_f32_16x16x16_bf16 v[116:119], v[104:105], v[44:45], v[240:243]
v_cvt_pk_bf16_f32 v52, v52, v53
v_cvt_pk_bf16_f32 v53, v54, v55
v_mfma_f32_16x16x16_bf16 v[120:123], v[76:77], v[44:45], v[228:231]
v_cvt_pk_bf16_f32 v84, v84, v85
v_cvt_pk_bf16_f32 v85, v86, v87
s_waitcnt vmcnt(8)
ds_read_b128 a[112:115], v224 offset:16384
v_mfma_f32_16x16x16_bf16 v[124:127], v[72:73], v[48:49], v[232:235]
v_cvt_pk_bf16_f32 v56, v56, v57
v_cvt_pk_bf16_f32 v57, v58, v59
ds_read_b128 a[116:119], v225 offset:16384
v_mfma_f32_16x16x16_bf16 v[128:131], v[80:81], v[48:49], v[228:231]
v_cvt_pk_bf16_f32 v88, v88, v89
v_cvt_pk_bf16_f32 v89, v90, v91
ds_read_b128 a[120:123], v226 offset:16384
v_mfma_f32_16x16x16_bf16 v[132:135], v[76:77], v[52:53], v[232:235]
ds_read_b128 a[124:127], v227 offset:16384
s_waitcnt lgkmcnt(4)
s_add_u32 m0, s65, 131072
s_xor_b32 s3, s24, 131584
buffer_load_dwordx4 v216, s[20:23], s3 offen offset:0 lds
v_cvt_pk_bf16_f32 v60, v60, v61
v_cvt_pk_bf16_f32 v61, v62, v63
v_mfma_f32_16x16x16_bf16 v[136:139], v[84:85], v[52:53], v[228:231]
v_cvt_pk_bf16_f32 v92, v92, v93
v_cvt_pk_bf16_f32 v93, v94, v95
v_mfma_f32_16x16x16_bf16 v[172:175], v[80:81], v[56:57], v[232:235]
v_cvt_pk_bf16_f32 v64, v64, v65
v_cvt_pk_bf16_f32 v65, v66, v67
buffer_load_dwordx4 v217, s[20:23], s3 offen offset:1024 lds
v_mfma_f32_16x16x16_bf16 v[176:179], v[88:89], v[56:57], v[228:231]
v_cvt_pk_bf16_f32 v96, v96, v97
v_cvt_pk_bf16_f32 v97, v98, v99
v_mfma_f32_16x16x16_bf16 v[180:183], v[84:85], v[60:61], v[232:235]
v_cvt_pk_bf16_f32 v68, v68, v69
v_cvt_pk_bf16_f32 v69, v70, v71
v_mfma_f32_16x16x16_bf16 v[184:187], v[92:93], v[60:61], v[228:231]
buffer_load_dwordx4 v218, s[20:23], s3 offen offset:2048 lds
v_cvt_pk_bf16_f32 v100, v100, v101
v_cvt_pk_bf16_f32 v101, v102, v103
v_mfma_f32_16x16x16_bf16 v[188:191], v[88:89], v[64:65], v[232:235]
v_mfma_f32_16x16x16_bf16 v[192:195], v[96:97], v[64:65], v[228:231]
v_mfma_f32_16x16x16_bf16 v[196:199], v[92:93], v[68:69], v[232:235]
v_mfma_f32_16x16x16_bf16 v[200:203], v[100:101], v[68:69], v[228:231]
s_mov_b32 s98, 0x3eb8aa3b
v_max3_f32 v204, v108, v109, v110
buffer_load_dwordx4 v219, s[20:23], s3 offen offset:3072 lds
v_max3_f32 v205, v116, v117, v118
v_max3_f32 v206, v124, v125, v126
v_max3_f32 v207, v132, v133, v134
v_max3_f32 v204, v204, v111, v112
v_max3_f32 v205, v205, v119, v120
v_max3_f32 v206, v206, v127, v128
v_max3_f32 v207, v207, v135, v136
v_max3_f32 v204, v204, v113, v114
s_waitcnt vmcnt(8)
ds_read_b128 a[128:131], v224 offset:0
v_max3_f32 v205, v205, v121, v122
v_max3_f32 v206, v206, v129, v130
v_max3_f32 v207, v207, v137, v138
ds_read_b128 a[132:135], v225 offset:0
v_max_f32 v204, v204, v115
v_max_f32 v205, v205, v123
v_max_f32 v206, v206, v131
ds_read_b128 a[136:139], v226 offset:0
v_max_f32_e64 v207, v207, v139
ds_read_b128 a[140:143], v227 offset:0
s_waitcnt lgkmcnt(4)
s_add_u32 m0, s65, 98304
s_xor_b32 s3, s24, 135680
buffer_load_dwordx4 v216, s[20:23], s3 offen offset:0 lds
v_mov_b32 v208, v204
v_mov_b32 v209, v205
v_mov_b32 v210, v206
v_mov_b32 v211, v207
v_permlane32_swap_b32 v204, v208
v_permlane32_swap_b32 v205, v209
v_permlane32_swap_b32 v206, v210
v_permlane32_swap_b32 v207, v211
buffer_load_dwordx4 v217, s[20:23], s3 offen offset:1024 lds
v_max_f32 v204, v204, v208
v_max_f32 v205, v205, v209
v_max_f32 v206, v206, v210
v_max_f32 v207, v207, v211
v_mov_b32 v208, v204
v_mov_b32 v209, v205
v_mov_b32 v210, v206
buffer_load_dwordx4 v218, s[20:23], s3 offen offset:2048 lds
v_mov_b32 v211, v207
v_permlane16_swap_b32 v204, v208
v_permlane16_swap_b32 v205, v209
v_permlane16_swap_b32 v206, v210
v_permlane16_swap_b32 v207, v211
v_max_f32 v204, v204, v208
v_max_f32 v205, v205, v209
v_max_f32 v206, v206, v210
buffer_load_dwordx4 v219, s[20:23], s3 offen offset:3072 lds
v_max_f32_e64 v207, v207, v211
v_mul_f32 v212, 0xbeb8aa3b, v204
v_mul_f32 v213, 0xbeb8aa3b, v205
v_mul_f32 v214, 0xbeb8aa3b, v206
v_mul_f32 v215, 0xbeb8aa3b, v207
v_pk_fma_f32 v[108:109], v[108:109], s[98:99], v[212:213] op_sel:[0,0,0] op_sel_hi:[1,0,0]
v_pk_fma_f32 v[110:111], v[110:111], s[98:99], v[212:213] op_sel:[0,0,0] op_sel_hi:[1,0,0]
s_waitcnt vmcnt(8)
ds_read_b128 a[144:147], v224 offset:32768
v_pk_fma_f32 v[112:113], v[112:113], s[98:99], v[212:213] op_sel:[0,0,0] op_sel_hi:[1,0,0]
v_pk_fma_f32 v[114:115], v[114:115], s[98:99], v[212:213] op_sel:[0,0,0] op_sel_hi:[1,0,0]
v_pk_fma_f32 v[116:117], v[116:117], s[98:99], v[212:213] op_sel:[0,0,1] op_sel_hi:[1,0,1]
ds_read_b128 a[148:151], v225 offset:32768
v_pk_fma_f32 v[118:119], v[118:119], s[98:99], v[212:213] op_sel:[0,0,1] op_sel_hi:[1,0,1]
v_pk_fma_f32 v[120:121], v[120:121], s[98:99], v[212:213] op_sel:[0,0,1] op_sel_hi:[1,0,1]
v_pk_fma_f32 v[122:123], v[122:123], s[98:99], v[212:213] op_sel:[0,0,1] op_sel_hi:[1,0,1]
ds_read_b128 a[152:155], v226 offset:32768
v_pk_fma_f32 v[124:125], v[124:125], s[98:99], v[214:215] op_sel:[0,0,0] op_sel_hi:[1,0,0]
v_pk_fma_f32 v[126:127], v[126:127], s[98:99], v[214:215] op_sel:[0,0,0] op_sel_hi:[1,0,0]
ds_read_b128 a[156:159], v227 offset:32768
s_waitcnt lgkmcnt(4)
s_add_u32 m0, s65, 81920
s_xor_b32 s3, s24, 768
buffer_load_dwordx4 v216, s[20:23], s3 offen offset:0 lds
v_pk_fma_f32 v[128:129], v[128:129], s[98:99], v[214:215] op_sel:[0,0,0] op_sel_hi:[1,0,0]
v_pk_fma_f32 v[130:131], v[130:131], s[98:99], v[214:215] op_sel:[0,0,0] op_sel_hi:[1,0,0]
v_pk_fma_f32 v[132:133], v[132:133], s[98:99], v[214:215] op_sel:[0,0,1] op_sel_hi:[1,0,1]
v_pk_fma_f32 v[134:135], v[134:135], s[98:99], v[214:215] op_sel:[0,0,1] op_sel_hi:[1,0,1]
v_pk_fma_f32 v[136:137], v[136:137], s[98:99], v[214:215] op_sel:[0,0,1] op_sel_hi:[1,0,1]
v_pk_fma_f32 v[138:139], v[138:139], s[98:99], v[214:215] op_sel:[0,0,1] op_sel_hi:[1,0,1]
v_exp_f32 v108, v108
v_exp_f32 v109, v109
buffer_load_dwordx4 v217, s[20:23], s3 offen offset:1024 lds
v_exp_f32 v110, v110
v_exp_f32 v111, v111
v_exp_f32 v112, v112
v_exp_f32 v113, v113
v_exp_f32 v114, v114
v_exp_f32 v115, v115
v_cvt_pk_bf16_f32 v108, v108, v109
buffer_load_dwordx4 v218, s[20:23], s3 offen offset:2048 lds
v_cvt_pk_bf16_f32 v109, v110, v111
v_cvt_pk_bf16_f32 v110, v112, v113
v_cvt_pk_bf16_f32 v111, v114, v115
v_exp_f32 v116, v116
v_exp_f32 v117, v117
v_mfma_f32_16x16x32_bf16 v[40:43], v[148:151], v[108:111], 0
v_exp_f32 v118, v118
v_exp_f32 v119, v119
buffer_load_dwordx4 v219, s[20:23], s3 offen offset:3072 lds
v_mfma_f32_16x16x32_bf16 v[72:75], v[32:35], v[108:111], 0
v_exp_f32 v120, v120
v_exp_f32 v121, v121
v_exp_f32 v122, v122
v_exp_f32 v123, v123
v_cvt_pk_bf16_f32 v116, v116, v117
v_cvt_pk_bf16_f32 v117, v118, v119
s_waitcnt vmcnt(8)
ds_read_b128 a[160:163], v224 offset:49152
v_cvt_pk_bf16_f32 v118, v120, v121
v_cvt_pk_bf16_f32 v119, v122, v123
v_exp_f32 v124, v124
ds_read_b128 a[164:167], v225 offset:49152
v_exp_f32 v125, v125
v_mfma_f32_16x16x32_bf16 v[44:47], v[158:161], v[116:119], 0
v_exp_f32 v126, v126
ds_read_b128 a[168:171], v226 offset:49152
v_exp_f32_e64 v127, v127
v_mfma_f32_16x16x32_bf16 v[76:79], v[32:35], v[116:119], 0
ds_read_b128 a[172:175], v227 offset:49152
s_waitcnt lgkmcnt(4)
s_add_u32 m0, s65, 114688
s_xor_b32 s3, s24, 4864
buffer_load_dwordx4 v216, s[20:23], s3 offen offset:0 lds
v_exp_f32 v128, v128
v_exp_f32 v129, v129
v_exp_f32 v130, v130
v_exp_f32_e64 v131, v131
v_cvt_pk_bf16_f32 v124, v124, v125
v_cvt_pk_bf16_f32 v125, v126, v127
v_cvt_pk_bf16_f32 v126, v128, v129
v_cvt_pk_bf16_f32 v127, v130, v131
buffer_load_dwordx4 v217, s[20:23], s3 offen offset:1024 lds
v_exp_f32 v132, v132
v_exp_f32 v133, v133
v_mfma_f32_16x16x32_bf16 v[48:51], v[150:153], v[124:127], 0
v_exp_f32 v134, v134
v_exp_f32 v135, v135
v_mfma_f32_16x16x32_bf16 v[80:83], v[32:35], v[124:127], 0
v_exp_f32 v136, v136
buffer_load_dwordx4 v218, s[20:23], s3 offen offset:2048 lds
v_exp_f32 v137, v137
v_exp_f32 v138, v138
v_exp_f32 v139, v139
v_cvt_pk_bf16_f32 v132, v132, v133
v_cvt_pk_bf16_f32 v133, v134, v135
v_cvt_pk_bf16_f32 v134, v136, v137
v_cvt_pk_bf16_f32 v135, v138, v139
v_rcp_f32 v72, v72
buffer_load_dwordx4 v219, s[20:23], s3 offen offset:3072 lds
v_mfma_f32_16x16x32_bf16 v[52:55], v[160:163], v[132:135], 0
v_rcp_f32 v76, v76
v_mfma_f32_16x16x32_bf16 v[84:87], v[32:35], v[132:135], 0
v_rcp_f32 v80, v80
v_mul_f32 v40, v40, v72
v_mul_f32 v41, v41, v72
v_mul_f32 v42, v42, v72
s_waitcnt vmcnt(8)
ds_read_b128 a[176:179], v224 offset:16384
v_mul_f32 v43, v43, v72
v_cvt_pk_bf16_f32 v40, v40, v41
v_cvt_pk_bf16_f32 v41, v42, v43
ds_read_b128 a[180:183], v225 offset:16384
ds_read_b128 a[184:187], v226 offset:16384
ds_read_b128 a[188:191], v227 offset:16384
ds_write_b64 v253, v[40:41] offset:0
v_mul_f32 v44, v44, v76
v_mul_f32 v45, v45, v76
v_mul_f32 v46, v46, v76
v_mul_f32 v47, v47, v76
s_waitcnt lgkmcnt(5)
s_add_u32 m0, s65, 131072
s_xor_b32 s3, s24, 131840
buffer_load_dwordx4 v216, s[20:23], s3 offen offset:0 lds
v_cvt_pk_bf16_f32 v44, v44, v45
v_cvt_pk_bf16_f32 v45, v46, v47
ds_write_b64 v253, v[44:45] offset:2048
v_mul_f32 v48, v48, v80
v_mul_f32 v49, v49, v80
v_mul_f32 v50, v50, v80
v_mul_f32_e64 v51, v51, v80
buffer_load_dwordx4 v217, s[20:23], s3 offen offset:1024 lds
v_cvt_pk_bf16_f32 v48, v48, v49
v_cvt_pk_bf16_f32 v49, v50, v51
ds_write_b64 v253, v[48:49] offset:4096
v_rcp_f32 v84, v84
s_nop 0
v_mul_f32 v52, v52, v84
v_mul_f32 v53, v53, v84
v_mul_f32 v54, v54, v84
v_mul_f32 v55, v55, v84
buffer_load_dwordx4 v218, s[20:23], s3 offen offset:2048 lds
v_cvt_pk_bf16_f32 v52, v52, v53
v_cvt_pk_bf16_f32 v53, v54, v55
ds_write_b64 v253, v[52:53] offset:6144
v_max3_f32 v204, v172, v173, v174
v_max3_f32 v205, v180, v181, v182
v_max3_f32 v206, v188, v189, v190
v_max3_f32 v207, v196, v197, v198
v_max3_f32 v204, v204, v175, v176
buffer_load_dwordx4 v219, s[20:23], s3 offen offset:3072 lds
v_max3_f32 v205, v205, v183, v184
v_max3_f32 v206, v206, v191, v192
v_max3_f32 v207, v207, v199, v200
v_max3_f32 v204, v204, v177, v178
v_max3_f32 v205, v205, v185, v186
v_max3_f32 v206, v206, v193, v194
v_max3_f32 v207, v207, v201, v202
s_waitcnt vmcnt(8)
ds_read_b128 a[192:195], v224 offset:0
v_max_f32 v204, v204, v179
v_max_f32 v205, v205, v187
v_max_f32 v206, v206, v195
ds_read_b128 a[196:199], v225 offset:0
v_max_f32 v207, v207, v203
v_mov_b32 v208, v204
v_mov_b32 v209, v205
ds_read_b128 a[200:203], v226 offset:0
v_mov_b32 v210, v206
v_mov_b32 v211, v207
ds_read_b128 a[204:207], v227 offset:0
s_waitcnt lgkmcnt(8)
s_add_u32 m0, s65, 98304
s_xor_b32 s3, s24, 135936
buffer_load_dwordx4 v216, s[20:23], s3 offen offset:0 lds
v_permlane32_swap_b32 v204, v208
v_permlane32_swap_b32 v205, v209
v_permlane32_swap_b32 v206, v210
v_permlane32_swap_b32 v207, v211
v_max_f32 v204, v204, v208
v_max_f32 v205, v205, v209
v_max_f32 v206, v206, v210
buffer_load_dwordx4 v217, s[20:23], s3 offen offset:1024 lds
v_max_f32 v207, v207, v211
v_mov_b32 v208, v204
v_mov_b32 v209, v205
v_mov_b32 v210, v206
v_mov_b32 v211, v207
v_permlane16_swap_b32 v204, v208
v_permlane16_swap_b32 v205, v209
v_permlane16_swap_b32 v206, v210
buffer_load_dwordx4 v218, s[20:23], s3 offen offset:2048 lds
v_permlane16_swap_b32 v207, v211
v_max_f32 v204, v204, v208
v_max_f32 v205, v205, v209
v_max_f32 v206, v206, v210
v_max_f32 v207, v207, v211
v_mul_f32 v212, 0xbeb8aa3b, v204
v_mul_f32 v213, 0xbeb8aa3b, v205
buffer_load_dwordx4 v219, s[20:23], s3 offen offset:3072 lds
v_mul_f32 v214, 0xbeb8aa3b, v206
v_mul_f32 v215, 0xbeb8aa3b, v207
v_pk_fma_f32 v[172:173], v[172:173], s[98:99], v[212:213] op_sel:[0,0,0] op_sel_hi:[1,0,0]
v_pk_fma_f32 v[174:175], v[174:175], s[98:99], v[212:213] op_sel:[0,0,0] op_sel_hi:[1,0,0]
v_pk_fma_f32 v[176:177], v[176:177], s[98:99], v[212:213] op_sel:[0,0,0] op_sel_hi:[1,0,0]
v_pk_fma_f32 v[178:179], v[178:179], s[98:99], v[212:213] op_sel:[0,0,0] op_sel_hi:[1,0,0]
v_pk_fma_f32 v[180:181], v[180:181], s[98:99], v[212:213] op_sel:[0,0,1] op_sel_hi:[1,0,1]
v_pk_fma_f32 v[182:183], v[182:183], s[98:99], v[212:213] op_sel:[0,0,1] op_sel_hi:[1,0,1]
s_add_u32 m0, s60, 0
s_add_u32 s3, s64, 0
buffer_load_dwordx4 v39, s[12:15], s3 offen lds
v_pk_fma_f32 v[184:185], v[184:185], s[98:99], v[212:213] op_sel:[0,0,1] op_sel_hi:[1,0,1]
v_pk_fma_f32 v[186:187], v[186:187], s[98:99], v[212:213] op_sel:[0,0,1] op_sel_hi:[1,0,1]
v_pk_fma_f32 v[188:189], v[188:189], s[98:99], v[214:215] op_sel:[0,0,0] op_sel_hi:[1,0,0]
v_pk_fma_f32 v[190:191], v[190:191], s[98:99], v[214:215] op_sel:[0,0,0] op_sel_hi:[1,0,0]
v_pk_fma_f32 v[192:193], v[192:193], s[98:99], v[214:215] op_sel:[0,0,0] op_sel_hi:[1,0,0]
v_pk_fma_f32 v[194:195], v[194:195], s[98:99], v[214:215] op_sel:[0,0,0] op_sel_hi:[1,0,0]
v_pk_fma_f32 v[196:197], v[196:197], s[98:99], v[214:215] op_sel:[0,0,1] op_sel_hi:[1,0,1]
v_pk_fma_f32 v[198:199], v[198:199], s[98:99], v[214:215] op_sel:[0,0,1] op_sel_hi:[1,0,1]
s_add_u32 m0, s60, 4096
s_add_u32 s3, s64, 32768
buffer_load_dwordx4 v39, s[12:15], s3 offen lds
v_pk_fma_f32 v[200:201], v[200:201], s[98:99], v[214:215] op_sel:[0,0,1] op_sel_hi:[1,0,1]
v_pk_fma_f32 v[202:203], v[202:203], s[98:99], v[214:215] op_sel:[0,0,1] op_sel_hi:[1,0,1]
v_exp_f32 v172, v172
v_exp_f32 v173, v173
v_exp_f32 v174, v174
v_exp_f32 v175, v175
v_exp_f32_e64 v176, v176
s_add_u32 m0, s60, 8192
s_add_u32 s3, s64, 65536
buffer_load_dwordx4 v39, s[12:15], s3 offen lds
v_exp_f32 v177, v177
v_exp_f32 v178, v178
v_exp_f32_e64 v179, v179
v_cvt_pk_bf16_f32 v172, v172, v173
v_cvt_pk_bf16_f32 v173, v174, v175
v_cvt_pk_bf16_f32 v174, v176, v177
v_cvt_pk_bf16_f32 v175, v178, v179
v_exp_f32 v180, v180
s_waitcnt vmcnt(11)
ds_read_b128 a[208:211], v224 offset:32768
v_exp_f32 v181, v181
v_mfma_f32_16x16x32_bf16 v[56:59], v[152:155], v[172:175], 0
v_exp_f32 v182, v182
ds_read_b128 a[212:215], v225 offset:32768
v_exp_f32 v183, v183
v_mfma_f32_16x16x32_bf16 v[88:91], v[32:35], v[172:175], 0
v_exp_f32 v184, v184
ds_read_b128 a[216:219], v226 offset:32768
v_exp_f32_e64 v185, v185
s_add_u32 m0, s60, 12288
s_add_u32 s3, s64, 98304
ds_read_b128 a[220:223], v227 offset:32768
buffer_load_dwordx4 v39, s[12:15], s3 offen lds
v_exp_f32 v186, v186
v_exp_f32 v187, v187
v_cvt_pk_bf16_f32 v180, v180, v181
v_cvt_pk_bf16_f32 v181, v182, v183
v_cvt_pk_bf16_f32 v182, v184, v185
v_cvt_pk_bf16_f32 v183, v186, v187
v_exp_f32 v188, v188
v_exp_f32 v189, v189
s_add_u32 m0, s60, 16384
s_add_u32 s3, s64, 131072
buffer_load_dwordx4 v39, s[12:15], s3 offen lds
v_mfma_f32_16x16x32_bf16 v[60:63], v[162:165], v[180:183], 0
v_exp_f32 v190, v190
v_exp_f32 v191, v191
v_mfma_f32_16x16x32_bf16 v[92:95], v[32:35], v[180:183], 0
v_exp_f32 v192, v192
v_exp_f32 v193, v193
v_exp_f32 v194, v194
s_waitcnt vmcnt(9)
ds_read_b128 a[224:227], v224 offset:49152
v_exp_f32_e64 v195, v195
v_cvt_pk_bf16_f32 v188, v188, v189
v_cvt_pk_bf16_f32 v189, v190, v191
ds_read_b128 a[228:231], v225 offset:49152
v_cvt_pk_bf16_f32 v190, v192, v193
v_cvt_pk_bf16_f32 v191, v194, v195
v_exp_f32 v196, v196
ds_read_b128 a[232:235], v226 offset:49152
v_exp_f32 v197, v197
v_mfma_f32_16x16x32_bf16 v[64:67], v[154:157], v[188:191], 0
s_add_u32 m0, s60, 20480
ds_read_b128 a[236:239], v227 offset:49152
s_add_u32 s3, s64, 163840
buffer_load_dwordx4 v39, s[12:15], s3 offen lds
v_exp_f32 v198, v198
v_exp_f32 v199, v199
v_mfma_f32_16x16x32_bf16 v[96:99], v[32:35], v[188:191], 0
v_exp_f32 v200, v200
v_exp_f32 v201, v201
v_exp_f32 v202, v202
v_exp_f32 v203, v203
v_cvt_pk_bf16_f32 v196, v196, v197
s_add_u32 m0, s60, 24576
s_add_u32 s3, s64, 196608
buffer_load_dwordx4 v39, s[12:15], s3 offen lds
v_cvt_pk_bf16_f32 v197, v198, v199
v_cvt_pk_bf16_f32 v198, v200, v201
v_cvt_pk_bf16_f32 v199, v202, v203
v_rcp_f32 v88, v88
s_nop 0
v_mfma_f32_16x16x32_bf16 v[68:71], v[164:167], v[196:199], 0
v_rcp_f32_e64 v92, v92
v_mfma_f32_16x16x32_bf16 v[100:103], v[32:35], v[196:199], 0
s_add_u32 m0, s60, 28672
s_add_u32 s3, s64, 229376
buffer_load_dwordx4 v39, s[12:15], s3 offen lds
v_rcp_f32 v96, v96
v_mul_f32 v56, v56, v88
v_mul_f32 v57, v57, v88
v_mul_f32 v58, v58, v88
v_mul_f32 v59, v59, v88
v_cvt_pk_bf16_f32 v56, v56, v57
v_cvt_pk_bf16_f32 v57, v58, v59
ds_write_b64 v253, v[56:57] offset:8192
s_waitcnt vmcnt(8)
ds_read_b128 a[240:243], v224 offset:16384
v_mul_f32 v60, v60, v92
v_mul_f32 v61, v61, v92
v_mul_f32 v62, v62, v92
ds_read_b128 a[244:247], v225 offset:16384
v_mul_f32 v63, v63, v92
v_cvt_pk_bf16_f32 v60, v60, v61
v_cvt_pk_bf16_f32 v61, v62, v63
ds_read_b128 a[248:251], v226 offset:16384
ds_read_b128 a[252:255], v227 offset:16384
ds_write_b64 v253, v[60:61] offset:10240
v_mul_f32 v64, v64, v96
v_mul_f32 v65, v65, v96
v_mul_f32 v66, v66, v96
v_mul_f32 v67, v67, v96
v_cvt_pk_bf16_f32 v64, v64, v65
v_cvt_pk_bf16_f32 v65, v66, v67
ds_write_b64 v253, v[64:65] offset:12288
v_rcp_f32 v100, v100
s_nop 0
v_mul_f32 v68, v68, v100
v_mul_f32 v69, v69, v100
v_mul_f32 v70, v70, v100
v_mul_f32 v71, v71, v100
v_cvt_pk_bf16_f32 v68, v68, v69
v_cvt_pk_bf16_f32 v69, v70, v71
ds_write_b64 v253, v[68:69] offset:14336
s_waitcnt lgkmcnt(0)
s_barrier
ds_read_b128 v[108:111], v254 offset:0
ds_read_b128 v[112:115], v254 offset:1024
ds_read_b128 v[116:119], v254 offset:8192
ds_read_b128 v[120:123], v254 offset:9216
s_add_u32 s97, s56, 65536
s_nop 0
s_waitcnt lgkmcnt(0)
buffer_store_dwordx4 v[108:111], v4, s[36:39], s56 offen offset:0 sc1
buffer_store_dwordx4 v[112:115], v4, s[36:39], s56 offen offset:1024 sc1
buffer_store_dwordx4 v[116:119], v4, s[36:39], s97 offen offset:0 sc1
buffer_store_dwordx4 v[120:123], v4, s[36:39], s97 offen offset:1024 sc1
s_add_u32 m0, s60, 32768
s_add_u32 s3, s64, 262144
buffer_load_dwordx4 v39, s[12:15], s3 offen lds
s_add_u32 m0, s60, 36864
s_add_u32 s3, s64, 294912
buffer_load_dwordx4 v39, s[12:15], s3 offen lds
s_add_u32 m0, s60, 40960
s_add_u32 s3, s64, 327680
buffer_load_dwordx4 v39, s[12:15], s3 offen lds
s_add_u32 m0, s60, 45056
s_add_u32 s3, s64, 360448
buffer_load_dwordx4 v39, s[12:15], s3 offen lds
s_add_u32 m0, s60, 49152
s_add_u32 s3, s64, 393216
buffer_load_dwordx4 v39, s[12:15], s3 offen lds
s_add_u32 m0, s60, 53248
s_add_u32 s3, s64, 425984
buffer_load_dwordx4 v39, s[12:15], s3 offen lds
s_add_u32 m0, s60, 57344
s_add_u32 s3, s64, 458752
buffer_load_dwordx4 v39, s[12:15], s3 offen lds
s_add_u32 m0, s60, 61440
s_add_u32 s3, s64, 491520
buffer_load_dwordx4 v39, s[12:15], s3 offen lds
s_add_u32 m0, s60, 90112
s_add_u32 s3, s64, 0
s_nop 0
buffer_load_dwordx4 v39, s[28:31], s3 offen lds
s_add_u32 m0, s60, 94208
s_add_u32 s3, s64, 98304
buffer_load_dwordx4 v39, s[28:31], s3 offen lds
s_add_u32 m0, s60, 98304
s_add_u32 s3, s64, 196608
buffer_load_dwordx4 v39, s[28:31], s3 offen lds
s_add_u32 m0, s60, 102400
s_add_u32 s3, s64, 294912
buffer_load_dwordx4 v39, s[28:31], s3 offen lds
s_add_u32 m0, s60, 106496
s_add_u32 s3, s64, 393216
buffer_load_dwordx4 v39, s[28:31], s3 offen lds
s_add_u32 m0, s60, 110592
s_add_u32 s3, s64, 491520
buffer_load_dwordx4 v39, s[28:31], s3 offen lds
s_add_u32 m0, s60, 114688
s_add_u32 s3, s64, 589824
buffer_load_dwordx4 v39, s[28:31], s3 offen lds
s_add_u32 m0, s60, 118784
s_add_u32 s3, s64, 688128
buffer_load_dwordx4 v39, s[28:31], s3 offen lds
s_add_u32 m0, s60, 122880
s_add_u32 s3, s64, 32768
buffer_load_dwordx4 v39, s[28:31], s3 offen lds
s_add_u32 m0, s60, 126976
s_add_u32 s3, s64, 131072
buffer_load_dwordx4 v39, s[28:31], s3 offen lds
s_add_u32 m0, s60, 131072
s_add_u32 s3, s64, 229376
buffer_load_dwordx4 v39, s[28:31], s3 offen lds
s_add_u32 m0, s60, 135168
s_add_u32 s3, s64, 327680
buffer_load_dwordx4 v39, s[28:31], s3 offen lds
s_branch L_join
L_lnA_slow:
s_mov_b32 s96, 0
L_lnA_loop:
s_sleep 2
buffer_load_dwordx4 v[180:183], v249, s[36:39], 0 offen sc1
s_waitcnt vmcnt(0)
v_xor_b32 v184, s69, v181
v_bitop3_b32 v184, v184, v183, s69 bitop3:0xf6
v_cmp_ne_u32 vcc, 0, v184
s_cbranch_vccz L_lnA_ok
s_add_u32 s96, s96, 1
s_cmp_lt_u32 s96, 200000
s_cbranch_scc1 L_lnA_loop
v_mov_b32 v3, 0
global_store_dword v3, v4, s[62:63] offset:24
s_waitcnt vmcnt(0)
v_mov_b32 v3, s69
s_branch L_lnA_ok
L_lnZ_slow:
s_mov_b32 s96, 0
L_lnZ_loop:
s_sleep 2
buffer_load_dwordx4 v[180:183], v249, s[36:39], 0 offen sc1
s_waitcnt vmcnt(0)
v_xor_b32 v184, s69, v181
v_bitop3_b32 v184, v184, v183, s69 bitop3:0xf6
v_cmp_ne_u32 vcc, 0, v184
s_cbranch_vccz L_lnZ_ok
s_add_u32 s96, s96, 1
s_cmp_lt_u32 s96, 200000
s_cbranch_scc1 L_lnZ_loop
v_mov_b32 v3, 0
global_store_dword v3, v4, s[62:63] offset:24
s_waitcnt vmcnt(0)
v_mov_b32 v3, s69
s_branch L_lnZ_ok
L_h1_slow:
s_mov_b32 s96, 0
L_h1_loop:
s_sleep 2
buffer_load_dwordx4 v[160:163], v4, s[36:39], s44 offen offset:0 sc1
buffer_load_dwordx4 v[164:167], v4, s[36:39], s44 offen offset:1024 sc1
buffer_load_dwordx4 v[168:171], v4, s[36:39], s44 offen offset:2048 sc1
buffer_load_dwordx4 v[172:175], v4, s[36:39], s44 offen offset:3072 sc1
s_waitcnt vmcnt(0)
v_xor_b32 v176, s69, v161
v_xor_b32 v177, s69, v163
v_bitop3_b32 v176, v176, v165, s69 bitop3:0xf6
v_bitop3_b32 v177, v177, v167, s69 bitop3:0xf6
v_bitop3_b32 v176, v176, v169, s69 bitop3:0xf6
v_bitop3_b32 v177, v177, v171, s69 bitop3:0xf6
v_bitop3_b32 v176, v176, v173, s69 bitop3:0xf6
v_bitop3_b32 v177, v177, v175, s69 bitop3:0xf6
v_or_b32 v176, v176, v177
v_cmp_ne_u32 vcc, 0, v176
s_cbranch_vccz L_h1_ok
s_add_u32 s96, s96, 1
s_cmp_lt_u32 s96, 200000
s_cbranch_scc1 L_h1_loop
v_mov_b32 v3, 0
global_store_dword v3, v4, s[62:63] offset:4
s_waitcnt vmcnt(0)
v_mov_b32 v3, s69
s_branch L_h1_ok
L_h2_slow:
s_mov_b32 s96, 0
L_h2_loop:
s_sleep 2
buffer_load_dword v30, v37, s[36:39], s52 offen sc1
s_waitcnt vmcnt(0)
v_cmp_ne_u32 vcc, s69, v30
s_cbranch_vccz L_h2_ok
s_add_u32 s96, s96, 1
s_cmp_lt_u32 s96, 200000
s_cbranch_scc1 L_h2_loop
v_mov_b32 v3, 0
global_store_dword v3, v4, s[62:63] offset:8
s_waitcnt vmcnt(0)
v_mov_b32 v3, s69
s_branch L_h2_ok
L_h6_slow:
s_mov_b32 s96, 0
L_h6_loop:
s_sleep 2
buffer_load_dword v30, v29, s[36:39], s50 offen sc1
s_waitcnt vmcnt(0)
v_cmp_ne_u32 vcc, s69, v30
s_cbranch_vccz L_h6_ok
s_add_u32 s96, s96, 1
s_cmp_lt_u32 s96, 200000
s_cbranch_scc1 L_h6_loop
v_mov_b32 v3, 0
global_store_dword v3, v4, s[62:63] offset:28
s_waitcnt vmcnt(0)
v_mov_b32 v3, s69
s_branch L_h6_ok
L_h3_slow:
s_mov_b32 s96, 0
L_h3_loop:
s_sleep 2
buffer_load_dword v30, v36, s[36:39], s53 offen offset:0 sc1
s_waitcnt vmcnt(0)
v_cmp_ne_u32 vcc, s69, v30
s_cbranch_vccz L_h3_ok
s_add_u32 s96, s96, 1
s_cmp_lt_u32 s96, 200000
s_cbranch_scc1 L_h3_loop
v_mov_b32 v3, 0
global_store_dword v3, v4, s[62:63] offset:12
s_waitcnt vmcnt(0)
v_mov_b32 v3, s69
s_branch L_h3_ok
L_h4_slow:
s_mov_b32 s96, 0
L_h4_loop:
s_sleep 2
buffer_load_dword v30, v36, s[36:39], s54 offen offset:0 sc1
s_waitcnt vmcnt(0)
v_cmp_ne_u32 vcc, s69, v30
s_cbranch_vccz L_h4_ok
s_add_u32 s96, s96, 1
s_cmp_lt_u32 s96, 200000
s_cbranch_scc1 L_h4_loop
v_mov_b32 v3, 0
global_store_dword v3, v4, s[62:63] offset:16
s_waitcnt vmcnt(0)
v_mov_b32 v3, s69
s_branch L_h4_ok
L_h5_slow:
s_mov_b32 s96, 0
L_h5_loop:
s_sleep 0
s_add_u32 s97, s57, 1024
buffer_load_dwordx4 v[192:195], v4, s[36:39], s97 offen sc1
s_add_u32 s97, s57, 4096
buffer_load_dwordx4 v[196:199], v4, s[36:39], s97 offen sc1
s_add_u32 s97, s57, 7168
buffer_load_dwordx4 v[200:203], v4, s[36:39], s97 offen sc1
s_add_u32 s97, s57, 10240
buffer_load_dwordx4 v[204:207], v4, s[36:39], s97 offen sc1
s_add_u32 s97, s57, 13312
buffer_load_dwordx4 v[208:211], v4, s[36:39], s97 offen sc1
s_add_u32 s97, s57, 16384
buffer_load_dwordx4 v[212:215], v4, s[36:39], s97 offen sc1
s_add_u32 s97, s57, 19456
buffer_load_dwordx4 v[216:219], v4, s[36:39], s97 offen sc1
s_waitcnt vmcnt(0)
v_max3_u32 v16, v192, v193, v194
v_max3_u32 v17, v195, v196, v197
v_max3_u32 v16, v16, v198, v199
v_max3_u32 v17, v17, v200, v201
v_max3_u32 v16, v16, v202, v203
v_max3_u32 v17, v17, v204, v205
v_max3_u32 v16, v16, v206, v207
v_max3_u32 v17, v17, v208, v209
v_max3_u32 v16, v16, v210, v211
v_max3_u32 v17, v17, v212, v213
v_max3_u32 v16, v16, v214, v215
v_max3_u32 v17, v17, v216, v217
v_max3_u32 v16, v16, v218, v219
v_max_u32 v16, v16, v17
v_cmp_eq_u32 vcc, -1, v16
s_cbranch_vccz L_h5_ok
s_add_u32 s96, s96, 1
s_cmp_lt_u32 s96, 200000
s_cbranch_scc1 L_h5_loop
v_mov_b32 v3, 0
global_store_dword v3, v4, s[62:63] offset:20
s_waitcnt vmcnt(0)
v_mov_b32 v3, s69
s_branch L_h5_ok
L_h7_slow:
s_mov_b32 s96, 0
L_h7_loop:
s_sleep 0
s_add_u32 s97, s57, 2048
buffer_load_dwordx4 v[220:223], v4, s[36:39], s97 offen sc1
s_add_u32 s97, s57, 5120
buffer_load_dwordx4 v[224:227], v4, s[36:39], s97 offen sc1
s_add_u32 s97, s57, 8192
buffer_load_dwordx4 v[228:231], v4, s[36:39], s97 offen sc1
s_add_u32 s97, s57, 11264
buffer_load_dwordx4 v[232:235], v4, s[36:39], s97 offen sc1
s_add_u32 s97, s57, 14336
buffer_load_dwordx4 v[236:239], v4, s[36:39], s97 offen sc1
s_add_u32 s97, s57, 17408
buffer_load_dwordx4 v[240:243], v4, s[36:39], s97 offen sc1
s_add_u32 s97, s57, 20480
buffer_load_dwordx4 v[244:247], v4, s[36:39], s97 offen sc1
s_waitcnt vmcnt(0)
v_max3_u32 v16, v220, v221, v222
v_max3_u32 v17, v223, v224, v225
v_max3_u32 v16, v16, v226, v227
v_max3_u32 v17, v17, v228, v229
v_max3_u32 v16, v16, v230, v231
v_max3_u32 v17, v17, v232, v233
v_max3_u32 v16, v16, v234, v235
v_max3_u32 v17, v17, v236, v237
v_max3_u32 v16, v16, v238, v239
v_max3_u32 v17, v17, v240, v241
v_max3_u32 v16, v16, v242, v243
v_max3_u32 v17, v17, v244, v245
v_max3_u32 v16, v16, v246, v247
v_max_u32 v16, v16, v17
v_cmp_eq_u32 vcc, -1, v16
s_cbranch_vccz L_h7_ok
s_add_u32 s96, s96, 1
s_cmp_lt_u32 s96, 200000
s_cbranch_scc1 L_h7_loop
v_mov_b32 v3, 0
global_store_dword v3, v4, s[62:63] offset:0
s_waitcnt vmcnt(0)
v_mov_b32 v3, s69
s_branch L_h7_ok
.section .rodata,"a"
.p2align 6
.amdhsa_kernel recurrent_scan__sliding_local_dilated__mixer_gmlp__prompt_kernel
.amdhsa_next_free_vgpr 512
.amdhsa_next_free_sgpr 102
.amdhsa_accum_offset 256
.amdhsa_group_segment_fixed_size 0
.amdhsa_kernarg_size 88
.amdhsa_user_sgpr_count 2
.amdhsa_user_sgpr_kernarg_segment_ptr 1
.amdhsa_system_sgpr_workgroup_id_x 1
.end_amdhsa_kernel
```
